```python
import torch

def _softmax(x, axis=-1):
    return torch.softmax(x, dim=axis)

def _gelu(x):
    return torch.nn.functional.gelu(x, approximate='tanh')

def _silu(x):
    return torch.nn.functional.silu(x)

def _sigmoid(x):
    return torch.sigmoid(x)

def _layernorm(x, axis=-1, eps=1e-05):
    m = x.mean(dim=axis, keepdim=True)
    v = x.var(dim=axis, keepdim=True, unbiased=False)
    return (x - m) / torch.sqrt(v + eps)

def _scatter_add(tgt, idx, src, axis=0):
    return tgt.clone().index_add_(axis, idx, src)

def _segment_sum(src, seg, n):
    out = torch.zeros((n,) + src.shape[1:], dtype=src.dtype)
    return out.index_add_(0, seg, src)

def _pad(x, pw):
    flat = tuple((v for pair in reversed(pw) for v in pair))
    return torch.nn.functional.pad(x, flat)
kernel_name = 'adaLN_cond__spectral_gfnet__mixer_channel_mlp__prompt'

def setup_inputs():

    _w = lambda a: (lambda t: t.to(torch.bfloat16) if t.is_floating_point() else t)(torch.as_tensor(a))

    def _A_setup():
        B, S, D = (1, 2048, 1024)
        Df = D // 2 + 1
        return {'x': _w((lambda *s: torch.randn(*s, dtype=torch.bfloat16) * 0.05)(B, S, D)), 'w_r': _w((lambda *s: torch.randn(*s, dtype=torch.bfloat16) * 1.6)(S, Df) * 0.02), 'w_i': _w((lambda *s: torch.randn(*s, dtype=torch.bfloat16) * 1.6)(S, Df) * 0.02)}
    _A_in = _A_setup()

    def _B_setup():
        B, S, D, F = (1, 2048, 1024, 3584)
        return {'x': _w((lambda *s: torch.randn(*s, dtype=torch.bfloat16) * 0.05)(B, S, D)), 'w1': _w((lambda *s: torch.randn(*s, dtype=torch.bfloat16) * 3.2)(D, F) * D ** (-0.5)), 'b1': _w((lambda *s: torch.randn(*s, dtype=torch.bfloat16) * 0.8)(F)), 'w2': _w((lambda *s: torch.randn(*s, dtype=torch.bfloat16) * 0.05)(F, D) * F ** (-0.5)), 'b2': _w((lambda *s: torch.randn(*s, dtype=torch.bfloat16) * 0.1)(D))}
    _B_in = _B_setup()
    return {'A_x': _A_in['x'], 'A_w_r': _A_in['w_r'], 'A_w_i': _A_in['w_i'], 'B_x': _B_in['x'], 'B_w1': _B_in['w1'], 'B_b1': _B_in['b1'], 'B_w2': _B_in['w2'], 'B_b2': _B_in['b2'], 'c': _w((lambda *s: torch.randn(*s, dtype=torch.bfloat16) * 0.2)(1, 1024) * 8.0), 'w_mod': _w((lambda *s: torch.randn(*s, dtype=torch.bfloat16) * 0.2)(1024, 6 * 1024) * 1024 ** (-0.5) * 8.0)}

def reference(A_x, A_w_r, A_w_i, B_x, B_w1, B_b1, B_w2, B_b2, c, w_mod):

    def _A_ref(x, w_r, w_i):
        B, S, D = x.shape
        X = (lambda x, axes=(-2, -1): torch.fft.rfft2(x.float(), dim=axes))(x, axes=(-2, -1))
        W = w_r + 1j * w_i
        X = X * W
        y = (lambda x, s, axes=(-2, -1): torch.fft.irfft2(x, s=s, dim=axes).to(torch.bfloat16))(X, (S, D), axes=(-2, -1))
        return y

    def _B_ref(x, w1, b1, w2, b2):
        y = _layernorm(x, axis=-1)
        h = _gelu(torch.einsum('bsd,df->bsf', y, w1) + b1)
        return torch.einsum('bsf,fd->bsd', h, w2) + b2
    x = A_x
    mod = (_silu(c) @ w_mod).reshape(c.shape[0], 6, 1, -1)
    sa, ca, ga, sb, cb, gb = (mod[:, 0].clone(), mod[:, 1].clone(), mod[:, 2].clone(), mod[:, 3].clone(), mod[:, 4].clone(), mod[:, 5].clone())
    h = _layernorm(x, axis=-1) * (1 + ca) + sa
    x = x + ga * _A_ref(h, A_w_r, A_w_i)
    h = _layernorm(x, axis=-1) * (1 + cb) + sb
    x = x + gb * _B_ref(h, B_w1, B_b1, B_w2, B_b2)
    return x
```

```asm
; @launch kernel=adaLN_cond__spectral_gfnet__mixer_channel_mlp__prompt_kernel grid=(256,1,1) block=(512,1,1) lds=163840
.amdgcn_target "amdgcn-amd-amdhsa--gfx950"
.text
.globl adaLN_cond__spectral_gfnet__mixer_channel_mlp__prompt_kernel
.p2align 8
.type adaLN_cond__spectral_gfnet__mixer_channel_mlp__prompt_kernel,@function
adaLN_cond__spectral_gfnet__mixer_channel_mlp__prompt_kernel:
    s_cmp_ge_u32 s2, 256
    s_cbranch_scc1 adaLN_cond__spectral_gfnet__mixer_channel_mlp__prompt_kernel_end1
    s_load_dwordx2 s[8:9], s[0:1], 96
    s_load_dwordx2 s[10:11], s[0:1], 0
    s_load_dwordx4 s[4:7], s[0:1], 32
    s_load_dwordx4 s[52:55], s[0:1], 48
    s_load_dwordx2 s[56:57], s[0:1], 80
    s_load_dwordx2 s[66:67], s[0:1], 88
    v_lshrrev_b32 v1, 6, v0
    v_and_b32 v2, 63, v0
    v_readfirstlane_b32 s3, v1
    s_and_b32 s58, s2, 7
    s_lshl_b32 s58, s58, 5
    s_lshr_b32 s60, s2, 3
    s_add_u32 s58, s58, s60
    s_and_b32 s60, s58, 15
    s_cmp_lt_u32 s3, 4
    s_cbranch_scc1 adaLN_cond__spectral_gfnet__mixer_channel_mlp__prompt_kernel_comp2
    s_load_dwordx4 s[44:47], s[0:1], 64
    s_load_dwordx4 s[48:51], s[0:1], 8
    s_sub_u32 s35, s3, 4
    s_setprio 1
    s_lshr_b32 s61, s58, 1
    v_and_b32 v3, 7, v2
    v_lshrrev_b32 v4, 3, v2
    v_mul_u32_u24 v100, 98304, v4
    v_lshl_add_u32 v100, v3, 4, v100
    v_lshlrev_b32 v101, 4, v4
    s_and_b32 s30, s58, 1
    s_cmp_eq_u32 s30, 1
    s_cbranch_scc1 adaLN_cond__spectral_gfnet__mixer_channel_mlp__prompt_kernel_filt3
    s_lshr_b32 s31, s61, 2
    s_and_b32 s30, s61, 3
    s_lshl_b32 s32, s30, 2
    s_add_u32 s32, s32, s35
    s_mul_i32 s33, s32, 786432
    s_lshl_b32 s34, s31, 7
    s_add_u32 s33, s33, s34
    s_lshl_b32 s32, s32, 7
    s_waitcnt lgkmcnt(0)
    s_mov_b32 s12, s46
    s_mov_b32 s13, s47
    s_mov_b32 s14, 12582912
    s_mov_b32 s15, 0x20000
    s_mov_b32 s16, s44
    s_mov_b32 s17, s45
    s_mov_b32 s18, 2048
    s_mov_b32 s19, 0x20000
    buffer_load_dwordx4 v[8:11], v101, s[16:19], s32 offen
    buffer_load_dwordx4 v[48:51], v100, s[12:15], s33 offen nt
    s_add_u32 s33, s33, 12288
    buffer_load_dwordx4 v[52:55], v100, s[12:15], s33 offen nt
    s_add_u32 s33, s33, 12288
    buffer_load_dwordx4 v[56:59], v100, s[12:15], s33 offen nt
    s_add_u32 s33, s33, 12288
    buffer_load_dwordx4 v[60:63], v100, s[12:15], s33 offen nt
    s_add_u32 s33, s33, 12288
    buffer_load_dwordx4 v[64:67], v100, s[12:15], s33 offen nt
    s_add_u32 s33, s33, 12288
    buffer_load_dwordx4 v[68:71], v100, s[12:15], s33 offen nt
    s_add_u32 s33, s33, 12288
    buffer_load_dwordx4 v[72:75], v100, s[12:15], s33 offen nt
    s_add_u32 s33, s33, 12288
    buffer_load_dwordx4 v[76:79], v100, s[12:15], s33 offen nt
    s_add_u32 s33, s33, 12288
    s_mov_b32 s20, s8
    s_mov_b32 s21, s9
    s_mov_b32 s22, 37748736
    s_mov_b32 s23, 0x20000
    s_getpc_b64 s[24:25]
adaLN_cond__spectral_gfnet__mixer_channel_mlp__prompt_kernel_pc5:
    s_sub_u32 s24, s24, adaLN_cond__spectral_gfnet__mixer_channel_mlp__prompt_kernel_pc5-adaLN_cond__spectral_gfnet__mixer_channel_mlp__prompt_kernel
    s_subb_u32 s25, s25, 0
    s_mov_b32 s26, code_end-adaLN_cond__spectral_gfnet__mixer_channel_mlp__prompt_kernel
    s_mov_b32 s27, 0x20000
    s_getreg_b32 s28, hwreg(HW_REG_HW_ID, 8, 3)
    s_lshl_b32 s28, s28, 2
    s_add_u32 s28, s28, s35
    s_lshl_b32 s28, s28, 10
    v_lshlrev_b32 v120, 4, v2
    buffer_load_dwordx4 v[124:127], v120, s[24:27], s28 offen
    v_lshlrev_b32 v12, 7, v2
    v_mov_b32 v84, 0
    v_mov_b32 v85, 0
    v_mov_b32 v86, 0
    v_mov_b32 v87, 0
    s_mul_i32 s36, s61, 1792
    s_add_u32 s36, s36, 393216
    s_cmp_eq_u32 s35, 0
    s_cselect_b32 s36, s36, 37748736
    s_mov_b64 exec, 0x3fff
    buffer_store_dwordx4 v[84:87], v12, s[20:23], s36 offen sc1
    s_mov_b64 exec, -1
    s_mul_i32 s34, s30, 24576
    s_lshl_b32 s36, s31, 8
    s_add_u32 s34, s34, s36
    v_lshlrev_b32 v12, 2, v2
    s_waitcnt vmcnt(10)
    v_lshlrev_b32 v16, 16, v8
    v_and_b32 v17, 0xffff0000, v8
    v_lshlrev_b32 v18, 16, v9
    v_and_b32 v19, 0xffff0000, v9
    v_lshlrev_b32 v20, 16, v10
    v_and_b32 v21, 0xffff0000, v10
    v_lshlrev_b32 v22, 16, v11
    v_and_b32 v23, 0xffff0000, v11
    v_mul_f32 v24, 0xbfb8aa3b, v16
    v_mul_f32 v25, 0xbfb8aa3b, v17
    v_mul_f32 v26, 0xbfb8aa3b, v18
    v_mul_f32 v27, 0xbfb8aa3b, v19
    v_mul_f32 v28, 0xbfb8aa3b, v20
    v_mul_f32 v29, 0xbfb8aa3b, v21
    v_mul_f32 v30, 0xbfb8aa3b, v22
    v_mul_f32 v31, 0xbfb8aa3b, v23
    v_exp_f32 v24, v24
    v_exp_f32 v25, v25
    v_exp_f32 v26, v26
    v_exp_f32 v27, v27
    v_exp_f32 v28, v28
    v_exp_f32 v29, v29
    v_exp_f32 v30, v30
    v_exp_f32 v31, v31
    v_add_f32 v24, 1.0, v24
    v_add_f32 v25, 1.0, v25
    v_add_f32 v26, 1.0, v26
    v_add_f32 v27, 1.0, v27
    v_add_f32 v28, 1.0, v28
    v_add_f32 v29, 1.0, v29
    v_add_f32 v30, 1.0, v30
    v_add_f32 v31, 1.0, v31
    v_rcp_f32 v24, v24
    v_rcp_f32 v25, v25
    v_rcp_f32 v26, v26
    v_rcp_f32 v27, v27
    v_rcp_f32 v28, v28
    v_rcp_f32 v29, v29
    v_rcp_f32 v30, v30
    v_rcp_f32 v31, v31
    v_pk_mul_f32 v[16:17], v[16:17], v[24:25]
    v_pk_mul_f32 v[18:19], v[18:19], v[26:27]
    v_pk_mul_f32 v[20:21], v[20:21], v[28:29]
    v_pk_mul_f32 v[22:23], v[22:23], v[30:31]
    v_cvt_pk_bf16_f32 v24, v16, v17
    v_cvt_pk_bf16_f32 v26, v18, v19
    v_cvt_pk_bf16_f32 v28, v20, v21
    v_cvt_pk_bf16_f32 v30, v22, v23
    v_lshlrev_b32 v16, 16, v24
    v_and_b32 v17, 0xffff0000, v24
    v_lshlrev_b32 v18, 16, v26
    v_and_b32 v19, 0xffff0000, v26
    v_lshlrev_b32 v20, 16, v28
    v_and_b32 v21, 0xffff0000, v28
    v_lshlrev_b32 v22, 16, v30
    v_and_b32 v23, 0xffff0000, v30
    s_waitcnt vmcnt(9)
    v_lshlrev_b32 v32, 16, v48
    v_and_b32 v33, 0xffff0000, v48
    v_lshlrev_b32 v34, 16, v49
    v_and_b32 v35, 0xffff0000, v49
    v_lshlrev_b32 v36, 16, v50
    v_and_b32 v37, 0xffff0000, v50
    v_lshlrev_b32 v38, 16, v51
    v_and_b32 v39, 0xffff0000, v51
    v_pk_mul_f32 v[40:41], v[32:33], v[16:17] op_sel_hi:[1,0]
    v_pk_mul_f32 v[42:43], v[34:35], v[16:17] op_sel_hi:[1,0]
    v_pk_mul_f32 v[44:45], v[36:37], v[16:17] op_sel_hi:[1,0]
    v_pk_mul_f32 v[46:47], v[38:39], v[16:17] op_sel_hi:[1,0]
    s_waitcnt vmcnt(8)
    v_lshlrev_b32 v32, 16, v52
    v_and_b32 v33, 0xffff0000, v52
    v_lshlrev_b32 v34, 16, v53
    v_and_b32 v35, 0xffff0000, v53
    v_lshlrev_b32 v36, 16, v54
    v_and_b32 v37, 0xffff0000, v54
    v_lshlrev_b32 v38, 16, v55
    v_and_b32 v39, 0xffff0000, v55
    v_pk_fma_f32 v[40:41], v[32:33], v[16:17], v[40:41] op_sel:[0,1,0] op_sel_hi:[1,1,1]
    v_pk_fma_f32 v[42:43], v[34:35], v[16:17], v[42:43] op_sel:[0,1,0] op_sel_hi:[1,1,1]
    v_pk_fma_f32 v[44:45], v[36:37], v[16:17], v[44:45] op_sel:[0,1,0] op_sel_hi:[1,1,1]
    v_pk_fma_f32 v[46:47], v[38:39], v[16:17], v[46:47] op_sel:[0,1,0] op_sel_hi:[1,1,1]
    s_waitcnt vmcnt(7)
    v_lshlrev_b32 v32, 16, v56
    v_and_b32 v33, 0xffff0000, v56
    v_lshlrev_b32 v34, 16, v57
    v_and_b32 v35, 0xffff0000, v57
    v_lshlrev_b32 v36, 16, v58
    v_and_b32 v37, 0xffff0000, v58
    v_lshlrev_b32 v38, 16, v59
    v_and_b32 v39, 0xffff0000, v59
    v_pk_fma_f32 v[40:41], v[32:33], v[18:19], v[40:41] op_sel_hi:[1,0,1]
    v_pk_fma_f32 v[42:43], v[34:35], v[18:19], v[42:43] op_sel_hi:[1,0,1]
    v_pk_fma_f32 v[44:45], v[36:37], v[18:19], v[44:45] op_sel_hi:[1,0,1]
    v_pk_fma_f32 v[46:47], v[38:39], v[18:19], v[46:47] op_sel_hi:[1,0,1]
    s_waitcnt vmcnt(6)
    v_lshlrev_b32 v32, 16, v60
    v_and_b32 v33, 0xffff0000, v60
    v_lshlrev_b32 v34, 16, v61
    v_and_b32 v35, 0xffff0000, v61
    v_lshlrev_b32 v36, 16, v62
    v_and_b32 v37, 0xffff0000, v62
    v_lshlrev_b32 v38, 16, v63
    v_and_b32 v39, 0xffff0000, v63
    v_pk_fma_f32 v[40:41], v[32:33], v[18:19], v[40:41] op_sel:[0,1,0] op_sel_hi:[1,1,1]
    v_pk_fma_f32 v[42:43], v[34:35], v[18:19], v[42:43] op_sel:[0,1,0] op_sel_hi:[1,1,1]
    v_pk_fma_f32 v[44:45], v[36:37], v[18:19], v[44:45] op_sel:[0,1,0] op_sel_hi:[1,1,1]
    v_pk_fma_f32 v[46:47], v[38:39], v[18:19], v[46:47] op_sel:[0,1,0] op_sel_hi:[1,1,1]
    s_waitcnt vmcnt(5)
    v_lshlrev_b32 v32, 16, v64
    v_and_b32 v33, 0xffff0000, v64
    v_lshlrev_b32 v34, 16, v65
    v_and_b32 v35, 0xffff0000, v65
    v_lshlrev_b32 v36, 16, v66
    v_and_b32 v37, 0xffff0000, v66
    v_lshlrev_b32 v38, 16, v67
    v_and_b32 v39, 0xffff0000, v67
    v_pk_fma_f32 v[40:41], v[32:33], v[20:21], v[40:41] op_sel_hi:[1,0,1]
    v_pk_fma_f32 v[42:43], v[34:35], v[20:21], v[42:43] op_sel_hi:[1,0,1]
    v_pk_fma_f32 v[44:45], v[36:37], v[20:21], v[44:45] op_sel_hi:[1,0,1]
    v_pk_fma_f32 v[46:47], v[38:39], v[20:21], v[46:47] op_sel_hi:[1,0,1]
    s_waitcnt vmcnt(4)
    v_lshlrev_b32 v32, 16, v68
    v_and_b32 v33, 0xffff0000, v68
    v_lshlrev_b32 v34, 16, v69
    v_and_b32 v35, 0xffff0000, v69
    v_lshlrev_b32 v36, 16, v70
    v_and_b32 v37, 0xffff0000, v70
    v_lshlrev_b32 v38, 16, v71
    v_and_b32 v39, 0xffff0000, v71
    v_pk_fma_f32 v[40:41], v[32:33], v[20:21], v[40:41] op_sel:[0,1,0] op_sel_hi:[1,1,1]
    v_pk_fma_f32 v[42:43], v[34:35], v[20:21], v[42:43] op_sel:[0,1,0] op_sel_hi:[1,1,1]
    v_pk_fma_f32 v[44:45], v[36:37], v[20:21], v[44:45] op_sel:[0,1,0] op_sel_hi:[1,1,1]
    v_pk_fma_f32 v[46:47], v[38:39], v[20:21], v[46:47] op_sel:[0,1,0] op_sel_hi:[1,1,1]
    s_waitcnt vmcnt(3)
    v_lshlrev_b32 v32, 16, v72
    v_and_b32 v33, 0xffff0000, v72
    v_lshlrev_b32 v34, 16, v73
    v_and_b32 v35, 0xffff0000, v73
    v_lshlrev_b32 v36, 16, v74
    v_and_b32 v37, 0xffff0000, v74
    v_lshlrev_b32 v38, 16, v75
    v_and_b32 v39, 0xffff0000, v75
    v_pk_fma_f32 v[40:41], v[32:33], v[22:23], v[40:41] op_sel_hi:[1,0,1]
    v_pk_fma_f32 v[42:43], v[34:35], v[22:23], v[42:43] op_sel_hi:[1,0,1]
    v_pk_fma_f32 v[44:45], v[36:37], v[22:23], v[44:45] op_sel_hi:[1,0,1]
    v_pk_fma_f32 v[46:47], v[38:39], v[22:23], v[46:47] op_sel_hi:[1,0,1]
    s_waitcnt vmcnt(2)
    v_lshlrev_b32 v32, 16, v76
    v_and_b32 v33, 0xffff0000, v76
    v_lshlrev_b32 v34, 16, v77
    v_and_b32 v35, 0xffff0000, v77
    v_lshlrev_b32 v36, 16, v78
    v_and_b32 v37, 0xffff0000, v78
    v_lshlrev_b32 v38, 16, v79
    v_and_b32 v39, 0xffff0000, v79
    v_pk_fma_f32 v[40:41], v[32:33], v[22:23], v[40:41] op_sel:[0,1,0] op_sel_hi:[1,1,1]
    v_pk_fma_f32 v[42:43], v[34:35], v[22:23], v[42:43] op_sel:[0,1,0] op_sel_hi:[1,1,1]
    v_pk_fma_f32 v[44:45], v[36:37], v[22:23], v[44:45] op_sel:[0,1,0] op_sel_hi:[1,1,1]
    v_pk_fma_f32 v[46:47], v[38:39], v[22:23], v[46:47] op_sel:[0,1,0] op_sel_hi:[1,1,1]
    s_nop 0
    v_permlane32_swap_b32 v40, v44
    v_permlane32_swap_b32 v41, v45
    v_permlane32_swap_b32 v42, v46
    v_permlane32_swap_b32 v43, v47
    v_pk_add_f32 v[40:41], v[40:41], v[44:45]
    v_pk_add_f32 v[42:43], v[42:43], v[46:47]
    s_nop 1
    v_permlane16_swap_b32 v40, v42
    v_permlane16_swap_b32 v41, v43
    v_pk_add_f32 v[40:41], v[40:41], v[42:43]
    s_nop 1
    v_add_f32_dpp v40, v40, v40 row_ror:8 row_mask:0xf bank_mask:0xf
    v_add_f32_dpp v41, v41, v41 row_ror:8 row_mask:0xf bank_mask:0xf
    v_and_b32 v14, 7, v2
    v_lshlrev_b32 v14, 5, v14
    v_lshrrev_b32 v15, 4, v2
    v_lshl_add_u32 v14, v15, 3, v14
    s_lshl_b32 s38, s35, 8
    s_add_u32 s38, s38, 92160
    v_add_u32 v14, s38, v14
    ds_write_b64 v14, v[40:41]
    s_waitcnt lgkmcnt(0)
    s_barrier
    s_cmp_lg_u32 s35, 0
    s_cbranch_scc1 adaLN_cond__spectral_gfnet__mixer_channel_mlp__prompt_kernel_w56
    v_lshlrev_b32 v20, 2, v2
    v_add_u32 v20, 92160, v20
    ds_read2st64_b32 v[16:17], v20 offset0:0 offset1:1
    ds_read2st64_b32 v[18:19], v20 offset0:2 offset1:3
    s_waitcnt lgkmcnt(0)
    v_pk_add_f32 v[16:17], v[16:17], v[18:19]
    v_add_f32 v16, v16, v17
    buffer_store_dword v16, v12, s[20:23], s34 offen sc1
    s_mov_b32 s24, s66
    s_mov_b32 s25, s67
    s_mov_b32 s26, 256
    s_mov_b32 s27, 0x20000
    v_mov_b32 v17, 1
    s_mov_b64 exec, 1
    s_waitcnt vmcnt(0)
    buffer_atomic_add v17, off, s[24:27], 0 offset:128 sc0 sc1
    s_waitcnt vmcnt(0)
    v_readfirstlane_b32 s36, v17
    s_nop 0
    s_cmp_lg_u32 s36, 127
    s_cbranch_scc1 adaLN_cond__spectral_gfnet__mixer_channel_mlp__prompt_kernel_ng8
    buffer_store_dword v17, off, s[24:27], 0 sc1
adaLN_cond__spectral_gfnet__mixer_channel_mlp__prompt_kernel_ng8:
    s_mov_b64 exec, -1
    s_branch adaLN_cond__spectral_gfnet__mixer_channel_mlp__prompt_kernel_sj4
adaLN_cond__spectral_gfnet__mixer_channel_mlp__prompt_kernel_w56:
    s_cmp_lg_u32 s35, 1
    s_cbranch_scc1 adaLN_cond__spectral_gfnet__mixer_channel_mlp__prompt_kernel_sj4
    s_lshr_b32 s30, s61, 6
    s_lshl_b32 s30, s30, 4
    s_bfe_u32 s31, s61, 0x10005
    s_lshl_b32 s31, s31, 5
    s_add_u32 s30, s30, s31
    s_bfe_u32 s31, s61, 0x30002
    s_lshl_b32 s31, s31, 8
    s_add_u32 s30, s30, s31
    s_and_b32 s31, s61, 3
    s_lshl_b32 s31, s31, 2
    s_add_u32 s30, s30, s31
    v_and_b32 v3, 3, v2
    v_lshrrev_b32 v4, 2, v2
    v_lshl_add_u32 v3, v3, 6, v4
    v_add_u32 v3, s30, v3
    v_sub_u32 v5, 2048, v3
    v_and_b32 v5, 2047, v5
    v_mul_u32_u24 v3, 1026, v3
    v_mul_u32_u24 v5, 1026, v5
    s_lshl_b32 s31, s61, 6
    s_add_u32 s31, s31, 9437184
    s_add_u32 s32, s31, 8192
    v_lshlrev_b32 v4, 2, v2
    s_mov_b32 s12, s48
    s_mov_b32 s13, s49
    s_mov_b32 s14, 2101248
    s_mov_b32 s15, 0x20000
    s_mov_b32 s16, s50
    s_mov_b32 s17, s51
    s_mov_b32 s18, 2101248
    s_mov_b32 s19, 0x20000
    s_mov_b64 exec, 0xffff
    buffer_load_ushort v16, v3, s[12:15], 0 offen offset:0
    buffer_load_ushort v17, v3, s[12:15], 0 offen offset:1024
    buffer_load_ushort v18, v3, s[16:19], 0 offen offset:0
    buffer_load_ushort v19, v3, s[16:19], 0 offen offset:1024
    buffer_load_ushort v20, v5, s[12:15], 0 offen offset:0
    buffer_load_ushort v21, v5, s[12:15], 0 offen offset:1024
    buffer_load_ushort v22, v5, s[16:19], 0 offen offset:0
    buffer_load_ushort v23, v5, s[16:19], 0 offen offset:1024
    s_waitcnt vmcnt(0)
    v_lshlrev_b32 v16, 16, v16
    v_lshlrev_b32 v17, 16, v17
    v_lshlrev_b32 v18, 16, v18
    v_lshlrev_b32 v19, 16, v19
    v_lshlrev_b32 v20, 16, v20
    v_lshlrev_b32 v21, 16, v21
    v_lshlrev_b32 v22, 16, v22
    v_lshlrev_b32 v23, 16, v23
    v_add_f32 v16, v16, v20
    v_add_f32 v17, v17, v21
    v_sub_f32 v18, v18, v22
    v_sub_f32 v19, v19, v23
    v_add_f32 v20, v16, v17
    v_add_f32 v21, v18, v19
    v_sub_f32 v22, v16, v17
    v_sub_f32 v23, v18, v19
    v_mul_f32 v20, 0x3e800000, v20
    v_mul_f32 v21, 0x3e800000, v21
    v_mul_f32 v22, 0x3e800000, v22
    v_mul_f32 v23, 0x3e800000, v23
    v_cvt_pk_bf16_f32 v16, v20, v21
    v_cvt_pk_bf16_f32 v17, v22, v23
    buffer_store_dword v16, v4, s[20:23], s31 offen sc1
    buffer_store_dword v17, v4, s[20:23], s32 offen sc1
    s_mov_b64 exec, -1
    s_branch adaLN_cond__spectral_gfnet__mixer_channel_mlp__prompt_kernel_sj4
adaLN_cond__spectral_gfnet__mixer_channel_mlp__prompt_kernel_filt3:
    s_getpc_b64 s[24:25]
adaLN_cond__spectral_gfnet__mixer_channel_mlp__prompt_kernel_pc9:
    s_sub_u32 s24, s24, adaLN_cond__spectral_gfnet__mixer_channel_mlp__prompt_kernel_pc9-adaLN_cond__spectral_gfnet__mixer_channel_mlp__prompt_kernel
    s_subb_u32 s25, s25, 0
    s_mov_b32 s26, code_end-adaLN_cond__spectral_gfnet__mixer_channel_mlp__prompt_kernel
    s_mov_b32 s27, 0x20000
    s_getreg_b32 s28, hwreg(HW_REG_HW_ID, 8, 3)
    s_lshl_b32 s28, s28, 2
    s_add_u32 s28, s28, s35
    s_lshl_b32 s28, s28, 10
    v_lshlrev_b32 v120, 4, v2
    buffer_load_dwordx4 v[124:127], v120, s[24:27], s28 offen
    s_and_b32 s30, s61, 1
    s_lshl_b32 s30, s30, 2
    s_add_u32 s30, s30, s35
    s_bfe_u32 s31, s61, 0x30001
    s_lshr_b32 s33, s61, 4
    s_lshl_b32 s34, s31, 3
    s_lshl_b32 s40, s33, 8
    s_add_u32 s34, s34, s40
    s_mul_i32 s34, s34, 1026
    s_lshl_b32 s40, s30, 7
    s_add_u32 s34, s34, s40
    v_and_b32 v3, 7, v2
    v_lshrrev_b32 v4, 3, v2
    v_mul_u32_u24 v5, 1026, v3
    v_and_b32 v7, 2, v5
    v_and_b32 v5, -4, v5
    v_lshl_add_u32 v5, v4, 4, v5
    s_bfe_u32 s40, s31, 0x10001
    s_lshl_b32 s40, s40, 8
    s_bfe_u32 s36, s31, 0x10002
    s_lshl_b32 s36, s36, 7
    s_add_u32 s40, s40, s36
    s_lshl_b32 s36, s33, 4
    s_add_u32 s40, s40, s36
    s_and_b32 s36, s31, 1
    s_lshl_b32 s36, s36, 3
    s_add_u32 s40, s40, s36
    s_lshl_b32 s40, s40, 4
    s_mul_i32 s36, s30, 524288
    s_add_u32 s40, s40, s36
    s_add_u32 s40, s40, 5242880
    v_mul_u32_u24 v6, 65536, v4
    v_lshl_add_u32 v6, v3, 4, v6
    s_mov_b32 s36, 0x05040100
    s_mov_b32 s37, 0x07060302
    s_waitcnt lgkmcnt(0)
    s_mov_b32 s20, s8
    s_mov_b32 s21, s9
    s_mov_b32 s22, 37748736
    s_mov_b32 s23, 0x20000
adaLN_cond__spectral_gfnet__mixer_channel_mlp__prompt_kernel_zz10:
    s_mov_b32 s12, s48
    s_mov_b32 s13, s49
    s_mov_b32 s14, 2101248
    s_mov_b32 s15, 0x20000
    s_mov_b32 s16, s50
    s_mov_b32 s17, s51
    s_mov_b32 s18, 2101248
    s_mov_b32 s19, 0x20000
    s_waitcnt vmcnt(0)
    buffer_load_dwordx4 v[8:11], v5, s[12:15], s34 offen
    buffer_load_dwordx4 v[32:35], v5, s[16:19], s34 offen
    buffer_load_dword v12, v5, s[12:15], s34 offen offset:16
    buffer_load_dword v36, v5, s[16:19], s34 offen offset:16
    s_add_u32 s34, s34, 65664
    buffer_load_dwordx4 v[14:17], v5, s[12:15], s34 offen
    buffer_load_dwordx4 v[38:41], v5, s[16:19], s34 offen
    buffer_load_dword v18, v5, s[12:15], s34 offen offset:16
    buffer_load_dword v42, v5, s[16:19], s34 offen offset:16
    s_add_u32 s34, s34, 65664
    buffer_load_dwordx4 v[20:23], v5, s[12:15], s34 offen
    buffer_load_dwordx4 v[44:47], v5, s[16:19], s34 offen
    buffer_load_dword v24, v5, s[12:15], s34 offen offset:16
    buffer_load_dword v48, v5, s[16:19], s34 offen offset:16
    s_add_u32 s34, s34, 65664
    buffer_load_dwordx4 v[26:29], v5, s[12:15], s34 offen
    buffer_load_dwordx4 v[50:53], v5, s[16:19], s34 offen
    buffer_load_dword v30, v5, s[12:15], s34 offen offset:16
    buffer_load_dword v54, v5, s[16:19], s34 offen offset:16
    s_add_u32 s34, s34, 65664
    s_barrier
    s_waitcnt vmcnt(12)
    v_alignbyte_b32 v8, v9, v8, v7
    v_alignbyte_b32 v9, v10, v9, v7
    v_alignbyte_b32 v10, v11, v10, v7
    v_alignbyte_b32 v11, v12, v11, v7
    v_alignbyte_b32 v32, v33, v32, v7
    v_alignbyte_b32 v33, v34, v33, v7
    v_alignbyte_b32 v34, v35, v34, v7
    v_alignbyte_b32 v35, v36, v35, v7
    s_waitcnt vmcnt(8)
    v_alignbyte_b32 v14, v15, v14, v7
    v_alignbyte_b32 v15, v16, v15, v7
    v_alignbyte_b32 v16, v17, v16, v7
    v_alignbyte_b32 v17, v18, v17, v7
    v_alignbyte_b32 v38, v39, v38, v7
    v_alignbyte_b32 v39, v40, v39, v7
    v_alignbyte_b32 v40, v41, v40, v7
    v_alignbyte_b32 v41, v42, v41, v7
    s_waitcnt vmcnt(4)
    v_alignbyte_b32 v20, v21, v20, v7
    v_alignbyte_b32 v21, v22, v21, v7
    v_alignbyte_b32 v22, v23, v22, v7
    v_alignbyte_b32 v23, v24, v23, v7
    v_alignbyte_b32 v44, v45, v44, v7
    v_alignbyte_b32 v45, v46, v45, v7
    v_alignbyte_b32 v46, v47, v46, v7
    v_alignbyte_b32 v47, v48, v47, v7
    s_waitcnt vmcnt(0)
    v_alignbyte_b32 v26, v27, v26, v7
    v_alignbyte_b32 v27, v28, v27, v7
    v_alignbyte_b32 v28, v29, v28, v7
    v_alignbyte_b32 v29, v30, v29, v7
    v_alignbyte_b32 v50, v51, v50, v7
    v_alignbyte_b32 v51, v52, v51, v7
    v_alignbyte_b32 v52, v53, v52, v7
    v_alignbyte_b32 v53, v54, v53, v7
    v_perm_b32 v56, v32, v8, s36
    v_perm_b32 v57, v38, v14, s36
    v_perm_b32 v58, v44, v20, s36
    v_perm_b32 v59, v50, v26, s36
    buffer_store_dwordx4 v[56:59], v6, s[20:23], s40 offen sc1
    s_add_u32 s40, s40, 8192
    v_perm_b32 v60, v32, v8, s37
    v_perm_b32 v61, v38, v14, s37
    v_perm_b32 v62, v44, v20, s37
    v_perm_b32 v63, v50, v26, s37
    buffer_store_dwordx4 v[60:63], v6, s[20:23], s40 offen sc1
    s_add_u32 s40, s40, 8192
    v_perm_b32 v64, v33, v9, s36
    v_perm_b32 v65, v39, v15, s36
    v_perm_b32 v66, v45, v21, s36
    v_perm_b32 v67, v51, v27, s36
    buffer_store_dwordx4 v[64:67], v6, s[20:23], s40 offen sc1
    s_add_u32 s40, s40, 8192
    v_perm_b32 v68, v33, v9, s37
    v_perm_b32 v69, v39, v15, s37
    v_perm_b32 v70, v45, v21, s37
    v_perm_b32 v71, v51, v27, s37
    buffer_store_dwordx4 v[68:71], v6, s[20:23], s40 offen sc1
    s_add_u32 s40, s40, 8192
    v_perm_b32 v72, v34, v10, s36
    v_perm_b32 v73, v40, v16, s36
    v_perm_b32 v74, v46, v22, s36
    v_perm_b32 v75, v52, v28, s36
    buffer_store_dwordx4 v[72:75], v6, s[20:23], s40 offen sc1
    s_add_u32 s40, s40, 8192
    v_perm_b32 v76, v34, v10, s37
    v_perm_b32 v77, v40, v16, s37
    v_perm_b32 v78, v46, v22, s37
    v_perm_b32 v79, v52, v28, s37
    buffer_store_dwordx4 v[76:79], v6, s[20:23], s40 offen sc1
    s_add_u32 s40, s40, 8192
    v_perm_b32 v80, v35, v11, s36
    v_perm_b32 v81, v41, v17, s36
    v_perm_b32 v82, v47, v23, s36
    v_perm_b32 v83, v53, v29, s36
    buffer_store_dwordx4 v[80:83], v6, s[20:23], s40 offen sc1
    s_add_u32 s40, s40, 8192
    v_perm_b32 v84, v35, v11, s37
    v_perm_b32 v85, v41, v17, s37
    v_perm_b32 v86, v47, v23, s37
    v_perm_b32 v87, v53, v29, s37
    buffer_store_dwordx4 v[84:87], v6, s[20:23], s40 offen sc1
    s_add_u32 s40, s40, 8192
adaLN_cond__spectral_gfnet__mixer_channel_mlp__prompt_kernel_sj4:
    v_lshlrev_b32 v121, 4, v2
    s_lshr_b32 s31, s58, 2
    s_add_u32 s31, s31, 32
    s_and_b32 s30, s58, 3
    s_lshl_b32 s32, s30, 2
    s_add_u32 s32, s32, s35
    s_mul_i32 s33, s32, 786432
    s_lshl_b32 s34, s31, 7
    s_add_u32 s33, s33, s34
    s_lshl_b32 s32, s32, 7
    s_mul_i32 s34, s30, 24576
    s_lshl_b32 s40, s31, 8
    s_add_u32 s34, s34, s40
    s_add_u32 s34, s34, 98304
    s_lshl_b32 s40, s58, 2
    s_add_u32 s40, s40, s35
    s_lshl_b32 s40, s40, 10
    s_mov_b32 s12, s46
    s_mov_b32 s13, s47
    s_mov_b32 s14, 12582912
    s_mov_b32 s15, 0x20000
    s_mov_b32 s16, s44
    s_mov_b32 s17, s45
    s_mov_b32 s18, 2048
    s_mov_b32 s19, 0x20000
    buffer_load_dwordx4 v[96:99], v101, s[16:19], s32 offen
    s_lshl_b32 s38, s35, 10
    s_getpc_b64 s[24:25]
adaLN_cond__spectral_gfnet__mixer_channel_mlp__prompt_kernel_pc11:
    s_add_u32 s24, s24, k2_tab-adaLN_cond__spectral_gfnet__mixer_channel_mlp__prompt_kernel_pc11
    s_addc_u32 s25, s25, 0
    s_mov_b32 s26, 18432
    s_mov_b32 s27, 0x20000
    s_add_u32 s39, s38, 0
    s_add_u32 m0, s39, 98304
    s_nop 0
    buffer_load_dwordx4 v121, s[24:27], s39 offen lds
    s_add_u32 s39, s38, 4096
    s_add_u32 m0, s39, 98304
    s_nop 0
    buffer_load_dwordx4 v121, s[24:27], s39 offen lds
    s_add_u32 s39, s38, 8192
    s_add_u32 m0, s39, 98304
    s_nop 0
    buffer_load_dwordx4 v121, s[24:27], s39 offen lds
    s_add_u32 s39, s38, 12288
    s_add_u32 m0, s39, 98304
    s_nop 0
    buffer_load_dwordx4 v121, s[24:27], s39 offen lds
    s_add_u32 s39, s38, 16384
    s_add_u32 m0, s39, 98304
    s_nop 0
    buffer_load_dwordx4 v121, s[24:27], s39 offen lds
    buffer_load_dwordx4 v[128:131], v100, s[12:15], s33 offen nt
    s_add_u32 s33, s33, 12288
    buffer_load_dwordx4 v[132:135], v100, s[12:15], s33 offen nt
    s_add_u32 s33, s33, 12288
    buffer_load_dwordx4 v[136:139], v100, s[12:15], s33 offen nt
    s_add_u32 s33, s33, 12288
    s_waitcnt vmcnt(2)
    buffer_load_dwordx4 v[140:143], v100, s[12:15], s33 offen nt
    s_add_u32 s33, s33, 12288
    s_waitcnt vmcnt(2)
    buffer_load_dwordx4 v[144:147], v100, s[12:15], s33 offen nt
    s_add_u32 s33, s33, 12288
    s_waitcnt vmcnt(2)
    buffer_load_dwordx4 v[148:151], v100, s[12:15], s33 offen nt
    s_add_u32 s33, s33, 12288
    s_mov_b32 s16, s4
    s_mov_b32 s17, s5
    s_mov_b32 s18, 7340032
    s_mov_b32 s19, 0x20000
    s_barrier
    s_getreg_b32 s69, hwreg(HW_REG_XCC_ID, 0, 4)
    s_and_b32 s69, s69, 7
    s_lshl_b32 s28, s69, 7
    s_add_u32 s28, s28, 589824
    s_cmp_eq_u32 s35, 2
    s_cselect_b32 s28, s28, 37748736
    v_mov_b32 v122, 1
    s_mov_b64 exec, 1
    buffer_atomic_add v122, off, s[20:23], s28 sc0 sc1
    s_mov_b64 exec, -1
    buffer_load_dwordx4 v[152:155], v100, s[12:15], s33 offen nt
    s_add_u32 s33, s33, 12288
    buffer_load_dwordx4 v[156:159], v100, s[12:15], s33 offen nt
    s_add_u32 s33, s33, 12288
    s_barrier
    s_waitcnt vmcnt(9)
    v_lshlrev_b32 v104, 16, v96
    v_and_b32 v105, 0xffff0000, v96
    v_lshlrev_b32 v106, 16, v97
    v_and_b32 v107, 0xffff0000, v97
    v_lshlrev_b32 v108, 16, v98
    v_and_b32 v109, 0xffff0000, v98
    v_lshlrev_b32 v110, 16, v99
    v_and_b32 v111, 0xffff0000, v99
    v_mul_f32 v160, 0xbfb8aa3b, v104
    v_mul_f32 v161, 0xbfb8aa3b, v105
    v_mul_f32 v162, 0xbfb8aa3b, v106
    v_mul_f32 v163, 0xbfb8aa3b, v107
    v_mul_f32 v164, 0xbfb8aa3b, v108
    v_mul_f32 v165, 0xbfb8aa3b, v109
    v_mul_f32 v166, 0xbfb8aa3b, v110
    v_mul_f32 v167, 0xbfb8aa3b, v111
    v_exp_f32 v160, v160
    v_exp_f32 v161, v161
    v_exp_f32 v162, v162
    v_exp_f32 v163, v163
    v_exp_f32 v164, v164
    v_exp_f32 v165, v165
    v_exp_f32 v166, v166
    v_exp_f32 v167, v167
    v_add_f32 v160, 1.0, v160
    v_add_f32 v161, 1.0, v161
    v_add_f32 v162, 1.0, v162
    v_add_f32 v163, 1.0, v163
    v_add_f32 v164, 1.0, v164
    v_add_f32 v165, 1.0, v165
    v_add_f32 v166, 1.0, v166
    v_add_f32 v167, 1.0, v167
    v_rcp_f32 v160, v160
    v_rcp_f32 v161, v161
    v_rcp_f32 v162, v162
    v_rcp_f32 v163, v163
    v_rcp_f32 v164, v164
    v_rcp_f32 v165, v165
    v_rcp_f32 v166, v166
    v_rcp_f32 v167, v167
    v_pk_mul_f32 v[104:105], v[104:105], v[160:161]
    v_pk_mul_f32 v[106:107], v[106:107], v[162:163]
    v_pk_mul_f32 v[108:109], v[108:109], v[164:165]
    v_pk_mul_f32 v[110:111], v[110:111], v[166:167]
    v_cvt_pk_bf16_f32 v160, v104, v105
    v_cvt_pk_bf16_f32 v162, v106, v107
    v_cvt_pk_bf16_f32 v164, v108, v109
    v_cvt_pk_bf16_f32 v166, v110, v111
    v_lshlrev_b32 v104, 16, v160
    v_and_b32 v105, 0xffff0000, v160
    v_lshlrev_b32 v106, 16, v162
    v_and_b32 v107, 0xffff0000, v162
    v_lshlrev_b32 v108, 16, v164
    v_and_b32 v109, 0xffff0000, v164
    v_lshlrev_b32 v110, 16, v166
    v_and_b32 v111, 0xffff0000, v166
    s_waitcnt vmcnt(8)
    v_lshlrev_b32 v160, 16, v128
    v_and_b32 v161, 0xffff0000, v128
    v_lshlrev_b32 v162, 16, v129
    v_and_b32 v163, 0xffff0000, v129
    v_lshlrev_b32 v164, 16, v130
    v_and_b32 v165, 0xffff0000, v130
    v_lshlrev_b32 v166, 16, v131
    v_and_b32 v167, 0xffff0000, v131
    v_pk_mul_f32 v[112:113], v[160:161], v[104:105] op_sel_hi:[1,0]
    v_pk_mul_f32 v[114:115], v[162:163], v[104:105] op_sel_hi:[1,0]
    v_pk_mul_f32 v[116:117], v[164:165], v[104:105] op_sel_hi:[1,0]
    v_pk_mul_f32 v[118:119], v[166:167], v[104:105] op_sel_hi:[1,0]
    s_waitcnt vmcnt(7)
    v_lshlrev_b32 v160, 16, v132
    v_and_b32 v161, 0xffff0000, v132
    v_lshlrev_b32 v162, 16, v133
    v_and_b32 v163, 0xffff0000, v133
    v_lshlrev_b32 v164, 16, v134
    v_and_b32 v165, 0xffff0000, v134
    v_lshlrev_b32 v166, 16, v135
    v_and_b32 v167, 0xffff0000, v135
    v_pk_fma_f32 v[112:113], v[160:161], v[104:105], v[112:113] op_sel:[0,1,0] op_sel_hi:[1,1,1]
    v_pk_fma_f32 v[114:115], v[162:163], v[104:105], v[114:115] op_sel:[0,1,0] op_sel_hi:[1,1,1]
    v_pk_fma_f32 v[116:117], v[164:165], v[104:105], v[116:117] op_sel:[0,1,0] op_sel_hi:[1,1,1]
    v_pk_fma_f32 v[118:119], v[166:167], v[104:105], v[118:119] op_sel:[0,1,0] op_sel_hi:[1,1,1]
    s_waitcnt vmcnt(6)
    v_lshlrev_b32 v160, 16, v136
    v_and_b32 v161, 0xffff0000, v136
    v_lshlrev_b32 v162, 16, v137
    v_and_b32 v163, 0xffff0000, v137
    v_lshlrev_b32 v164, 16, v138
    v_and_b32 v165, 0xffff0000, v138
    v_lshlrev_b32 v166, 16, v139
    v_and_b32 v167, 0xffff0000, v139
    v_pk_fma_f32 v[112:113], v[160:161], v[106:107], v[112:113] op_sel_hi:[1,0,1]
    v_pk_fma_f32 v[114:115], v[162:163], v[106:107], v[114:115] op_sel_hi:[1,0,1]
    v_pk_fma_f32 v[116:117], v[164:165], v[106:107], v[116:117] op_sel_hi:[1,0,1]
    v_pk_fma_f32 v[118:119], v[166:167], v[106:107], v[118:119] op_sel_hi:[1,0,1]
    s_waitcnt vmcnt(5)
    v_lshlrev_b32 v160, 16, v140
    v_and_b32 v161, 0xffff0000, v140
    v_lshlrev_b32 v162, 16, v141
    v_and_b32 v163, 0xffff0000, v141
    v_lshlrev_b32 v164, 16, v142
    v_and_b32 v165, 0xffff0000, v142
    v_lshlrev_b32 v166, 16, v143
    v_and_b32 v167, 0xffff0000, v143
    v_pk_fma_f32 v[112:113], v[160:161], v[106:107], v[112:113] op_sel:[0,1,0] op_sel_hi:[1,1,1]
    v_pk_fma_f32 v[114:115], v[162:163], v[106:107], v[114:115] op_sel:[0,1,0] op_sel_hi:[1,1,1]
    v_pk_fma_f32 v[116:117], v[164:165], v[106:107], v[116:117] op_sel:[0,1,0] op_sel_hi:[1,1,1]
    v_pk_fma_f32 v[118:119], v[166:167], v[106:107], v[118:119] op_sel:[0,1,0] op_sel_hi:[1,1,1]
    s_waitcnt vmcnt(4)
    v_lshlrev_b32 v160, 16, v144
    v_and_b32 v161, 0xffff0000, v144
    v_lshlrev_b32 v162, 16, v145
    v_and_b32 v163, 0xffff0000, v145
    v_lshlrev_b32 v164, 16, v146
    v_and_b32 v165, 0xffff0000, v146
    v_lshlrev_b32 v166, 16, v147
    v_and_b32 v167, 0xffff0000, v147
    v_pk_fma_f32 v[112:113], v[160:161], v[108:109], v[112:113] op_sel_hi:[1,0,1]
    v_pk_fma_f32 v[114:115], v[162:163], v[108:109], v[114:115] op_sel_hi:[1,0,1]
    v_pk_fma_f32 v[116:117], v[164:165], v[108:109], v[116:117] op_sel_hi:[1,0,1]
    v_pk_fma_f32 v[118:119], v[166:167], v[108:109], v[118:119] op_sel_hi:[1,0,1]
    s_waitcnt vmcnt(3)
    v_lshlrev_b32 v160, 16, v148
    v_and_b32 v161, 0xffff0000, v148
    v_lshlrev_b32 v162, 16, v149
    v_and_b32 v163, 0xffff0000, v149
    v_lshlrev_b32 v164, 16, v150
    v_and_b32 v165, 0xffff0000, v150
    v_lshlrev_b32 v166, 16, v151
    v_and_b32 v167, 0xffff0000, v151
    v_pk_fma_f32 v[112:113], v[160:161], v[108:109], v[112:113] op_sel:[0,1,0] op_sel_hi:[1,1,1]
    v_pk_fma_f32 v[114:115], v[162:163], v[108:109], v[114:115] op_sel:[0,1,0] op_sel_hi:[1,1,1]
    v_pk_fma_f32 v[116:117], v[164:165], v[108:109], v[116:117] op_sel:[0,1,0] op_sel_hi:[1,1,1]
    v_pk_fma_f32 v[118:119], v[166:167], v[108:109], v[118:119] op_sel:[0,1,0] op_sel_hi:[1,1,1]
    s_waitcnt vmcnt(2)
    s_cmp_lg_u32 s35, 2
    s_cbranch_scc1 adaLN_cond__spectral_gfnet__mixer_channel_mlp__prompt_kernel_tk12
    v_lshl_or_b32 v122, s69, 16, v122
    v_mov_b32 v123, 93184
    s_mov_b64 exec, 1
    ds_write_b32 v123, v122
    s_mov_b64 exec, -1
    s_waitcnt lgkmcnt(0)
adaLN_cond__spectral_gfnet__mixer_channel_mlp__prompt_kernel_tk12:
    s_barrier
    buffer_load_dwordx4 v[92:95], v121, s[16:19], s40 offen
    s_add_u32 s40, s40, 1048576
    buffer_load_dwordx4 v[92:95], v121, s[16:19], s40 offen
    s_add_u32 s40, s40, 1048576
    buffer_load_dwordx4 v[92:95], v121, s[16:19], s40 offen
    s_add_u32 s40, s40, 1048576
    s_waitcnt vmcnt(4)
    v_lshlrev_b32 v160, 16, v152
    v_and_b32 v161, 0xffff0000, v152
    v_lshlrev_b32 v162, 16, v153
    v_and_b32 v163, 0xffff0000, v153
    v_lshlrev_b32 v164, 16, v154
    v_and_b32 v165, 0xffff0000, v154
    v_lshlrev_b32 v166, 16, v155
    v_and_b32 v167, 0xffff0000, v155
    v_pk_fma_f32 v[112:113], v[160:161], v[110:111], v[112:113] op_sel_hi:[1,0,1]
    v_pk_fma_f32 v[114:115], v[162:163], v[110:111], v[114:115] op_sel_hi:[1,0,1]
    v_pk_fma_f32 v[116:117], v[164:165], v[110:111], v[116:117] op_sel_hi:[1,0,1]
    v_pk_fma_f32 v[118:119], v[166:167], v[110:111], v[118:119] op_sel_hi:[1,0,1]
    s_waitcnt vmcnt(3)
    v_lshlrev_b32 v160, 16, v156
    v_and_b32 v161, 0xffff0000, v156
    v_lshlrev_b32 v162, 16, v157
    v_and_b32 v163, 0xffff0000, v157
    v_lshlrev_b32 v164, 16, v158
    v_and_b32 v165, 0xffff0000, v158
    v_lshlrev_b32 v166, 16, v159
    v_and_b32 v167, 0xffff0000, v159
    v_pk_fma_f32 v[112:113], v[160:161], v[110:111], v[112:113] op_sel:[0,1,0] op_sel_hi:[1,1,1]
    v_pk_fma_f32 v[114:115], v[162:163], v[110:111], v[114:115] op_sel:[0,1,0] op_sel_hi:[1,1,1]
    v_pk_fma_f32 v[116:117], v[164:165], v[110:111], v[116:117] op_sel:[0,1,0] op_sel_hi:[1,1,1]
    v_pk_fma_f32 v[118:119], v[166:167], v[110:111], v[118:119] op_sel:[0,1,0] op_sel_hi:[1,1,1]
    s_lshl_b32 s39, s58, 7
    s_add_u32 s37, s39, 524288
    v_lshlrev_b32 v176, 2, v2
    s_barrier
    v_permlane32_swap_b32 v112, v116
    v_permlane32_swap_b32 v113, v117
    v_permlane32_swap_b32 v114, v118
    v_permlane32_swap_b32 v115, v119
    v_pk_add_f32 v[112:113], v[112:113], v[116:117]
    v_pk_add_f32 v[114:115], v[114:115], v[118:119]
    s_nop 1
    v_permlane16_swap_b32 v112, v114
    v_permlane16_swap_b32 v113, v115
    v_pk_add_f32 v[112:113], v[112:113], v[114:115]
    s_nop 1
    v_add_f32_dpp v112, v112, v112 row_ror:8 row_mask:0xf bank_mask:0xf
    v_add_f32_dpp v113, v113, v113 row_ror:8 row_mask:0xf bank_mask:0xf
    v_and_b32 v14, 7, v2
    v_lshlrev_b32 v14, 5, v14
    v_lshrrev_b32 v15, 4, v2
    v_lshl_add_u32 v14, v15, 3, v14
    s_lshl_b32 s38, s35, 8
    s_add_u32 s38, s38, 92160
    v_add_u32 v14, s38, v14
    ds_write_b64 v14, v[112:113]
    s_waitcnt lgkmcnt(0)
    s_barrier
    s_cmp_lg_u32 s35, 0
    s_cbranch_scc1 adaLN_cond__spectral_gfnet__mixer_channel_mlp__prompt_kernel_w713
    v_lshlrev_b32 v20, 2, v2
    v_add_u32 v20, 92160, v20
    ds_read2st64_b32 v[16:17], v20 offset0:0 offset1:1
    ds_read2st64_b32 v[18:19], v20 offset0:2 offset1:3
    s_waitcnt lgkmcnt(0)
    v_pk_add_f32 v[16:17], v[16:17], v[18:19]
    v_add_f32 v16, v16, v17
    buffer_store_dword v16, v176, s[20:23], s34 offen sc1
adaLN_cond__spectral_gfnet__mixer_channel_mlp__prompt_kernel_w713:
    v_mov_b32 v10, 93184
    ds_read_b32 v11, v10
    s_waitcnt lgkmcnt(0)
    v_readfirstlane_b32 s62, v11
    s_nop 0
    s_lshr_b32 s63, s62, 16
    s_and_b32 s62, s62, 0xffff
    s_lshl_b32 s65, s63, 5
    s_add_u32 s65, s65, s62
    s_cmp_lt_u32 s62, 32
    s_cbranch_scc1 adaLN_cond__spectral_gfnet__mixer_channel_mlp__prompt_kernel_rok14
    s_mov_b32 s68, s62
    v_lshlrev_b32 v10, 7, v2
    s_mov_b32 s62, 589824
    buffer_load_dword v11, v10, s[20:23], s62 offen sc1
    s_waitcnt vmcnt(0)
    s_sub_u32 s68, s68, 32
    v_readlane_b32 s62, v11, 0
    s_nop 0
    s_max_u32 s62, s62, 32
    s_sub_u32 s62, s62, 32
    s_cmp_gt_u32 s63, 0
    s_cselect_b32 s62, s62, 0
    s_add_u32 s68, s68, s62
    v_readlane_b32 s62, v11, 1
    s_nop 0
    s_max_u32 s62, s62, 32
    s_sub_u32 s62, s62, 32
    s_cmp_gt_u32 s63, 1
    s_cselect_b32 s62, s62, 0
    s_add_u32 s68, s68, s62
    v_readlane_b32 s62, v11, 2
    s_nop 0
    s_max_u32 s62, s62, 32
    s_sub_u32 s62, s62, 32
    s_cmp_gt_u32 s63, 2
    s_cselect_b32 s62, s62, 0
    s_add_u32 s68, s68, s62
    v_readlane_b32 s62, v11, 3
    s_nop 0
    s_max_u32 s62, s62, 32
    s_sub_u32 s62, s62, 32
    s_cmp_gt_u32 s63, 3
    s_cselect_b32 s62, s62, 0
    s_add_u32 s68, s68, s62
    v_readlane_b32 s62, v11, 4
    s_nop 0
    s_max_u32 s62, s62, 32
    s_sub_u32 s62, s62, 32
    s_cmp_gt_u32 s63, 4
    s_cselect_b32 s62, s62, 0
    s_add_u32 s68, s68, s62
    v_readlane_b32 s62, v11, 5
    s_nop 0
    s_max_u32 s62, s62, 32
    s_sub_u32 s62, s62, 32
    s_cmp_gt_u32 s63, 5
    s_cselect_b32 s62, s62, 0
    s_add_u32 s68, s68, s62
    v_readlane_b32 s62, v11, 6
    s_nop 0
    s_max_u32 s62, s62, 32
    s_sub_u32 s62, s62, 32
    s_cmp_gt_u32 s63, 6
    s_cselect_b32 s62, s62, 0
    s_add_u32 s68, s68, s62
    s_mov_b32 s65, 0
    v_readlane_b32 s62, v11, 0
    s_nop 0
    s_min_u32 s62, s62, 32
    s_add_u32 s63, s62, s68
    s_add_u32 s64, s63, 0
    s_cmp_lt_u32 s63, 32
    s_cselect_b32 s65, s64, s65
    s_cselect_b32 s63, 0x10000, s63
    s_sub_u32 s68, s63, 32
    v_readlane_b32 s62, v11, 1
    s_nop 0
    s_min_u32 s62, s62, 32
    s_add_u32 s63, s62, s68
    s_add_u32 s64, s63, 32
    s_cmp_lt_u32 s63, 32
    s_cselect_b32 s65, s64, s65
    s_cselect_b32 s63, 0x10000, s63
    s_sub_u32 s68, s63, 32
    v_readlane_b32 s62, v11, 2
    s_nop 0
    s_min_u32 s62, s62, 32
    s_add_u32 s63, s62, s68
    s_add_u32 s64, s63, 64
    s_cmp_lt_u32 s63, 32
    s_cselect_b32 s65, s64, s65
    s_cselect_b32 s63, 0x10000, s63
    s_sub_u32 s68, s63, 32
    v_readlane_b32 s62, v11, 3
    s_nop 0
    s_min_u32 s62, s62, 32
    s_add_u32 s63, s62, s68
    s_add_u32 s64, s63, 96
    s_cmp_lt_u32 s63, 32
    s_cselect_b32 s65, s64, s65
    s_cselect_b32 s63, 0x10000, s63
    s_sub_u32 s68, s63, 32
    v_readlane_b32 s62, v11, 4
    s_nop 0
    s_min_u32 s62, s62, 32
    s_add_u32 s63, s62, s68
    s_add_u32 s64, s63, 128
    s_cmp_lt_u32 s63, 32
    s_cselect_b32 s65, s64, s65
    s_cselect_b32 s63, 0x10000, s63
    s_sub_u32 s68, s63, 32
    v_readlane_b32 s62, v11, 5
    s_nop 0
    s_min_u32 s62, s62, 32
    s_add_u32 s63, s62, s68
    s_add_u32 s64, s63, 160
    s_cmp_lt_u32 s63, 32
    s_cselect_b32 s65, s64, s65
    s_cselect_b32 s63, 0x10000, s63
    s_sub_u32 s68, s63, 32
    v_readlane_b32 s62, v11, 6
    s_nop 0
    s_min_u32 s62, s62, 32
    s_add_u32 s63, s62, s68
    s_add_u32 s64, s63, 192
    s_cmp_lt_u32 s63, 32
    s_cselect_b32 s65, s64, s65
    s_cselect_b32 s63, 0x10000, s63
    s_sub_u32 s68, s63, 32
    v_readlane_b32 s62, v11, 7
    s_nop 0
    s_min_u32 s62, s62, 32
    s_add_u32 s63, s62, s68
    s_add_u32 s64, s63, 224
    s_cmp_lt_u32 s63, 32
    s_cselect_b32 s65, s64, s65
    s_cselect_b32 s63, 0x10000, s63
    s_sub_u32 s68, s63, 32
adaLN_cond__spectral_gfnet__mixer_channel_mlp__prompt_kernel_rok14:
    s_bfe_u32 s59, s65, 0x10005
    s_lshl_b32 s59, s59, 3
    s_and_b32 s58, s65, 7
    s_add_u32 s59, s59, s58
    s_lshr_b32 s60, s65, 6
    s_lshl_b32 s60, s60, 2
    s_bfe_u32 s58, s65, 0x20003
    s_add_u32 s60, s60, s58
    s_lshl_b32 s58, s59, 4
    s_add_u32 s58, s58, s60
    s_lshl_b32 s38, s35, 10
    s_getpc_b64 s[24:25]
adaLN_cond__spectral_gfnet__mixer_channel_mlp__prompt_kernel_pc15:
    s_add_u32 s24, s24, k3_tab-adaLN_cond__spectral_gfnet__mixer_channel_mlp__prompt_kernel_pc15
    s_addc_u32 s25, s25, 0
    s_mov_b32 s26, 14336
    s_mov_b32 s27, 0x20000
    s_add_u32 s39, s38, 0
    s_add_u32 m0, s39, 0
    s_nop 0
    buffer_load_dwordx4 v121, s[24:27], s39 offen lds
    s_add_u32 s39, s38, 4096
    s_add_u32 m0, s39, 0
    s_nop 0
    buffer_load_dwordx4 v121, s[24:27], s39 offen lds
    s_add_u32 s39, s38, 8192
    s_add_u32 m0, s39, 0
    s_nop 0
    buffer_load_dwordx4 v121, s[24:27], s39 offen lds
    s_add_u32 s39, s38, 12288
    s_add_u32 m0, s39, 0
    s_nop 0
    buffer_load_dwordx4 v121, s[24:27], s39 offen lds
    s_getpc_b64 s[24:25]
adaLN_cond__spectral_gfnet__mixer_channel_mlp__prompt_kernel_pc16:
    s_sub_u32 s24, s24, adaLN_cond__spectral_gfnet__mixer_channel_mlp__prompt_kernel_pc16-adaLN_cond__spectral_gfnet__mixer_channel_mlp__prompt_kernel
    s_subb_u32 s25, s25, 0
    s_mov_b32 s26, code_end-adaLN_cond__spectral_gfnet__mixer_channel_mlp__prompt_kernel
    s_mov_b32 s27, 0x20000
    s_getreg_b32 s28, hwreg(HW_REG_HW_ID, 8, 3)
    s_lshl_b32 s28, s28, 2
    s_add_u32 s28, s28, s35
    s_lshl_b32 s28, s28, 10
    s_add_u32 s28, s28, 4096
    v_lshlrev_b32 v120, 4, v2
    buffer_load_dwordx4 v[124:127], v120, s[24:27], s28 offen
    buffer_load_dwordx4 v[92:95], v121, s[16:19], s40 offen
    s_add_u32 s40, s40, 1048576
    buffer_load_dwordx4 v[92:95], v121, s[16:19], s40 offen
    s_add_u32 s40, s40, 1048576
    buffer_load_dwordx4 v[92:95], v121, s[16:19], s40 offen
    s_add_u32 s40, s40, 1048576
    s_cmp_lg_u32 s58, 0
    s_cbranch_scc1 adaLN_cond__spectral_gfnet__mixer_channel_mlp__prompt_kernel_bx17
    s_barrier
adaLN_cond__spectral_gfnet__mixer_channel_mlp__prompt_kernel_bx17:
    s_barrier
    s_cmp_lg_u32 s35, 0
    s_cbranch_scc1 adaLN_cond__spectral_gfnet__mixer_channel_mlp__prompt_kernel_w818
    v_mov_b32 v11, 1
    s_mov_b64 exec, 1
    s_waitcnt vmcnt(8)
    buffer_store_dword v11, off, s[20:23], s37 sc1
    s_mov_b64 exec, -1
adaLN_cond__spectral_gfnet__mixer_channel_mlp__prompt_kernel_w818:
    s_mov_b32 s61, s40
    v_and_b32 v6, 15, v2
    v_lshrrev_b32 v7, 4, v2
    s_sub_u32 s35, s3, 4
    s_and_b32 s36, s35, 1
    s_lshl_b32 s36, s36, 2
    v_add_u32 v3, s36, v7
    v_and_b32 v4, 7, v2
    v_xor_b32 v3, v3, v4
    v_lshlrev_b32 v3, 4, v3
    v_lshrrev_b32 v4, 3, v2
    v_lshl_add_u32 v3, v4, 11, v3
    s_lshl_b32 s36, s35, 14
    v_add_u32 v8, s36, v3
    v_add_u32 v9, 65536, v8
    v_add_u32 v10, 131072, v8
    v_add_u32 v11, 196608, v8
    v_and_b32 v3, 1, v7
    v_lshlrev_b32 v3, 1, v3
    v_and_b32 v4, 3, v2
    v_xor_b32 v3, v3, v4
    v_lshlrev_b32 v3, 4, v3
    v_lshrrev_b32 v4, 2, v2
    v_mul_u32_u24 v4, 7168, v4
    v_add_u32 v3, v3, v4
    s_mul_i32 s36, s35, 114688
    v_add_u32 v12, s36, v3
    s_lshl_b32 s40, s59, 18
    s_add_u32 s40, s40, 25165824
    s_mul_i32 s41, s60, 448
    s_lshl_b32 s42, s35, 10
    s_add_u32 s43, s42, 49152
    s_mov_b32 s16, s4
    s_mov_b32 s17, s5
    s_mov_b32 s18, 7340032
    s_mov_b32 s19, 0x20000
    v_lshlrev_b32 v13, 4, v0
    v_add_u32 v13, 0xfffff000, v13
    v_and_b32 v15, 511, v13
    s_lshl_b32 s66, s58, 2
    s_add_u32 s66, s66, s35
    s_mul_i32 s66, s66, 7168
    s_add_u32 s66, s66, s52
    s_addc_u32 s67, s53, 0
    s_mov_b32 s12, s52
    s_mov_b32 s13, s53
    s_mov_b32 s14, 7340032
    s_mov_b32 s15, 0x20000
    s_sub_u32 s69, s66, s52
    v_lshlrev_b32 v14, 4, v2
    v_and_b32 v14, 511, v14
    s_lshl_b32 s63, s58, 2
    s_add_u32 s63, s63, s35
    s_lshl_b32 s63, s63, 12
    s_add_u32 s63, s63, 29360128
    v_mov_b32 v16, -1
    v_mov_b32 v17, -1
    v_mov_b32 v18, -1
    v_mov_b32 v19, -1
    v_lshlrev_b32 v24, 4, v2
    s_mov_b32 s49, 0
    buffer_store_dwordx4 v[16:19], v24, s[20:23], s63 offen offset:0 sc1
    buffer_store_dwordx4 v[16:19], v24, s[20:23], s63 offen offset:1024 sc1
    buffer_store_dwordx4 v[16:19], v24, s[20:23], s63 offen offset:2048 sc1
    buffer_store_dwordx4 v[16:19], v24, s[20:23], s63 offen offset:3072 sc1
    s_lshl_b32 s44, s35, 4
    v_lshl_add_u32 v26, v7, 6, v6
    v_add_u32 v26, s44, v26
    s_and_b32 s44, s60, 7
    s_lshl_b32 s44, s44, 3
    s_add_u32 s44, s44, 192
    v_and_b32 v27, 7, v2
    v_add_u32 v27, s44, v27
    v_cmp_lt_u32 vcc, 47, v2
    s_nop 1
    v_cndmask_b32 v26, v26, v27, vcc
    v_lshlrev_b32 v26, 7, v26
    s_mov_b32 s64, 0
    s_mov_b32 s44, 524288
    s_barrier
    s_barrier
adaLN_cond__spectral_gfnet__mixer_channel_mlp__prompt_kernel_gp19:
    buffer_load_dword v28, v26, s[20:23], s44 offen sc1
    s_add_u32 s64, s64, 1
    s_waitcnt vmcnt(0)
    v_cmp_eq_u32 vcc, 0, v28
    s_cmp_ge_u32 s64, 100000
    s_cbranch_scc1 adaLN_cond__spectral_gfnet__mixer_channel_mlp__prompt_kernel_ge20
    s_nop 2
    s_cbranch_vccnz adaLN_cond__spectral_gfnet__mixer_channel_mlp__prompt_kernel_gp19
adaLN_cond__spectral_gfnet__mixer_channel_mlp__prompt_kernel_ge20:
    s_mov_b32 s44, 106496
    buffer_load_dwordx4 v[32:35], v13, s[20:23], s44 offen sc1
    s_mov_b32 s44, 131072
    buffer_load_dwordx4 v[36:39], v13, s[20:23], s44 offen sc1
    s_mov_b32 s44, 155648
    buffer_load_dwordx4 v[40:43], v13, s[20:23], s44 offen sc1
    s_mov_b32 s44, 180224
    buffer_load_dwordx4 v[44:47], v13, s[20:23], s44 offen sc1
    s_mov_b32 s44, 110592
    buffer_load_dwordx4 v[48:51], v13, s[20:23], s44 offen sc1
    s_mov_b32 s44, 135168
    buffer_load_dwordx4 v[52:55], v13, s[20:23], s44 offen sc1
    s_mov_b32 s44, 159744
    buffer_load_dwordx4 v[56:59], v13, s[20:23], s44 offen sc1
    s_mov_b32 s44, 184320
    buffer_load_dwordx4 v[60:63], v13, s[20:23], s44 offen sc1
    s_mov_b32 s44, 114688
    buffer_load_dwordx4 v[64:67], v13, s[20:23], s44 offen sc1
    s_mov_b32 s44, 139264
    buffer_load_dwordx4 v[68:71], v13, s[20:23], s44 offen sc1
    s_mov_b32 s44, 163840
    buffer_load_dwordx4 v[72:75], v13, s[20:23], s44 offen sc1
    s_mov_b32 s44, 188416
    buffer_load_dwordx4 v[76:79], v13, s[20:23], s44 offen sc1
    s_and_b32 s45, s60, 7
    s_lshl_b32 s45, s45, 9
    s_add_u32 s44, s45, 118784
    buffer_load_dwordx4 v[80:83], v15, s[20:23], s44 offen sc1
    s_add_u32 s44, s45, 143360
    buffer_load_dwordx4 v[84:87], v15, s[20:23], s44 offen sc1
    s_add_u32 s44, s45, 167936
    buffer_load_dwordx4 v[88:91], v15, s[20:23], s44 offen sc1
    s_add_u32 s44, s45, 192512
    buffer_load_dwordx4 v[92:95], v15, s[20:23], s44 offen sc1
    s_barrier
    s_waitcnt vmcnt(12)
    v_pk_add_f32 v[32:33], v[32:33], v[36:37]
    v_pk_add_f32 v[34:35], v[34:35], v[38:39]
    v_pk_add_f32 v[40:41], v[40:41], v[44:45]
    v_pk_add_f32 v[42:43], v[42:43], v[46:47]
    v_pk_add_f32 v[32:33], v[32:33], v[40:41]
    v_pk_add_f32 v[34:35], v[34:35], v[42:43]
    v_cvt_pk_bf16_f32 v36, v32, v33
    v_cvt_pk_bf16_f32 v38, v34, v35
    v_lshlrev_b32 v32, 16, v36
    v_and_b32 v33, 0xffff0000, v36
    v_lshlrev_b32 v34, 16, v38
    v_and_b32 v35, 0xffff0000, v38
    ds_write_b128 v13, v[32:35] offset:16384
    s_waitcnt vmcnt(8)
    v_pk_add_f32 v[48:49], v[48:49], v[52:53]
    v_pk_add_f32 v[50:51], v[50:51], v[54:55]
    v_pk_add_f32 v[56:57], v[56:57], v[60:61]
    v_pk_add_f32 v[58:59], v[58:59], v[62:63]
    v_pk_add_f32 v[48:49], v[48:49], v[56:57]
    v_pk_add_f32 v[50:51], v[50:51], v[58:59]
    v_cvt_pk_bf16_f32 v52, v48, v49
    v_cvt_pk_bf16_f32 v54, v50, v51
    v_lshlrev_b32 v48, 16, v52
    v_and_b32 v49, 0xffff0000, v52
    v_lshlrev_b32 v50, 16, v54
    v_and_b32 v51, 0xffff0000, v54
    ds_write_b128 v13, v[48:51] offset:24576
    s_waitcnt vmcnt(4)
    v_pk_add_f32 v[64:65], v[64:65], v[68:69]
    v_pk_add_f32 v[66:67], v[66:67], v[70:71]
    v_pk_add_f32 v[72:73], v[72:73], v[76:77]
    v_pk_add_f32 v[74:75], v[74:75], v[78:79]
    v_pk_add_f32 v[64:65], v[64:65], v[72:73]
    v_pk_add_f32 v[66:67], v[66:67], v[74:75]
    v_cvt_pk_bf16_f32 v68, v64, v65
    v_cvt_pk_bf16_f32 v70, v66, v67
    v_lshlrev_b32 v64, 16, v68
    v_and_b32 v65, 0xffff0000, v68
    v_lshlrev_b32 v66, 16, v70
    v_and_b32 v67, 0xffff0000, v70
    v_pk_add_f32 v[64:65], v[64:65], 1.0 op_sel_hi:[1,0]
    v_pk_add_f32 v[66:67], v[66:67], 1.0 op_sel_hi:[1,0]
    v_cvt_pk_bf16_f32 v68, v64, v65
    v_cvt_pk_bf16_f32 v70, v66, v67
    v_lshlrev_b32 v64, 16, v68
    v_and_b32 v65, 0xffff0000, v68
    v_lshlrev_b32 v66, 16, v70
    v_and_b32 v67, 0xffff0000, v70
    ds_write_b128 v13, v[64:67] offset:20480
    s_waitcnt vmcnt(0)
    v_pk_add_f32 v[80:81], v[80:81], v[84:85]
    v_pk_add_f32 v[82:83], v[82:83], v[86:87]
    v_pk_add_f32 v[88:89], v[88:89], v[92:93]
    v_pk_add_f32 v[90:91], v[90:91], v[94:95]
    v_pk_add_f32 v[80:81], v[80:81], v[88:89]
    v_pk_add_f32 v[82:83], v[82:83], v[90:91]
    v_cvt_pk_bf16_f32 v84, v80, v81
    v_cvt_pk_bf16_f32 v86, v82, v83
    v_lshlrev_b32 v80, 16, v84
    v_and_b32 v81, 0xffff0000, v84
    v_lshlrev_b32 v82, 16, v86
    v_and_b32 v83, 0xffff0000, v86
    s_lshl_b32 s45, s58, 9
    s_add_u32 s45, s45, 655360
    s_waitcnt lgkmcnt(0)
    s_barrier
    buffer_store_dwordx4 v[80:83], v15, s[20:23], s45 offen sc1
    s_add_u32 m0, s43, 0
    s_nop 0
    buffer_load_dwordx4 v12, s[16:19], s41 offen offset:0  lds
    s_add_u32 m0, s43, 4032
    s_nop 0
    buffer_load_dwordx4 v12, s[16:19], s41 offen offset:64  lds
    s_add_u32 m0, s43, 8064
    s_nop 0
    buffer_load_dwordx4 v12, s[16:19], s41 offen offset:128  lds
    s_add_u32 m0, s43, 12096
    s_nop 0
    buffer_load_dwordx4 v12, s[16:19], s41 offen offset:192  lds
    s_add_u32 m0, s43, 16128
    s_nop 0
    buffer_load_dwordx4 v12, s[16:19], s41 offen offset:256  lds
    s_add_u32 m0, s43, 20160
    s_nop 0
    buffer_load_dwordx4 v12, s[16:19], s41 offen offset:320  lds
    s_add_u32 m0, s43, 24192
    s_nop 0
    buffer_load_dwordx4 v12, s[16:19], s41 offen offset:384  lds
    s_add_u32 s41, s41, 458752
    s_add_u32 s43, s43, 28672
    s_cmp_ge_u32 s43, 135168
    s_cselect_b32 s44, 86016, 0
    s_sub_u32 s43, s43, s44
    s_add_u32 m0, s43, 0
    s_nop 0
    buffer_load_dwordx4 v12, s[16:19], s41 offen offset:0  lds
    s_add_u32 m0, s43, 4032
    s_nop 0
    buffer_load_dwordx4 v12, s[16:19], s41 offen offset:64  lds
    s_add_u32 m0, s43, 8064
    s_nop 0
    buffer_load_dwordx4 v12, s[16:19], s41 offen offset:128  lds
    s_add_u32 m0, s43, 12096
    s_nop 0
    buffer_load_dwordx4 v12, s[16:19], s41 offen offset:192  lds
    s_add_u32 m0, s43, 16128
    s_nop 0
    buffer_load_dwordx4 v12, s[16:19], s41 offen offset:256  lds
    s_add_u32 m0, s43, 20160
    s_nop 0
    buffer_load_dwordx4 v12, s[16:19], s41 offen offset:320  lds
    s_add_u32 m0, s43, 24192
    s_nop 0
    buffer_load_dwordx4 v12, s[16:19], s41 offen offset:384  lds
    s_add_u32 s41, s41, 458752
    s_add_u32 s43, s43, 28672
    s_cmp_ge_u32 s43, 135168
    s_cselect_b32 s44, 86016, 0
    s_sub_u32 s43, s43, s44
    s_add_u32 m0, s43, 0
    s_nop 0
    buffer_load_dwordx4 v12, s[16:19], s41 offen offset:0  lds
    s_add_u32 m0, s43, 4032
    s_nop 0
    buffer_load_dwordx4 v12, s[16:19], s41 offen offset:64  lds
    s_add_u32 m0, s43, 8064
    s_nop 0
    buffer_load_dwordx4 v12, s[16:19], s41 offen offset:128  lds
    s_add_u32 m0, s43, 12096
    s_nop 0
    buffer_load_dwordx4 v12, s[16:19], s41 offen offset:192  lds
    s_add_u32 m0, s43, 16128
    s_nop 0
    buffer_load_dwordx4 v12, s[16:19], s41 offen offset:256  lds
    s_add_u32 m0, s43, 20160
    s_nop 0
    buffer_load_dwordx4 v12, s[16:19], s41 offen offset:320  lds
    s_add_u32 m0, s43, 24192
    s_nop 0
    buffer_load_dwordx4 v12, s[16:19], s41 offen offset:384  lds
    s_add_u32 s41, s41, 458752
    s_add_u32 s43, s43, 28672
    s_cmp_ge_u32 s43, 135168
    s_cselect_b32 s44, 86016, 0
    s_sub_u32 s43, s43, s44
    buffer_load_dwordx4 v[28:31], v24, s[16:19], s61 offen
    s_add_u32 s61, s61, 1048576
    s_barrier
    s_setprio 3
    s_add_u32 m0, s42, 0
    s_nop 0
    buffer_load_dwordx4 v8, s[20:23], s40 offen sc1 lds
    s_add_u32 m0, s42, 4096
    s_nop 0
    buffer_load_dwordx4 v9, s[20:23], s40 offen sc1 lds
    s_add_u32 m0, s42, 8192
    s_nop 0
    buffer_load_dwordx4 v10, s[20:23], s40 offen sc1 lds
    s_add_u32 m0, s42, 12288
    s_nop 0
    buffer_load_dwordx4 v11, s[20:23], s40 offen sc1 lds
    s_add_u32 s40, s40, 128
    s_add_u32 s42, s42, 16384
    s_cmp_ge_u32 s42, 49152
    s_cselect_b32 s44, 49152, 0
    s_sub_u32 s42, s42, s44
    s_add_u32 m0, s42, 0
    s_nop 0
    buffer_load_dwordx4 v8, s[20:23], s40 offen sc1 lds
    s_add_u32 m0, s42, 4096
    s_nop 0
    buffer_load_dwordx4 v9, s[20:23], s40 offen sc1 lds
    s_add_u32 m0, s42, 8192
    s_nop 0
    buffer_load_dwordx4 v10, s[20:23], s40 offen sc1 lds
    s_add_u32 m0, s42, 12288
    s_nop 0
    buffer_load_dwordx4 v11, s[20:23], s40 offen sc1 lds
    s_add_u32 s40, s40, 128
    s_add_u32 s42, s42, 16384
    s_cmp_ge_u32 s42, 49152
    s_cselect_b32 s44, 49152, 0
    s_sub_u32 s42, s42, s44
    s_add_u32 m0, s42, 0
    s_nop 0
    buffer_load_dwordx4 v8, s[20:23], s40 offen sc1 lds
    s_add_u32 m0, s42, 4096
    s_nop 0
    buffer_load_dwordx4 v9, s[20:23], s40 offen sc1 lds
    s_add_u32 m0, s42, 8192
    s_nop 0
    buffer_load_dwordx4 v10, s[20:23], s40 offen sc1 lds
    s_add_u32 m0, s42, 12288
    s_nop 0
    buffer_load_dwordx4 v11, s[20:23], s40 offen sc1 lds
    s_add_u32 s40, s40, 128
    s_add_u32 s42, s42, 16384
    s_cmp_ge_u32 s42, 49152
    s_cselect_b32 s44, 49152, 0
    s_sub_u32 s42, s42, s44
    s_waitcnt vmcnt(8)
    s_barrier
    s_load_dword s68, s[66:67], 0
    s_load_dword s68, s[66:67], 64
    s_load_dword s68, s[66:67], 128
    s_load_dword s68, s[66:67], 192
    s_load_dword s68, s[66:67], 256
    s_load_dword s68, s[66:67], 320
    s_load_dword s68, s[66:67], 384
    s_load_dword s68, s[66:67], 448
    s_add_u32 s66, s66, 512
    s_addc_u32 s67, s67, 0
    s_waitcnt vmcnt(4)
    s_barrier
    s_add_u32 m0, s42, 0
    s_nop 0
    buffer_load_dwordx4 v8, s[20:23], s40 offen sc1 lds
    s_add_u32 m0, s42, 4096
    s_nop 0
    buffer_load_dwordx4 v9, s[20:23], s40 offen sc1 lds
    s_add_u32 m0, s42, 8192
    s_nop 0
    buffer_load_dwordx4 v10, s[20:23], s40 offen sc1 lds
    s_add_u32 m0, s42, 12288
    s_nop 0
    buffer_load_dwordx4 v11, s[20:23], s40 offen sc1 lds
    s_add_u32 m0, s43, 0
    s_nop 0
    buffer_load_dwordx4 v12, s[16:19], s41 offen offset:0  lds
    s_add_u32 m0, s43, 4032
    s_nop 0
    buffer_load_dwordx4 v12, s[16:19], s41 offen offset:64  lds
    s_add_u32 m0, s43, 8064
    s_nop 0
    buffer_load_dwordx4 v12, s[16:19], s41 offen offset:128  lds
    s_add_u32 m0, s43, 12096
    s_nop 0
    buffer_load_dwordx4 v12, s[16:19], s41 offen offset:192  lds
    s_add_u32 m0, s43, 16128
    s_nop 0
    buffer_load_dwordx4 v12, s[16:19], s41 offen offset:256  lds
    s_add_u32 m0, s43, 20160
    s_nop 0
    buffer_load_dwordx4 v12, s[16:19], s41 offen offset:320  lds
    s_add_u32 m0, s43, 24192
    s_nop 0
    buffer_load_dwordx4 v12, s[16:19], s41 offen offset:384  lds
    s_add_u32 s40, s40, 128
    s_add_u32 s42, s42, 16384
    s_cmp_ge_u32 s42, 49152
    s_cselect_b32 s44, 49152, 0
    s_sub_u32 s42, s42, s44
    s_add_u32 s41, s41, 458752
    s_add_u32 s43, s43, 28672
    s_cmp_ge_u32 s43, 135168
    s_cselect_b32 s44, 86016, 0
    s_sub_u32 s43, s43, s44
    s_load_dword s68, s[66:67], 0
    s_load_dword s68, s[66:67], 64
    s_load_dword s68, s[66:67], 128
    s_load_dword s68, s[66:67], 192
    s_load_dword s68, s[66:67], 256
    s_load_dword s68, s[66:67], 320
    s_load_dword s68, s[66:67], 384
    s_load_dword s68, s[66:67], 448
    s_add_u32 s66, s66, 512
    s_addc_u32 s67, s67, 0
    s_mov_b32 s47, 1
    s_mov_b32 m0, s42
adaLN_cond__spectral_gfnet__mixer_channel_mlp__prompt_kernel_lloop21:
    s_waitcnt vmcnt(11)
    s_barrier
    buffer_load_dwordx4 v8, s[20:23], s40 offen sc1 lds
    s_add_u32 m0, s42, 4096
    s_load_dword s68, s[66:67], 0
    buffer_load_dwordx4 v9, s[20:23], s40 offen sc1 lds
    s_add_u32 m0, s42, 8192
    s_load_dword s68, s[66:67], 64
    buffer_load_dwordx4 v10, s[20:23], s40 offen sc1 lds
    s_add_u32 m0, s42, 12288
    s_load_dword s68, s[66:67], 128
    buffer_load_dwordx4 v11, s[20:23], s40 offen sc1 lds
    s_add_u32 m0, s43, 0
    s_load_dword s68, s[66:67], 192
    buffer_load_dwordx4 v12, s[16:19], s41 offen offset:0  lds
    s_add_u32 m0, s43, 4032
    s_add_u32 s40, s40, 128
    s_load_dword s68, s[66:67], 256
    buffer_load_dwordx4 v12, s[16:19], s41 offen offset:64  lds
    s_add_u32 m0, s43, 8064
    s_add_u32 s42, s42, 16384
    s_load_dword s68, s[66:67], 320
    buffer_load_dwordx4 v12, s[16:19], s41 offen offset:128  lds
    s_add_u32 m0, s43, 12096
    s_cmp_ge_u32 s42, 49152
    s_cselect_b32 s44, 49152, 0
    s_cselect_b32 s46, 86016, 0
    s_load_dword s68, s[66:67], 384
    buffer_load_dwordx4 v12, s[16:19], s41 offen offset:192  lds
    s_add_u32 m0, s43, 16128
    s_sub_u32 s42, s42, s44
    s_load_dword s68, s[66:67], 448
    buffer_load_dwordx4 v12, s[16:19], s41 offen offset:256  lds
    s_add_u32 m0, s43, 20160
    s_add_u32 s66, s66, 512
    s_addc_u32 s67, s67, 0
    buffer_load_dwordx4 v12, s[16:19], s41 offen offset:320  lds
    s_add_u32 m0, s43, 24192
    s_add_u32 s43, s43, 28672
    s_sub_u32 s43, s43, s46
    s_add_u32 s47, s47, 1
    buffer_load_dwordx4 v12, s[16:19], s41 offen offset:384  lds
    s_add_u32 s41, s41, 458752
    s_mov_b32 m0, s42
    s_cmp_lt_u32 s47, 13
    s_cbranch_scc1 adaLN_cond__spectral_gfnet__mixer_channel_mlp__prompt_kernel_lloop21
    v_lshlrev_b32 v8, 4, v2
    v_lshlrev_b32 v3, 1, v7
    v_and_b32 v4, 7, v2
    v_xor_b32 v3, v3, v4
    v_lshlrev_b32 v3, 4, v3
    v_lshrrev_b32 v4, 3, v2
    v_lshl_add_u32 v9, v4, 11, v3
    v_add_u32 v10, 16384, v9
    s_lshr_b32 s37, s60, 3
    s_and_b32 s38, s60, 7
    s_and_b32 s36, s35, 1
    s_lshr_b32 s45, s35, 1
    s_add_u32 s46, s45, 6
    s_mul_i32 s39, s38, 7
    v_subrev_u32 v13, 7, v2
    v_mul_u32_u24 v14, 86, v13
    v_lshrrev_b32 v14, 8, v14
    v_mul_u32_u24 v15, 3, v14
    v_sub_u32 v13, v13, v15
    v_min_u32 v15, 1, v13
    v_lshl_add_u32 v13, v15, 1, v13
    v_subrev_u32 v15, 28, v2
    v_lshrrev_b32 v16, 2, v15
    v_and_b32 v17, 2, v15
    v_and_b32 v15, 3, v15
    v_add3_u32 v15, v15, v17, 1
    v_cmp_lt_u32 vcc, 27, v2
    s_nop 1
    v_cndmask_b32 v14, v14, v16, vcc
    v_cndmask_b32 v13, v13, v15, vcc
    v_cmp_le_u32 vcc, s38, v14
    s_nop 1
    v_addc_co_u32 v14, vcc, 0, v14, vcc
    v_mad_u32_u24 v12, v14, 7, v13
    v_add_u32 v13, s39, v2
    v_cmp_gt_u32 vcc, 7, v2
    s_nop 1
    v_cndmask_b32 v12, v12, v13, vcc
    s_mul_i32 s40, s59, 112
    s_mul_i32 s44, s37, 56
    s_add_u32 s40, s40, s44
    s_lshl_b32 s40, s40, 13
    s_add_u32 s40, s40, 1048576
    s_add_u32 s48, s39, 3
    s_lshl_b32 s48, s48, 13
    s_add_u32 s48, s48, s40
    s_lshl_b32 s44, s35, 11
    s_add_u32 s48, s48, s44
    v_add_u32 v11, s44, v8
    s_lshl_b32 s44, s36, 12
    s_add_u32 s40, s40, s44
    s_mul_i32 s41, s37, 3670016
    s_lshl_b32 s44, s36, 15
    s_add_u32 s41, s41, s44
    s_lshl_b32 s44, s38, 8
    s_add_u32 s41, s41, s44
    s_lshl_b32 s42, s35, 12
    s_add_u32 s42, s42, 98304
    s_lshl_b32 s43, s35, 11
    s_add_u32 s43, s43, 16384
    s_mov_b32 s16, s52
    s_mov_b32 s17, s53
    s_mov_b32 s18, 7340032
    s_mov_b32 s19, 0x20000
    s_mov_b32 s22, 37748736
    s_waitcnt vmcnt(11)
    s_barrier
    s_waitcnt vmcnt(0)
    s_barrier
    s_barrier
    v_readlane_b32 s44, v12, s45
    s_nop 0
    s_lshl_b32 s44, s44, 16
    s_add_u32 s44, s44, s41
    s_add_u32 m0, s43, 0
    s_nop 0
    buffer_load_dwordx4 v9, s[16:19], s44 offen offset:0  lds
    s_add_u32 m0, s43, 8064
    s_nop 0
    buffer_load_dwordx4 v9, s[16:19], s44 offen offset:128  lds
    s_add_u32 m0, s43, 1024
    s_nop 0
    buffer_load_dwordx4 v10, s[16:19], s44 offen offset:0  lds
    s_add_u32 m0, s43, 9088
    s_nop 0
    buffer_load_dwordx4 v10, s[16:19], s44 offen offset:128  lds
    s_add_u32 s45, s45, 2
    s_add_u32 s43, s43, 32768
    s_cmp_ge_u32 s43, 163840
    s_cselect_b32 s44, 163840, 0
    s_sub_u32 s43, s43, s44
    v_readlane_b32 s44, v12, s45
    s_nop 0
    s_lshl_b32 s44, s44, 16
    s_add_u32 s44, s44, s41
    s_add_u32 m0, s43, 0
    s_nop 0
    buffer_load_dwordx4 v9, s[16:19], s44 offen offset:0  lds
    s_add_u32 m0, s43, 8064
    s_nop 0
    buffer_load_dwordx4 v9, s[16:19], s44 offen offset:128  lds
    s_add_u32 m0, s43, 1024
    s_nop 0
    buffer_load_dwordx4 v10, s[16:19], s44 offen offset:0  lds
    s_add_u32 m0, s43, 9088
    s_nop 0
    buffer_load_dwordx4 v10, s[16:19], s44 offen offset:128  lds
    s_add_u32 s45, s45, 2
    s_add_u32 s43, s43, 32768
    s_cmp_ge_u32 s43, 163840
    s_cselect_b32 s44, 163840, 0
    s_sub_u32 s43, s43, s44
    v_readlane_b32 s44, v12, s45
    s_nop 0
    s_lshl_b32 s44, s44, 16
    s_add_u32 s44, s44, s41
    s_add_u32 m0, s43, 0
    s_nop 0
    buffer_load_dwordx4 v9, s[16:19], s44 offen offset:0  lds
    s_add_u32 m0, s43, 8064
    s_nop 0
    buffer_load_dwordx4 v9, s[16:19], s44 offen offset:128  lds
    s_add_u32 m0, s43, 1024
    s_nop 0
    buffer_load_dwordx4 v10, s[16:19], s44 offen offset:0  lds
    s_add_u32 m0, s43, 9088
    s_nop 0
    buffer_load_dwordx4 v10, s[16:19], s44 offen offset:128  lds
    s_add_u32 s45, s45, 2
    s_add_u32 s43, s43, 32768
    s_cmp_ge_u32 s43, 163840
    s_cselect_b32 s44, 163840, 0
    s_sub_u32 s43, s43, s44
    s_lshl_b32 s62, s59, 11
    s_lshl_b32 s44, s37, 10
    s_add_u32 s62, s62, s44
    s_add_u32 s62, s62, 425984
    v_lshlrev_b32 v6, 7, v2
    v_and_b32 v6, 2047, v6
    s_lshl_b32 s63, s59, 11
    s_add_u32 s63, s63, 557056
    s_lshr_b32 s44, s35, 1
    s_lshl_b32 s50, s44, 2
    s_add_u32 s50, s50, s39
    s_lshl_b32 s50, s50, 13
    s_add_u32 s50, s50, s40
    s_lshl_b32 s44, s44, 16
    s_lshl_b32 s51, s36, 12
    s_add_u32 s44, s44, s51
    v_add_u32 v13, s44, v8
    s_barrier
    ds_read_b128 v[32:35], v13 offset:0
    ds_read_b128 v[36:39], v13 offset:1024
    ds_read_b128 v[40:43], v13 offset:2048
    ds_read_b128 v[44:47], v13 offset:3072
    ds_read_b128 v[16:19], v11 offset:40960
    ds_read_b128 v[20:23], v11 offset:41984
    s_waitcnt lgkmcnt(0)
    buffer_store_dwordx4 v[32:35], v8, s[20:23], s50 offen offset:0 sc1
    buffer_store_dwordx4 v[36:39], v8, s[20:23], s50 offen offset:1024 sc1
    buffer_store_dwordx4 v[40:43], v8, s[20:23], s50 offen offset:2048 sc1
    buffer_store_dwordx4 v[44:47], v8, s[20:23], s50 offen offset:3072 sc1
    buffer_store_dwordx4 v[16:19], v8, s[20:23], s48 offen sc1
    buffer_store_dwordx4 v[20:23], v8, s[20:23], s48 offen offset:1024 sc1
    s_add_u32 s50, s50, 8192
    v_readlane_b32 s44, v12, s45
    s_nop 0
    s_lshl_b32 s44, s44, 16
    s_add_u32 s44, s44, s41
    s_add_u32 m0, s43, 0
    s_nop 0
    buffer_load_dwordx4 v9, s[16:19], s44 offen offset:0  lds
    s_add_u32 m0, s43, 8064
    s_nop 0
    buffer_load_dwordx4 v9, s[16:19], s44 offen offset:128  lds
    s_add_u32 m0, s43, 1024
    s_nop 0
    buffer_load_dwordx4 v10, s[16:19], s44 offen offset:0  lds
    s_add_u32 m0, s43, 9088
    s_nop 0
    buffer_load_dwordx4 v10, s[16:19], s44 offen offset:128  lds
    s_add_u32 s45, s45, 2
    s_add_u32 s43, s43, 32768
    s_cmp_ge_u32 s43, 163840
    s_cselect_b32 s44, 163840, 0
    s_sub_u32 s43, s43, s44
    s_waitcnt vmcnt(4)
    s_barrier
    s_cmp_lg_u32 s35, 0
    s_cbranch_scc1 adaLN_cond__spectral_gfnet__mixer_channel_mlp__prompt_kernel_rel22
    s_lshl_b32 s64, s58, 7
    s_add_u32 s64, s64, 425984
    v_mov_b32 v4, 0
    v_mov_b32 v5, 1
    s_mov_b64 exec, 1
    buffer_store_dword v5, v4, s[20:23], s64 offen sc1
    s_mov_b64 exec, -1
adaLN_cond__spectral_gfnet__mixer_channel_mlp__prompt_kernel_rel22:
    ds_read_b128 v[48:51], v13 offset:8192
    ds_read_b128 v[52:55], v13 offset:9216
    ds_read_b128 v[56:59], v13 offset:10240
    ds_read_b128 v[60:63], v13 offset:11264
    s_waitcnt lgkmcnt(0)
    buffer_store_dwordx4 v[48:51], v8, s[20:23], s50 offen offset:0 sc1
    buffer_store_dwordx4 v[52:55], v8, s[20:23], s50 offen offset:1024 sc1
    buffer_store_dwordx4 v[56:59], v8, s[20:23], s50 offen offset:2048 sc1
    buffer_store_dwordx4 v[60:63], v8, s[20:23], s50 offen offset:3072 sc1
    s_add_u32 s50, s50, 8192
    v_readlane_b32 s44, v12, s45
    s_nop 0
    s_lshl_b32 s44, s44, 16
    s_add_u32 s44, s44, s41
    s_add_u32 m0, s43, 0
    s_nop 0
    buffer_load_dwordx4 v9, s[16:19], s44 offen offset:0  lds
    s_add_u32 m0, s43, 8064
    s_nop 0
    buffer_load_dwordx4 v9, s[16:19], s44 offen offset:128  lds
    s_add_u32 m0, s43, 1024
    s_nop 0
    buffer_load_dwordx4 v10, s[16:19], s44 offen offset:0  lds
    s_add_u32 m0, s43, 9088
    s_nop 0
    buffer_load_dwordx4 v10, s[16:19], s44 offen offset:128  lds
    s_add_u32 s45, s45, 2
    s_add_u32 s43, s43, 32768
    s_cmp_ge_u32 s43, 163840
    s_cselect_b32 s44, 163840, 0
    s_sub_u32 s43, s43, s44
    s_waitcnt vmcnt(12)
    s_barrier
    s_barrier
    v_lshlrev_b32 v4, 7, v2
    v_and_b32 v4, 1023, v4
    s_mov_b32 s64, 0
adaLN_cond__spectral_gfnet__mixer_channel_mlp__prompt_kernel_poll23:
    buffer_load_dword v5, v4, s[20:23], s62 offen sc1
    s_add_u32 s64, s64, 1
    s_waitcnt vmcnt(0)
    v_cmp_eq_u32 vcc, 0, v5
    s_cmp_ge_u32 s64, 100000
    s_cbranch_scc1 adaLN_cond__spectral_gfnet__mixer_channel_mlp__prompt_kernel_pollx24
    s_nop 2
    s_cbranch_vccnz adaLN_cond__spectral_gfnet__mixer_channel_mlp__prompt_kernel_poll23
adaLN_cond__spectral_gfnet__mixer_channel_mlp__prompt_kernel_pollx24:
    s_cmp_lt_u32 s35, 2
    s_cbranch_scc1 adaLN_cond__spectral_gfnet__mixer_channel_mlp__prompt_kernel_skip325
    v_readlane_b32 s44, v12, s46
    s_nop 0
    s_lshl_b32 s44, s44, 13
    s_add_u32 s44, s44, s40
    s_mov_b32 m0, s42
    s_nop 0
    buffer_load_dwordx4 v8, s[20:23], s44 offen offset:0 sc1 lds
    buffer_load_dwordx4 v8, s[20:23], s44 offen offset:1024 sc1 lds
    buffer_load_dwordx4 v8, s[20:23], s44 offen offset:2048 sc1 lds
    buffer_load_dwordx4 v8, s[20:23], s44 offen offset:3072 sc1 lds
adaLN_cond__spectral_gfnet__mixer_channel_mlp__prompt_kernel_skip325:
    s_add_u32 s46, s46, 2
    s_add_u32 s42, s42, 32768
    s_cmp_ge_u32 s42, 163840
    s_cselect_b32 s44, 163840, 0
    s_sub_u32 s42, s42, s44
    v_readlane_b32 s44, v12, s46
    s_nop 0
    s_lshl_b32 s44, s44, 13
    s_add_u32 s44, s44, s40
    s_mov_b32 m0, s42
    s_nop 0
    buffer_load_dwordx4 v8, s[20:23], s44 offen offset:0 sc1 lds
    buffer_load_dwordx4 v8, s[20:23], s44 offen offset:1024 sc1 lds
    buffer_load_dwordx4 v8, s[20:23], s44 offen offset:2048 sc1 lds
    buffer_load_dwordx4 v8, s[20:23], s44 offen offset:3072 sc1 lds
    s_add_u32 s46, s46, 2
    s_add_u32 s42, s42, 32768
    s_cmp_ge_u32 s42, 163840
    s_cselect_b32 s44, 163840, 0
    s_sub_u32 s42, s42, s44
    s_barrier
    ds_read_b128 v[64:67], v13 offset:32768
    ds_read_b128 v[68:71], v13 offset:33792
    ds_read_b128 v[72:75], v13 offset:34816
    ds_read_b128 v[76:79], v13 offset:35840
    s_waitcnt lgkmcnt(0)
    buffer_store_dwordx4 v[64:67], v8, s[20:23], s50 offen offset:0 sc1
    buffer_store_dwordx4 v[68:71], v8, s[20:23], s50 offen offset:1024 sc1
    buffer_store_dwordx4 v[72:75], v8, s[20:23], s50 offen offset:2048 sc1
    buffer_store_dwordx4 v[76:79], v8, s[20:23], s50 offen offset:3072 sc1
    s_add_u32 s50, s50, 8192
    v_readlane_b32 s44, v12, s46
    s_nop 0
    s_lshl_b32 s44, s44, 13
    s_add_u32 s44, s44, s40
    s_mov_b32 m0, s42
    s_nop 0
    buffer_load_dwordx4 v8, s[20:23], s44 offen offset:0 sc1 lds
    buffer_load_dwordx4 v8, s[20:23], s44 offen offset:1024 sc1 lds
    buffer_load_dwordx4 v8, s[20:23], s44 offen offset:2048 sc1 lds
    buffer_load_dwordx4 v8, s[20:23], s44 offen offset:3072 sc1 lds
    s_add_u32 s46, s46, 2
    s_add_u32 s42, s42, 32768
    s_cmp_ge_u32 s42, 163840
    s_cselect_b32 s44, 163840, 0
    s_sub_u32 s42, s42, s44
    v_readlane_b32 s44, v12, s45
    s_nop 0
    s_lshl_b32 s44, s44, 16
    s_add_u32 s44, s44, s41
    s_add_u32 m0, s43, 0
    s_nop 0
    buffer_load_dwordx4 v9, s[16:19], s44 offen offset:0  lds
    s_add_u32 m0, s43, 8064
    s_nop 0
    buffer_load_dwordx4 v9, s[16:19], s44 offen offset:128  lds
    s_add_u32 m0, s43, 1024
    s_nop 0
    buffer_load_dwordx4 v10, s[16:19], s44 offen offset:0  lds
    s_add_u32 m0, s43, 9088
    s_nop 0
    buffer_load_dwordx4 v10, s[16:19], s44 offen offset:128  lds
    s_add_u32 s45, s45, 2
    s_add_u32 s43, s43, 32768
    s_cmp_ge_u32 s43, 163840
    s_cselect_b32 s44, 163840, 0
    s_sub_u32 s43, s43, s44
    s_waitcnt vmcnt(16)
    s_barrier
    v_readlane_b32 s44, v12, s46
    s_nop 0
    s_lshl_b32 s44, s44, 13
    s_add_u32 s44, s44, s40
    s_mov_b32 m0, s42
    s_nop 0
    buffer_load_dwordx4 v8, s[20:23], s44 offen offset:0 sc1 lds
    buffer_load_dwordx4 v8, s[20:23], s44 offen offset:1024 sc1 lds
    buffer_load_dwordx4 v8, s[20:23], s44 offen offset:2048 sc1 lds
    buffer_load_dwordx4 v8, s[20:23], s44 offen offset:3072 sc1 lds
    s_add_u32 s46, s46, 2
    s_add_u32 s42, s42, 32768
    s_cmp_ge_u32 s42, 163840
    s_cselect_b32 s44, 163840, 0
    s_sub_u32 s42, s42, s44
    v_readlane_b32 s44, v12, s45
    s_nop 0
    s_lshl_b32 s44, s44, 16
    s_add_u32 s44, s44, s41
    s_add_u32 m0, s43, 0
    s_nop 0
    buffer_load_dwordx4 v9, s[16:19], s44 offen offset:0  lds
    s_add_u32 m0, s43, 8064
    s_nop 0
    buffer_load_dwordx4 v9, s[16:19], s44 offen offset:128  lds
    s_add_u32 m0, s43, 1024
    s_nop 0
    buffer_load_dwordx4 v10, s[16:19], s44 offen offset:0  lds
    s_add_u32 m0, s43, 9088
    s_nop 0
    buffer_load_dwordx4 v10, s[16:19], s44 offen offset:128  lds
    s_add_u32 s45, s45, 2
    s_add_u32 s43, s43, 32768
    s_cmp_ge_u32 s43, 163840
    s_cselect_b32 s44, 163840, 0
    s_sub_u32 s43, s43, s44
    v_readlane_b32 s44, v12, s46
    s_nop 0
    s_lshl_b32 s44, s44, 13
    s_add_u32 s44, s44, s40
    s_mov_b32 m0, s42
    s_nop 0
    buffer_load_dwordx4 v8, s[20:23], s44 offen offset:0 sc1 lds
    buffer_load_dwordx4 v8, s[20:23], s44 offen offset:1024 sc1 lds
    buffer_load_dwordx4 v8, s[20:23], s44 offen offset:2048 sc1 lds
    buffer_load_dwordx4 v8, s[20:23], s44 offen offset:3072 sc1 lds
    s_add_u32 s46, s46, 2
    s_add_u32 s42, s42, 32768
    s_cmp_ge_u32 s42, 163840
    s_cselect_b32 s44, 163840, 0
    s_sub_u32 s42, s42, s44
    v_readlane_b32 s44, v12, s45
    s_nop 0
    s_lshl_b32 s44, s44, 16
    s_add_u32 s44, s44, s41
    s_add_u32 m0, s43, 0
    s_nop 0
    buffer_load_dwordx4 v9, s[16:19], s44 offen offset:0  lds
    s_add_u32 m0, s43, 8064
    s_nop 0
    buffer_load_dwordx4 v9, s[16:19], s44 offen offset:128  lds
    s_add_u32 m0, s43, 1024
    s_nop 0
    buffer_load_dwordx4 v10, s[16:19], s44 offen offset:0  lds
    s_add_u32 m0, s43, 9088
    s_nop 0
    buffer_load_dwordx4 v10, s[16:19], s44 offen offset:128  lds
    s_add_u32 s45, s45, 2
    s_add_u32 s43, s43, 32768
    s_cmp_ge_u32 s43, 163840
    s_cselect_b32 s44, 163840, 0
    s_sub_u32 s43, s43, s44
    s_waitcnt vmcnt(24)
    s_barrier
    v_readlane_b32 s44, v12, s46
    s_nop 0
    s_lshl_b32 s44, s44, 13
    s_add_u32 s44, s44, s40
    s_mov_b32 m0, s42
    s_nop 0
    buffer_load_dwordx4 v8, s[20:23], s44 offen offset:0 sc1 lds
    buffer_load_dwordx4 v8, s[20:23], s44 offen offset:1024 sc1 lds
    buffer_load_dwordx4 v8, s[20:23], s44 offen offset:2048 sc1 lds
    buffer_load_dwordx4 v8, s[20:23], s44 offen offset:3072 sc1 lds
    s_add_u32 s46, s46, 2
    s_add_u32 s42, s42, 32768
    s_cmp_ge_u32 s42, 163840
    s_cselect_b32 s44, 163840, 0
    s_sub_u32 s42, s42, s44
    v_readlane_b32 s44, v12, s45
    s_nop 0
    s_lshl_b32 s44, s44, 16
    s_add_u32 s44, s44, s41
    s_add_u32 m0, s43, 0
    s_nop 0
    buffer_load_dwordx4 v9, s[16:19], s44 offen offset:0  lds
    s_add_u32 m0, s43, 8064
    s_nop 0
    buffer_load_dwordx4 v9, s[16:19], s44 offen offset:128  lds
    s_add_u32 m0, s43, 1024
    s_nop 0
    buffer_load_dwordx4 v10, s[16:19], s44 offen offset:0  lds
    s_add_u32 m0, s43, 9088
    s_nop 0
    buffer_load_dwordx4 v10, s[16:19], s44 offen offset:128  lds
    s_add_u32 s45, s45, 2
    s_add_u32 s43, s43, 32768
    s_cmp_ge_u32 s43, 163840
    s_cselect_b32 s44, 163840, 0
    s_sub_u32 s43, s43, s44
    s_cmp_lg_u32 s35, 0
    s_cbranch_scc1 adaLN_cond__spectral_gfnet__mixer_channel_mlp__prompt_kernel_rel26
    s_lshl_b32 s64, s58, 7
    s_add_u32 s64, s64, 557056
    v_mov_b32 v4, 0
    v_mov_b32 v5, 1
    s_mov_b64 exec, 1
    buffer_store_dword v5, v4, s[20:23], s64 offen sc1
    s_mov_b64 exec, -1
adaLN_cond__spectral_gfnet__mixer_channel_mlp__prompt_kernel_rel26:
    s_waitcnt vmcnt(24)
    s_barrier
    v_readlane_b32 s44, v12, s46
    s_nop 0
    s_lshl_b32 s44, s44, 13
    s_add_u32 s44, s44, s40
    s_mov_b32 m0, s42
    s_nop 0
    buffer_load_dwordx4 v8, s[20:23], s44 offen offset:0 sc1 lds
    buffer_load_dwordx4 v8, s[20:23], s44 offen offset:1024 sc1 lds
    buffer_load_dwordx4 v8, s[20:23], s44 offen offset:2048 sc1 lds
    buffer_load_dwordx4 v8, s[20:23], s44 offen offset:3072 sc1 lds
    s_add_u32 s46, s46, 2
    s_add_u32 s42, s42, 32768
    s_cmp_ge_u32 s42, 163840
    s_cselect_b32 s44, 163840, 0
    s_sub_u32 s42, s42, s44
    v_readlane_b32 s44, v12, s45
    s_nop 0
    s_lshl_b32 s44, s44, 16
    s_add_u32 s44, s44, s41
    s_add_u32 m0, s43, 0
    s_nop 0
    buffer_load_dwordx4 v9, s[16:19], s44 offen offset:0  lds
    s_add_u32 m0, s43, 8064
    s_nop 0
    buffer_load_dwordx4 v9, s[16:19], s44 offen offset:128  lds
    s_add_u32 m0, s43, 1024
    s_nop 0
    buffer_load_dwordx4 v10, s[16:19], s44 offen offset:0  lds
    s_add_u32 m0, s43, 9088
    s_nop 0
    buffer_load_dwordx4 v10, s[16:19], s44 offen offset:128  lds
    s_add_u32 s45, s45, 2
    s_add_u32 s43, s43, 32768
    s_cmp_ge_u32 s43, 163840
    s_cselect_b32 s44, 163840, 0
    s_sub_u32 s43, s43, s44
    s_mov_b32 s47, 5
    s_mov_b32 s49, 640
    s_mov_b32 s48, 87360
    v_readlane_b32 s50, v12, s46
    v_readlane_b32 s51, v12, s45
    s_lshl_b32 s50, s50, 13
    s_add_u32 s50, s50, s40
    s_lshl_b32 s51, s51, 16
    s_add_u32 s51, s51, s41
    s_mov_b32 m0, s42
adaLN_cond__spectral_gfnet__mixer_channel_mlp__prompt_kernel_l2loop27:
    s_waitcnt vmcnt(24)
    s_barrier
    buffer_load_dwordx4 v8, s[20:23], s50 offen offset:0 sc1 lds
    s_add_u32 s46, s46, 2
    s_add_u32 s45, s45, 2
    buffer_load_dwordx4 v8, s[20:23], s50 offen offset:1024 sc1 lds
    v_readlane_b32 s65, v12, s46
    v_readlane_b32 s69, v12, s45
    buffer_load_dwordx4 v8, s[20:23], s50 offen offset:2048 sc1 lds
    s_add_u32 s42, s42, 32768
    s_cmp_ge_u32 s42, 163840
    s_cselect_b32 s44, 163840, 0
    buffer_load_dwordx4 v8, s[20:23], s50 offen offset:3072 sc1 lds
    s_mov_b32 m0, s43
    s_sub_u32 s42, s42, s44
    buffer_load_dwordx4 v9, s[16:19], s51 offen offset:0  lds
    s_add_u32 m0, s43, 8064
    s_lshl_b32 s50, s65, 13
    s_add_u32 s50, s50, s40
    buffer_load_dwordx4 v9, s[16:19], s51 offen offset:128  lds
    s_add_u32 m0, s43, 1024
    s_lshl_b32 s69, s69, 16
    s_add_u32 s69, s69, s41
    buffer_load_dwordx4 v10, s[16:19], s51 offen offset:0  lds
    s_add_u32 m0, s43, 9088
    s_add_u32 s43, s43, 32768
    s_sub_u32 s43, s43, s44
    s_add_u32 s47, s47, 1
    s_bitcmp1_b32 s49, s47
    buffer_load_dwordx4 v10, s[16:19], s51 offen offset:128  lds
    s_mov_b32 s51, s69
    s_mov_b32 m0, s42
    s_cbranch_scc1 adaLN_cond__spectral_gfnet__mixer_channel_mlp__prompt_kernel_q128
adaLN_cond__spectral_gfnet__mixer_channel_mlp__prompt_kernel_q229:
    s_cmp_lt_u32 s47, 23
    s_cbranch_scc1 adaLN_cond__spectral_gfnet__mixer_channel_mlp__prompt_kernel_l2loop27
    s_branch adaLN_cond__spectral_gfnet__mixer_channel_mlp__prompt_kernel_q330
adaLN_cond__spectral_gfnet__mixer_channel_mlp__prompt_kernel_q128:
    s_cmp_eq_u32 s47, 9
    s_cbranch_scc1 adaLN_cond__spectral_gfnet__mixer_channel_mlp__prompt_kernel_q431
    buffer_load_dword v7, v6, s[20:23], s63 offen sc1
    s_branch adaLN_cond__spectral_gfnet__mixer_channel_mlp__prompt_kernel_q229
adaLN_cond__spectral_gfnet__mixer_channel_mlp__prompt_kernel_q431:
    s_waitcnt vmcnt(16)
    v_cmp_eq_u32 vcc, 0, v7
    s_nop 4
    s_cbranch_vccz adaLN_cond__spectral_gfnet__mixer_channel_mlp__prompt_kernel_q229
    v_lshlrev_b32 v4, 7, v2
    v_and_b32 v4, 2047, v4
    s_mov_b32 s64, 0
adaLN_cond__spectral_gfnet__mixer_channel_mlp__prompt_kernel_poll32:
    buffer_load_dword v5, v4, s[20:23], s63 offen sc1
    s_add_u32 s64, s64, 1
    s_waitcnt vmcnt(0)
    v_cmp_eq_u32 vcc, 0, v5
    s_cmp_ge_u32 s64, 100000
    s_cbranch_scc1 adaLN_cond__spectral_gfnet__mixer_channel_mlp__prompt_kernel_pollx33
    s_nop 2
    s_cbranch_vccnz adaLN_cond__spectral_gfnet__mixer_channel_mlp__prompt_kernel_poll32
adaLN_cond__spectral_gfnet__mixer_channel_mlp__prompt_kernel_pollx33:
    s_branch adaLN_cond__spectral_gfnet__mixer_channel_mlp__prompt_kernel_q229
adaLN_cond__spectral_gfnet__mixer_channel_mlp__prompt_kernel_q330:
    s_waitcnt vmcnt(24)
    s_barrier
    s_waitcnt vmcnt(16)
    s_barrier
    s_waitcnt vmcnt(8)
    s_barrier
    s_waitcnt vmcnt(0)
    s_barrier
    s_waitcnt vmcnt(0)
    s_barrier
    s_endpgm
adaLN_cond__spectral_gfnet__mixer_channel_mlp__prompt_kernel_comp2:
    s_lshr_b32 s30, s3, 1
    s_lshl_b32 s30, s30, 4
    s_and_b32 s31, s3, 1
    s_lshl_b32 s31, s31, 1
    s_add_u32 s30, s30, s31
    s_bfe_u32 s31, s58, 0x20004
    s_lshl_b32 s31, s31, 2
    s_add_u32 s30, s30, s31
    s_lshl_b32 s30, s30, 6
    s_lshr_b32 s31, s58, 6
    s_lshl_b32 s31, s31, 4
    s_add_u32 s30, s30, s31
    s_add_u32 s30, s30, s60
    s_lshl_b32 s30, s30, 11
    v_and_b32 v3, 1, v2
    v_lshlrev_b32 v3, 17, v3
    v_bfe_u32 v4, v2, 1, 3
    v_lshl_add_u32 v3, v4, 3, v3
    v_lshrrev_b32 v6, 4, v2
    v_lshl_add_u32 v3, v6, 6, v3
    s_waitcnt lgkmcnt(0)
    s_mov_b32 s16, s10
    s_mov_b32 s17, s11
    s_mov_b32 s18, 4194304
    s_mov_b32 s19, 0x20000
    buffer_load_dwordx2 v[8:9], v3, s[16:19], s30 offen offset:0
    buffer_load_dwordx2 v[10:11], v3, s[16:19], s30 offen offset:256
    buffer_load_dwordx2 v[12:13], v3, s[16:19], s30 offen offset:512
    buffer_load_dwordx2 v[14:15], v3, s[16:19], s30 offen offset:768
    buffer_load_dwordx2 v[16:17], v3, s[16:19], s30 offen offset:1024
    buffer_load_dwordx2 v[18:19], v3, s[16:19], s30 offen offset:1280
    buffer_load_dwordx2 v[20:21], v3, s[16:19], s30 offen offset:1536
    buffer_load_dwordx2 v[22:23], v3, s[16:19], s30 offen offset:1792
    s_mov_b32 s20, s8
    s_mov_b32 s21, s9
    s_mov_b32 s22, 37748736
    s_mov_b32 s23, 0x20000
    s_mov_b32 s24, s66
    s_mov_b32 s25, s67
    s_mov_b32 s26, 256
    s_mov_b32 s27, 0x20000
    s_getpc_b64 s[12:13]
adaLN_cond__spectral_gfnet__mixer_channel_mlp__prompt_kernel_pc34:
    s_add_u32 s12, s12, k1_tab-adaLN_cond__spectral_gfnet__mixer_channel_mlp__prompt_kernel_pc34
    s_addc_u32 s13, s13, 0
    s_mov_b32 s14, 11264
    s_mov_b32 s15, 0x20000
    v_lshlrev_b32 v3, 4, v2
    s_lshl_b32 s33, s3, 10
    s_add_u32 s34, s33, 0
    s_add_u32 m0, s34, 49152
    s_nop 0
    buffer_load_dwordx4 v3, s[12:15], s34 offen lds
    s_add_u32 s34, s33, 4096
    s_add_u32 m0, s34, 49152
    s_nop 0
    buffer_load_dwordx4 v3, s[12:15], s34 offen lds
    s_add_u32 s34, s33, 8192
    s_add_u32 m0, s34, 49152
    s_nop 0
    buffer_load_dwordx4 v3, s[12:15], s34 offen lds
    v_and_b32 v5, 15, v2
    v_lshlrev_b32 v4, 4, v0
    v_cvt_f32_u32 v40, v5
    v_mul_f32 v40, 0x3a800000, v40
    v_lshlrev_b32 v41, 3, v6
    v_cvt_f32_u32 v41, v41
    v_mul_f32 v41, v41, v40
    v_cos_f32 v24, v41
    v_sin_f32 v25, v41
    v_add_f32 v41, v41, v40
    v_cos_f32 v26, v41
    v_sin_f32 v27, v41
    v_add_f32 v41, v41, v40
    v_cos_f32 v28, v41
    v_sin_f32 v29, v41
    v_add_f32 v41, v41, v40
    v_cos_f32 v30, v41
    v_sin_f32 v31, v41
    v_add_f32 v41, v41, v40
    v_cos_f32 v32, v41
    v_sin_f32 v33, v41
    v_add_f32 v41, v41, v40
    v_cos_f32 v34, v41
    v_sin_f32 v35, v41
    v_add_f32 v41, v41, v40
    v_cos_f32 v36, v41
    v_sin_f32 v37, v41
    v_add_f32 v41, v41, v40
    v_cos_f32 v38, v41
    v_sin_f32 v39, v41
    v_lshrrev_b32 v43, 1, v2
    v_lshlrev_b32 v43, 4, v43
    v_add_u32 v43, 49152, v43
    v_and_b32 v42, 31, v0
    v_lshlrev_b32 v42, 4, v42
    v_lshrrev_b32 v46, 7, v0
    v_lshl_add_u32 v42, v46, 9, v42
    v_bfe_u32 v46, v0, 5, 2
    v_lshl_add_u32 v42, v46, 2, v42
    v_add_u32 v42, 61440, v42
    v_add_u32 v49, 49152, v3
    s_mul_i32 s35, s3, 4864
    s_add_u32 s35, s35, 69632
    v_lshl_add_u32 v44, v6, 7, v5
    v_lshl_add_u32 v44, v44, 2, s35
    v_sub_u32 v45, 32, v5
    v_cmp_eq_u32 s[40:41], 0, v5
    s_nop 1
    v_cndmask_b32 v45, v45, 16, s[40:41]
    v_lshl_add_u32 v45, v6, 7, v45
    v_lshl_add_u32 v45, v45, 2, s35
    v_and_b32 v46, 1, v0
    v_mul_u32_u24 v47, 592, v46
    v_lshrrev_b32 v48, 1, v0
    v_add_u32 v47, v47, v48
    v_lshlrev_b32 v47, 2, v47
    v_add_u32 v47, 69632, v47
    v_lshrrev_b32 v48, 3, v0
    v_lshlrev_b32 v48, 15, v48
    v_and_b32 v46, 7, v0
    v_lshl_add_u32 v48, v46, 4, v48
    s_lshl_b32 s36, s58, 7
    s_add_u32 s36, s36, 9453568
    s_waitcnt vmcnt(10)
    v_lshlrev_b32 v224, 16, v8
    v_and_b32 v232, 0xffff0000, v8
    v_lshlrev_b32 v240, 16, v9
    v_and_b32 v248, 0xffff0000, v9
    s_waitcnt vmcnt(9)
    v_lshlrev_b32 v225, 16, v10
    v_and_b32 v233, 0xffff0000, v10
    v_lshlrev_b32 v241, 16, v11
    v_and_b32 v249, 0xffff0000, v11
    v_pk_mul_f32 v[58:59], v[224:225], v[224:225]
    v_pk_mul_f32 v[60:61], v[232:233], v[232:233]
    v_pk_add_f32 v[56:57], v[224:225], v[232:233]
    v_pk_fma_f32 v[58:59], v[240:241], v[240:241], v[58:59]
    v_pk_add_f32 v[56:57], v[56:57], v[240:241]
    v_pk_fma_f32 v[60:61], v[248:249], v[248:249], v[60:61]
    v_pk_add_f32 v[56:57], v[56:57], v[248:249]
    s_waitcnt vmcnt(8)
    v_lshlrev_b32 v226, 16, v12
    v_and_b32 v234, 0xffff0000, v12
    v_lshlrev_b32 v242, 16, v13
    v_and_b32 v250, 0xffff0000, v13
    s_waitcnt vmcnt(7)
    v_lshlrev_b32 v227, 16, v14
    v_and_b32 v235, 0xffff0000, v14
    v_lshlrev_b32 v243, 16, v15
    v_and_b32 v251, 0xffff0000, v15
    v_pk_fma_f32 v[58:59], v[226:227], v[226:227], v[58:59]
    v_pk_add_f32 v[56:57], v[56:57], v[226:227]
    v_pk_fma_f32 v[60:61], v[234:235], v[234:235], v[60:61]
    v_pk_add_f32 v[56:57], v[56:57], v[234:235]
    v_pk_fma_f32 v[58:59], v[242:243], v[242:243], v[58:59]
    v_pk_add_f32 v[56:57], v[56:57], v[242:243]
    v_pk_fma_f32 v[60:61], v[250:251], v[250:251], v[60:61]
    v_pk_add_f32 v[56:57], v[56:57], v[250:251]
    s_waitcnt vmcnt(6)
    v_lshlrev_b32 v228, 16, v16
    v_and_b32 v236, 0xffff0000, v16
    v_lshlrev_b32 v244, 16, v17
    v_and_b32 v252, 0xffff0000, v17
    s_waitcnt vmcnt(5)
    v_lshlrev_b32 v229, 16, v18
    v_and_b32 v237, 0xffff0000, v18
    v_lshlrev_b32 v245, 16, v19
    v_and_b32 v253, 0xffff0000, v19
    v_pk_fma_f32 v[58:59], v[228:229], v[228:229], v[58:59]
    v_pk_add_f32 v[56:57], v[56:57], v[228:229]
    v_pk_fma_f32 v[60:61], v[236:237], v[236:237], v[60:61]
    v_pk_add_f32 v[56:57], v[56:57], v[236:237]
    v_pk_fma_f32 v[58:59], v[244:245], v[244:245], v[58:59]
    v_pk_add_f32 v[56:57], v[56:57], v[244:245]
    v_pk_fma_f32 v[60:61], v[252:253], v[252:253], v[60:61]
    v_pk_add_f32 v[56:57], v[56:57], v[252:253]
    s_waitcnt vmcnt(4)
    v_lshlrev_b32 v230, 16, v20
    v_and_b32 v238, 0xffff0000, v20
    v_lshlrev_b32 v246, 16, v21
    v_and_b32 v254, 0xffff0000, v21
    s_waitcnt vmcnt(3)
    v_lshlrev_b32 v231, 16, v22
    v_and_b32 v239, 0xffff0000, v22
    v_lshlrev_b32 v247, 16, v23
    v_and_b32 v255, 0xffff0000, v23
    v_pk_fma_f32 v[58:59], v[230:231], v[230:231], v[58:59]
    v_pk_add_f32 v[56:57], v[56:57], v[230:231]
    v_pk_fma_f32 v[60:61], v[238:239], v[238:239], v[60:61]
    v_pk_add_f32 v[56:57], v[56:57], v[238:239]
    v_pk_fma_f32 v[58:59], v[246:247], v[246:247], v[58:59]
    v_pk_add_f32 v[56:57], v[56:57], v[246:247]
    v_pk_fma_f32 v[60:61], v[254:255], v[254:255], v[60:61]
    v_pk_add_f32 v[56:57], v[56:57], v[254:255]
    v_pk_add_f32 v[58:59], v[58:59], v[60:61]
    v_add_f32 v56, v56, v57
    v_add_f32 v58, v58, v59
    s_nop 1
    v_permlane32_swap_b32 v56, v58
    v_add_f32 v56, v56, v58
    v_mov_b32 v57, v56
    s_nop 1
    v_permlane16_swap_b32 v57, v56
    v_add_f32 v56, v56, v57
    s_nop 1
    v_add_f32_dpp v56, v56, v56 quad_perm:[2,3,0,1] row_mask:0xf bank_mask:0xf
    s_nop 1
    v_add_f32_dpp v56, v56, v56 row_ror:4 row_mask:0xf bank_mask:0xf
    s_nop 1
    v_add_f32_dpp v56, v56, v56 row_ror:8 row_mask:0xf bank_mask:0xf
    v_mov_b32 v57, v56
    s_nop 1
    v_permlane32_swap_b32 v57, v56
    s_waitcnt vmcnt(0)
    s_barrier
    ds_read_b128 v[128:131], v49 offset:0
    ds_read_b128 v[132:135], v49 offset:1024
    ds_read_b128 v[136:139], v49 offset:2048
    ds_read_b128 v[140:143], v49 offset:3072
    ds_read_b128 v[144:147], v49 offset:4096
    ds_read_b128 v[148:151], v49 offset:5120
    ds_read_b128 v[152:155], v49 offset:6144
    ds_read_b128 v[156:159], v49 offset:7168
    ds_read_b128 v[160:163], v49 offset:8192
    ds_read_b128 v[164:167], v49 offset:9216
    ds_read_b128 v[168:171], v49 offset:10240
    v_mul_f32 v57, 0x3a800000, v57
    v_mul_f32 v58, v57, v57
    v_mul_f32 v56, 0x3a800000, v56
    v_sub_f32 v56, v56, v58
    v_max_f32 v56, 0, v56
    v_cvt_pk_bf16_f32 v58, v57, v56
    v_and_b32 v56, 0xffff0000, v58
    v_lshlrev_b32 v57, 16, v58
    v_add_f32 v56, 0x3727c5ac, v56
    v_cvt_pk_bf16_f32 v56, v56, v56
    v_and_b32 v56, 0xffff0000, v56
    v_sqrt_f32 v56, v56
    s_nop 0
    v_cvt_pk_bf16_f32 v56, v56, v56
    v_and_b32 v56, 0xffff0000, v56
    v_rcp_f32 v60, v56
    s_nop 0
    v_mul_f32 v61, v57, v60
    v_sub_f32 v61, 0, v61
    v_pk_fma_f32 v[224:225], v[224:225], v[60:61], v[60:61] op_sel:[0,0,1] op_sel_hi:[1,0,1]
    v_pk_fma_f32 v[226:227], v[226:227], v[60:61], v[60:61] op_sel:[0,0,1] op_sel_hi:[1,0,1]
    v_pk_fma_f32 v[228:229], v[228:229], v[60:61], v[60:61] op_sel:[0,0,1] op_sel_hi:[1,0,1]
    v_pk_fma_f32 v[230:231], v[230:231], v[60:61], v[60:61] op_sel:[0,0,1] op_sel_hi:[1,0,1]
    v_pk_fma_f32 v[232:233], v[232:233], v[60:61], v[60:61] op_sel:[0,0,1] op_sel_hi:[1,0,1]
    v_pk_fma_f32 v[234:235], v[234:235], v[60:61], v[60:61] op_sel:[0,0,1] op_sel_hi:[1,0,1]
    v_pk_fma_f32 v[236:237], v[236:237], v[60:61], v[60:61] op_sel:[0,0,1] op_sel_hi:[1,0,1]
    v_pk_fma_f32 v[238:239], v[238:239], v[60:61], v[60:61] op_sel:[0,0,1] op_sel_hi:[1,0,1]
    v_pk_fma_f32 v[240:241], v[240:241], v[60:61], v[60:61] op_sel:[0,0,1] op_sel_hi:[1,0,1]
    v_pk_fma_f32 v[242:243], v[242:243], v[60:61], v[60:61] op_sel:[0,0,1] op_sel_hi:[1,0,1]
    v_pk_fma_f32 v[244:245], v[244:245], v[60:61], v[60:61] op_sel:[0,0,1] op_sel_hi:[1,0,1]
    v_pk_fma_f32 v[246:247], v[246:247], v[60:61], v[60:61] op_sel:[0,0,1] op_sel_hi:[1,0,1]
    v_pk_fma_f32 v[248:249], v[248:249], v[60:61], v[60:61] op_sel:[0,0,1] op_sel_hi:[1,0,1]
    v_pk_fma_f32 v[250:251], v[250:251], v[60:61], v[60:61] op_sel:[0,0,1] op_sel_hi:[1,0,1]
    v_pk_fma_f32 v[252:253], v[252:253], v[60:61], v[60:61] op_sel:[0,0,1] op_sel_hi:[1,0,1]
    v_pk_fma_f32 v[254:255], v[254:255], v[60:61], v[60:61] op_sel:[0,0,1] op_sel_hi:[1,0,1]
    s_mov_b32 s64, 0
    s_branch adaLN_cond__spectral_gfnet__mixer_channel_mlp__prompt_kernel_go137
adaLN_cond__spectral_gfnet__mixer_channel_mlp__prompt_kernel_go35:
    s_sleep 2
adaLN_cond__spectral_gfnet__mixer_channel_mlp__prompt_kernel_go137:
    buffer_load_dwordx2 v[56:57], off, s[24:27], 0 sc1
    s_add_u32 s64, s64, 1
    s_waitcnt vmcnt(0)
    v_cmp_eq_u32 vcc, 0, v56
    s_cmp_ge_u32 s64, 100000
    s_cbranch_scc1 adaLN_cond__spectral_gfnet__mixer_channel_mlp__prompt_kernel_gox36
    s_nop 2
    s_cbranch_vccnz adaLN_cond__spectral_gfnet__mixer_channel_mlp__prompt_kernel_go35
adaLN_cond__spectral_gfnet__mixer_channel_mlp__prompt_kernel_gox36:
    s_setprio 2
    s_mov_b32 s32, 0
    buffer_load_dwordx4 v[64:67], v4, s[20:23], s32 offen sc1
    s_mov_b32 s32, 4096
    buffer_load_dwordx4 v[68:71], v4, s[20:23], s32 offen sc1
    s_mov_b32 s32, 24576
    buffer_load_dwordx4 v[72:75], v4, s[20:23], s32 offen sc1
    s_mov_b32 s32, 28672
    buffer_load_dwordx4 v[76:79], v4, s[20:23], s32 offen sc1
    s_mov_b32 s32, 49152
    buffer_load_dwordx4 v[80:83], v4, s[20:23], s32 offen sc1
    s_mov_b32 s32, 53248
    buffer_load_dwordx4 v[84:87], v4, s[20:23], s32 offen sc1
    s_mov_b32 s32, 73728
    buffer_load_dwordx4 v[88:91], v4, s[20:23], s32 offen sc1
    s_mov_b32 s32, 77824
    buffer_load_dwordx4 v[92:95], v4, s[20:23], s32 offen sc1
    s_waitcnt vmcnt(0)
    v_pk_add_f32 v[64:65], v[64:65], v[72:73]
    v_pk_add_f32 v[66:67], v[66:67], v[74:75]
    v_pk_add_f32 v[68:69], v[68:69], v[76:77]
    v_pk_add_f32 v[70:71], v[70:71], v[78:79]
    v_pk_add_f32 v[80:81], v[80:81], v[88:89]
    v_pk_add_f32 v[82:83], v[82:83], v[90:91]
    v_pk_add_f32 v[84:85], v[84:85], v[92:93]
    v_pk_add_f32 v[86:87], v[86:87], v[94:95]
    v_pk_add_f32 v[64:65], v[64:65], v[80:81]
    v_pk_add_f32 v[66:67], v[66:67], v[82:83]
    v_pk_add_f32 v[68:69], v[68:69], v[84:85]
    v_pk_add_f32 v[70:71], v[70:71], v[86:87]
    v_cvt_pk_bf16_f32 v72, v64, v65
    v_cvt_pk_bf16_f32 v74, v66, v67
    v_cvt_pk_bf16_f32 v76, v68, v69
    v_cvt_pk_bf16_f32 v78, v70, v71
    v_lshlrev_b32 v64, 16, v72
    v_and_b32 v65, 0xffff0000, v72
    v_lshlrev_b32 v66, 16, v74
    v_and_b32 v67, 0xffff0000, v74
    v_lshlrev_b32 v68, 16, v76
    v_and_b32 v69, 0xffff0000, v76
    v_lshlrev_b32 v70, 16, v78
    v_and_b32 v71, 0xffff0000, v78
    ds_write2st64_b32 v42, v64, v65 offset0:0 offset1:4
    ds_write2st64_b32 v42, v66, v67 offset0:8 offset1:12
    v_pk_add_f32 v[68:69], v[68:69], 1.0 op_sel_hi:[1,0]
    v_pk_add_f32 v[70:71], v[70:71], 1.0 op_sel_hi:[1,0]
    v_cvt_pk_bf16_f32 v76, v68, v69
    v_cvt_pk_bf16_f32 v78, v70, v71
    v_lshlrev_b32 v68, 16, v76
    v_and_b32 v69, 0xffff0000, v76
    v_lshlrev_b32 v70, 16, v78
    v_and_b32 v71, 0xffff0000, v78
    ds_write2st64_b32 v42, v68, v69 offset0:16 offset1:20
    ds_write2st64_b32 v42, v70, v71 offset0:24 offset1:28
    s_waitcnt lgkmcnt(0)
    s_barrier
    ds_read_b128 v[64:67], v43 offset:12288
    ds_read_b128 v[68:71], v43 offset:12800
    ds_read_b128 v[72:75], v43 offset:16384
    ds_read_b128 v[76:79], v43 offset:16896
    ds_read_b128 v[80:83], v43 offset:13312
    ds_read_b128 v[84:87], v43 offset:13824
    ds_read_b128 v[88:91], v43 offset:17408
    ds_read_b128 v[92:95], v43 offset:17920
    ds_read_b128 v[96:99], v43 offset:14336
    ds_read_b128 v[100:103], v43 offset:14848
    ds_read_b128 v[104:107], v43 offset:18432
    ds_read_b128 v[108:111], v43 offset:18944
    ds_read_b128 v[112:115], v43 offset:15360
    ds_read_b128 v[116:119], v43 offset:15872
    ds_read_b128 v[120:123], v43 offset:19456
    ds_read_b128 v[124:127], v43 offset:19968
    s_waitcnt lgkmcnt(12)
    v_pk_fma_f32 v[224:225], v[224:225], v[72:73], v[64:65]
    v_pk_fma_f32 v[226:227], v[226:227], v[74:75], v[66:67]
    v_pk_fma_f32 v[228:229], v[228:229], v[76:77], v[68:69]
    v_pk_fma_f32 v[230:231], v[230:231], v[78:79], v[70:71]
    s_waitcnt lgkmcnt(8)
    v_pk_fma_f32 v[232:233], v[232:233], v[88:89], v[80:81]
    v_pk_fma_f32 v[234:235], v[234:235], v[90:91], v[82:83]
    v_pk_fma_f32 v[236:237], v[236:237], v[92:93], v[84:85]
    v_pk_fma_f32 v[238:239], v[238:239], v[94:95], v[86:87]
    s_waitcnt lgkmcnt(4)
    v_pk_fma_f32 v[240:241], v[240:241], v[104:105], v[96:97]
    v_pk_fma_f32 v[242:243], v[242:243], v[106:107], v[98:99]
    v_pk_fma_f32 v[244:245], v[244:245], v[108:109], v[100:101]
    v_pk_fma_f32 v[246:247], v[246:247], v[110:111], v[102:103]
    s_waitcnt lgkmcnt(0)
    v_pk_fma_f32 v[248:249], v[248:249], v[120:121], v[112:113]
    v_pk_fma_f32 v[250:251], v[250:251], v[122:123], v[114:115]
    v_pk_fma_f32 v[252:253], v[252:253], v[124:125], v[116:117]
    v_pk_fma_f32 v[254:255], v[254:255], v[126:127], v[118:119]
    v_cvt_pk_bf16_f32 v8, v224, v225
    v_cvt_pk_bf16_f32 v9, v226, v227
    v_cvt_pk_bf16_f32 v10, v228, v229
    v_cvt_pk_bf16_f32 v11, v230, v231
    v_cvt_pk_bf16_f32 v12, v232, v233
    v_cvt_pk_bf16_f32 v13, v234, v235
    v_mfma_f32_16x16x32_bf16 v[192:195], v[8:11], v[128:131], 0
    v_cvt_pk_bf16_f32 v14, v236, v237
    v_cvt_pk_bf16_f32 v15, v238, v239
    v_mfma_f32_16x16x32_bf16 v[196:199], v[8:11], v[132:135], 0
    v_cvt_pk_bf16_f32 v16, v240, v241
    v_cvt_pk_bf16_f32 v17, v242, v243
    v_mfma_f32_16x16x32_bf16 v[200:203], v[12:15], v[128:131], 0
    v_cvt_pk_bf16_f32 v18, v244, v245
    v_cvt_pk_bf16_f32 v19, v246, v247
    v_mfma_f32_16x16x32_bf16 v[204:207], v[12:15], v[132:135], 0
    v_cvt_pk_bf16_f32 v20, v248, v249
    v_cvt_pk_bf16_f32 v21, v250, v251
    v_mfma_f32_16x16x32_bf16 v[208:211], v[16:19], v[128:131], 0
    v_cvt_pk_bf16_f32 v22, v252, v253
    v_cvt_pk_bf16_f32 v23, v254, v255
    v_mfma_f32_16x16x32_bf16 v[212:215], v[16:19], v[132:135], 0
    s_nop 0
    v_mfma_f32_16x16x32_bf16 v[216:219], v[20:23], v[128:131], 0
    v_mfma_f32_16x16x32_bf16 v[220:223], v[20:23], v[132:135], 0
    v_pk_mul_f32 v[64:65], v[192:193], v[24:25] op_sel_hi:[1,0]
    v_pk_mul_f32 v[68:69], v[196:197], v[24:25] op_sel_hi:[1,0]
    v_pk_fma_f32 v[64:65], v[196:197], v[24:25], v[64:65] op_sel:[0,1,0] op_sel_hi:[1,1,1]
    v_pk_fma_f32 v[68:69], v[192:193], v[24:25], v[68:69] op_sel:[0,1,0] op_sel_hi:[1,1,1] neg_lo:[1,0,0] neg_hi:[1,0,0]
    v_pk_mul_f32 v[66:67], v[194:195], v[32:33] op_sel_hi:[1,0]
    v_pk_mul_f32 v[70:71], v[198:199], v[32:33] op_sel_hi:[1,0]
    v_pk_fma_f32 v[66:67], v[198:199], v[32:33], v[66:67] op_sel:[0,1,0] op_sel_hi:[1,1,1]
    v_pk_fma_f32 v[70:71], v[194:195], v[32:33], v[70:71] op_sel:[0,1,0] op_sel_hi:[1,1,1] neg_lo:[1,0,0] neg_hi:[1,0,0]
    v_pk_mul_f32 v[72:73], v[200:201], v[26:27] op_sel_hi:[1,0]
    v_pk_mul_f32 v[76:77], v[204:205], v[26:27] op_sel_hi:[1,0]
    v_pk_fma_f32 v[72:73], v[204:205], v[26:27], v[72:73] op_sel:[0,1,0] op_sel_hi:[1,1,1]
    v_pk_fma_f32 v[76:77], v[200:201], v[26:27], v[76:77] op_sel:[0,1,0] op_sel_hi:[1,1,1] neg_lo:[1,0,0] neg_hi:[1,0,0]
    v_pk_mul_f32 v[74:75], v[202:203], v[34:35] op_sel_hi:[1,0]
    v_pk_mul_f32 v[78:79], v[206:207], v[34:35] op_sel_hi:[1,0]
    v_pk_fma_f32 v[74:75], v[206:207], v[34:35], v[74:75] op_sel:[0,1,0] op_sel_hi:[1,1,1]
    v_pk_fma_f32 v[78:79], v[202:203], v[34:35], v[78:79] op_sel:[0,1,0] op_sel_hi:[1,1,1] neg_lo:[1,0,0] neg_hi:[1,0,0]
    v_pk_mul_f32 v[80:81], v[208:209], v[28:29] op_sel_hi:[1,0]
    v_pk_mul_f32 v[84:85], v[212:213], v[28:29] op_sel_hi:[1,0]
    v_pk_fma_f32 v[80:81], v[212:213], v[28:29], v[80:81] op_sel:[0,1,0] op_sel_hi:[1,1,1]
    v_pk_fma_f32 v[84:85], v[208:209], v[28:29], v[84:85] op_sel:[0,1,0] op_sel_hi:[1,1,1] neg_lo:[1,0,0] neg_hi:[1,0,0]
    v_pk_mul_f32 v[82:83], v[210:211], v[36:37] op_sel_hi:[1,0]
    v_pk_mul_f32 v[86:87], v[214:215], v[36:37] op_sel_hi:[1,0]
    v_pk_fma_f32 v[82:83], v[214:215], v[36:37], v[82:83] op_sel:[0,1,0] op_sel_hi:[1,1,1]
    v_pk_fma_f32 v[86:87], v[210:211], v[36:37], v[86:87] op_sel:[0,1,0] op_sel_hi:[1,1,1] neg_lo:[1,0,0] neg_hi:[1,0,0]
    v_pk_mul_f32 v[88:89], v[216:217], v[30:31] op_sel_hi:[1,0]
    v_pk_mul_f32 v[92:93], v[220:221], v[30:31] op_sel_hi:[1,0]
    v_pk_fma_f32 v[88:89], v[220:221], v[30:31], v[88:89] op_sel:[0,1,0] op_sel_hi:[1,1,1]
    v_pk_fma_f32 v[92:93], v[216:217], v[30:31], v[92:93] op_sel:[0,1,0] op_sel_hi:[1,1,1] neg_lo:[1,0,0] neg_hi:[1,0,0]
    v_pk_mul_f32 v[90:91], v[218:219], v[38:39] op_sel_hi:[1,0]
    v_pk_mul_f32 v[94:95], v[222:223], v[38:39] op_sel_hi:[1,0]
    v_pk_fma_f32 v[90:91], v[222:223], v[38:39], v[90:91] op_sel:[0,1,0] op_sel_hi:[1,1,1]
    v_pk_fma_f32 v[94:95], v[218:219], v[38:39], v[94:95] op_sel:[0,1,0] op_sel_hi:[1,1,1] neg_lo:[1,0,0] neg_hi:[1,0,0]
    s_waitcnt lgkmcnt(0)
    v_cvt_pk_bf16_f32 v96, v64, v72
    v_cvt_pk_bf16_f32 v97, v80, v88
    v_cvt_pk_bf16_f32 v98, v66, v74
    v_cvt_pk_bf16_f32 v99, v82, v90
    v_cvt_pk_bf16_f32 v104, v65, v73
    s_nop 0
    v_mfma_f32_16x16x32_bf16 v[192:195], v[136:139], v[96:99], 0
    v_cvt_pk_bf16_f32 v105, v81, v89
    v_cvt_pk_bf16_f32 v106, v67, v75
    v_cvt_pk_bf16_f32 v107, v83, v91
    v_mfma_f32_16x16x32_bf16 v[196:199], v[144:147], v[96:99], 0
    v_cvt_pk_bf16_f32 v100, v68, v76
    v_cvt_pk_bf16_f32 v101, v84, v92
    v_cvt_pk_bf16_f32 v102, v70, v78
    v_mfma_f32_16x16x32_bf16 v[200:203], v[148:151], v[96:99], 0
    v_cvt_pk_bf16_f32 v103, v86, v94
    v_cvt_pk_bf16_f32 v108, v69, v77
    v_cvt_pk_bf16_f32 v109, v85, v93
    v_mfma_f32_16x16x32_bf16 v[204:207], v[152:155], v[96:99], 0
    v_cvt_pk_bf16_f32 v110, v71, v79
    v_cvt_pk_bf16_f32 v111, v87, v95
    v_mfma_f32_16x16x32_bf16 v[208:211], v[136:139], v[104:107], 0
    v_mfma_f32_16x16x32_bf16 v[212:215], v[144:147], v[104:107], 0
    v_mfma_f32_16x16x32_bf16 v[216:219], v[148:151], v[104:107], 0
    v_mfma_f32_16x16x32_bf16 v[220:223], v[152:155], v[104:107], 0
    v_mfma_f32_16x16x32_bf16 v[192:195], v[140:143], v[100:103], v[192:195]
    v_mfma_f32_16x16x32_bf16 v[208:211], v[140:143], v[108:111], v[208:211]
    v_mfma_f32_16x16x32_bf16 v[196:199], v[136:139], v[100:103], v[196:199]
    v_mfma_f32_16x16x32_bf16 v[212:215], v[136:139], v[108:111], v[212:215]
    v_mfma_f32_16x16x32_bf16 v[200:203], v[152:155], v[100:103], v[200:203]
    v_mfma_f32_16x16x32_bf16 v[216:219], v[152:155], v[108:111], v[216:219]
    v_mfma_f32_16x16x32_bf16 v[204:207], v[156:159], v[100:103], v[204:207]
    v_mfma_f32_16x16x32_bf16 v[220:223], v[156:159], v[108:111], v[220:223]
    v_mfma_f32_16x16x32_bf16 v[224:227], v[136:139], v[96:99], 0
    v_mfma_f32_16x16x32_bf16 v[240:243], v[136:139], v[104:107], 0
    v_cvt_pk_bf16_f32 v64, v192, v208
    v_mfma_f32_16x16x32_bf16 v[228:231], v[160:163], v[96:99], 0
    v_cvt_pk_bf16_f32 v65, v193, v209
    v_cvt_pk_bf16_f32 v66, v194, v210
    v_mfma_f32_16x16x32_bf16 v[244:247], v[160:163], v[104:107], 0
    v_cvt_pk_bf16_f32 v67, v195, v211
    v_cvt_pk_bf16_f32 v68, v196, v212
    v_cvt_pk_bf16_f32 v69, v197, v213
    v_mfma_f32_16x16x32_bf16 v[232:235], v[164:167], v[100:103], 0
    v_cvt_pk_bf16_f32 v70, v198, v214
    v_cvt_pk_bf16_f32 v71, v199, v215
    v_cvt_pk_bf16_f32 v72, v200, v216
    v_mfma_f32_16x16x32_bf16 v[248:251], v[164:167], v[108:111], 0
    v_cvt_pk_bf16_f32 v73, v201, v217
    v_cvt_pk_bf16_f32 v74, v202, v218
    v_mfma_f32_16x16x32_bf16 v[236:239], v[168:171], v[100:103], 0
    v_cvt_pk_bf16_f32 v75, v203, v219
    v_cvt_pk_bf16_f32 v76, v204, v220
    v_cvt_pk_bf16_f32 v77, v205, v221
    v_mfma_f32_16x16x32_bf16 v[252:255], v[168:171], v[108:111], 0
    v_cvt_pk_bf16_f32 v78, v206, v222
    v_cvt_pk_bf16_f32 v79, v207, v223
    s_mov_b64 exec, s[40:41]
    v_cvt_pk_bf16_f32 v64, v224, v240
    v_cvt_pk_bf16_f32 v65, v225, v241
    v_cvt_pk_bf16_f32 v66, v226, v242
    v_cvt_pk_bf16_f32 v67, v227, v243
    v_cvt_pk_bf16_f32 v68, v228, v244
    v_cvt_pk_bf16_f32 v69, v229, v245
    v_cvt_pk_bf16_f32 v70, v230, v246
    v_cvt_pk_bf16_f32 v71, v231, v247
    v_cvt_pk_bf16_f32 v72, v232, v248
    v_cvt_pk_bf16_f32 v73, v233, v249
    v_cvt_pk_bf16_f32 v74, v234, v250
    v_cvt_pk_bf16_f32 v75, v235, v251
    v_cvt_pk_bf16_f32 v76, v236, v252
    v_cvt_pk_bf16_f32 v77, v237, v253
    v_cvt_pk_bf16_f32 v78, v238, v254
    v_cvt_pk_bf16_f32 v79, v239, v255
    s_mov_b64 exec, -1
    ds_write2_b32 v44, v64, v65 offset0:0 offset1:32
    ds_write2_b32 v44, v66, v67 offset0:64 offset1:96
    ds_write_b32 v44, v68 offset:2368
    ds_write_b32 v44, v69 offset:2496
    ds_write_b32 v44, v70 offset:2624
    ds_write_b32 v44, v71 offset:2752
    ds_write2_b32 v45, v72, v73 offset0:0 offset1:32
    ds_write2_b32 v45, v74, v75 offset0:64 offset1:96
    ds_write_b32 v45, v76 offset:2368
    ds_write_b32 v45, v77 offset:2496
    ds_write_b32 v45, v78 offset:2624
    ds_write_b32 v45, v79 offset:2752
    s_waitcnt lgkmcnt(0)
    s_barrier
    ds_read2st64_b32 v[96:97], v47 offset0:0 offset1:19
    ds_read2st64_b32 v[98:99], v47 offset0:38 offset1:57
    ds_read2st64_b32 v[100:101], v47 offset0:2 offset1:21
    ds_read2st64_b32 v[102:103], v47 offset0:40 offset1:59
    ds_read2st64_b32 v[104:105], v47 offset0:4 offset1:23
    ds_read2st64_b32 v[106:107], v47 offset0:42 offset1:61
    ds_read2st64_b32 v[108:109], v47 offset0:6 offset1:25
    ds_read2st64_b32 v[110:111], v47 offset0:44 offset1:63
    s_waitcnt lgkmcnt(6)
    buffer_store_dwordx4 v[96:99], v48, s[20:23], s36 offen sc1
    s_add_u32 s36, s36, 1048576
    s_waitcnt lgkmcnt(4)
    buffer_store_dwordx4 v[100:103], v48, s[20:23], s36 offen sc1
    s_add_u32 s36, s36, 1048576
    s_waitcnt lgkmcnt(2)
    buffer_store_dwordx4 v[104:107], v48, s[20:23], s36 offen sc1
    s_add_u32 s36, s36, 1048576
    s_waitcnt lgkmcnt(0)
    buffer_store_dwordx4 v[108:111], v48, s[20:23], s36 offen sc1
    s_add_u32 s36, s36, 1048576
    s_waitcnt vmcnt(0)
    s_barrier
    s_cmp_lg_u32 s3, 0
    s_cbranch_scc1 adaLN_cond__spectral_gfnet__mixer_channel_mlp__prompt_kernel_sig38
    s_lshl_b32 s64, s58, 7
    s_add_u32 s64, s64, 458752
    v_mov_b32 v4, 0
    v_mov_b32 v5, 1
    s_mov_b64 exec, 1
    buffer_store_dword v5, v4, s[20:23], s64 offen sc1
    s_mov_b64 exec, -1
adaLN_cond__spectral_gfnet__mixer_channel_mlp__prompt_kernel_sig38:
    v_mov_b32 v4, 93184
    ds_read_b32 v5, v4
    s_waitcnt lgkmcnt(0)
    v_readfirstlane_b32 s62, v5
    s_nop 0
    s_lshr_b32 s63, s62, 16
    s_and_b32 s62, s62, 0xffff
    s_lshl_b32 s65, s63, 5
    s_add_u32 s65, s65, s62
    s_cmp_lt_u32 s62, 32
    s_cbranch_scc1 adaLN_cond__spectral_gfnet__mixer_channel_mlp__prompt_kernel_rok39
    s_mov_b32 s68, s62
    s_mov_b32 s62, 458752
    v_lshlrev_b32 v4, 7, v2
    v_and_b32 v4, 8191, v4
    s_mov_b32 s64, 0
adaLN_cond__spectral_gfnet__mixer_channel_mlp__prompt_kernel_poll40:
    buffer_load_dword v5, v4, s[20:23], s62 offen sc1
    s_add_u32 s64, s64, 1
    s_waitcnt vmcnt(0)
    v_cmp_eq_u32 vcc, 0, v5
    s_cmp_ge_u32 s64, 100000
    s_cbranch_scc1 adaLN_cond__spectral_gfnet__mixer_channel_mlp__prompt_kernel_pollx41
    s_nop 2
    s_cbranch_vccnz adaLN_cond__spectral_gfnet__mixer_channel_mlp__prompt_kernel_poll40
adaLN_cond__spectral_gfnet__mixer_channel_mlp__prompt_kernel_pollx41:
    s_mov_b32 s62, 466944
    v_lshlrev_b32 v4, 7, v2
    v_and_b32 v4, 8191, v4
    s_mov_b32 s64, 0
adaLN_cond__spectral_gfnet__mixer_channel_mlp__prompt_kernel_poll42:
    buffer_load_dword v5, v4, s[20:23], s62 offen sc1
    s_add_u32 s64, s64, 1
    s_waitcnt vmcnt(0)
    v_cmp_eq_u32 vcc, 0, v5
    s_cmp_ge_u32 s64, 100000
    s_cbranch_scc1 adaLN_cond__spectral_gfnet__mixer_channel_mlp__prompt_kernel_pollx43
    s_nop 2
    s_cbranch_vccnz adaLN_cond__spectral_gfnet__mixer_channel_mlp__prompt_kernel_poll42
adaLN_cond__spectral_gfnet__mixer_channel_mlp__prompt_kernel_pollx43:
    s_mov_b32 s62, 475136
    v_lshlrev_b32 v4, 7, v2
    v_and_b32 v4, 8191, v4
    s_mov_b32 s64, 0
adaLN_cond__spectral_gfnet__mixer_channel_mlp__prompt_kernel_poll44:
    buffer_load_dword v5, v4, s[20:23], s62 offen sc1
    s_add_u32 s64, s64, 1
    s_waitcnt vmcnt(0)
    v_cmp_eq_u32 vcc, 0, v5
    s_cmp_ge_u32 s64, 100000
    s_cbranch_scc1 adaLN_cond__spectral_gfnet__mixer_channel_mlp__prompt_kernel_pollx45
    s_nop 2
    s_cbranch_vccnz adaLN_cond__spectral_gfnet__mixer_channel_mlp__prompt_kernel_poll44
adaLN_cond__spectral_gfnet__mixer_channel_mlp__prompt_kernel_pollx45:
    s_mov_b32 s62, 483328
    v_lshlrev_b32 v4, 7, v2
    v_and_b32 v4, 8191, v4
    s_mov_b32 s64, 0
adaLN_cond__spectral_gfnet__mixer_channel_mlp__prompt_kernel_poll46:
    buffer_load_dword v5, v4, s[20:23], s62 offen sc1
    s_add_u32 s64, s64, 1
    s_waitcnt vmcnt(0)
    v_cmp_eq_u32 vcc, 0, v5
    s_cmp_ge_u32 s64, 100000
    s_cbranch_scc1 adaLN_cond__spectral_gfnet__mixer_channel_mlp__prompt_kernel_pollx47
    s_nop 2
    s_cbranch_vccnz adaLN_cond__spectral_gfnet__mixer_channel_mlp__prompt_kernel_poll46
adaLN_cond__spectral_gfnet__mixer_channel_mlp__prompt_kernel_pollx47:
    v_lshlrev_b32 v4, 7, v2
    s_mov_b32 s62, 589824
    buffer_load_dword v5, v4, s[20:23], s62 offen sc1
    s_waitcnt vmcnt(0)
    s_sub_u32 s68, s68, 32
    v_readlane_b32 s62, v5, 0
    s_nop 0
    s_max_u32 s62, s62, 32
    s_sub_u32 s62, s62, 32
    s_cmp_gt_u32 s63, 0
    s_cselect_b32 s62, s62, 0
    s_add_u32 s68, s68, s62
    v_readlane_b32 s62, v5, 1
    s_nop 0
    s_max_u32 s62, s62, 32
    s_sub_u32 s62, s62, 32
    s_cmp_gt_u32 s63, 1
    s_cselect_b32 s62, s62, 0
    s_add_u32 s68, s68, s62
    v_readlane_b32 s62, v5, 2
    s_nop 0
    s_max_u32 s62, s62, 32
    s_sub_u32 s62, s62, 32
    s_cmp_gt_u32 s63, 2
    s_cselect_b32 s62, s62, 0
    s_add_u32 s68, s68, s62
    v_readlane_b32 s62, v5, 3
    s_nop 0
    s_max_u32 s62, s62, 32
    s_sub_u32 s62, s62, 32
    s_cmp_gt_u32 s63, 3
    s_cselect_b32 s62, s62, 0
    s_add_u32 s68, s68, s62
    v_readlane_b32 s62, v5, 4
    s_nop 0
    s_max_u32 s62, s62, 32
    s_sub_u32 s62, s62, 32
    s_cmp_gt_u32 s63, 4
    s_cselect_b32 s62, s62, 0
    s_add_u32 s68, s68, s62
    v_readlane_b32 s62, v5, 5
    s_nop 0
    s_max_u32 s62, s62, 32
    s_sub_u32 s62, s62, 32
    s_cmp_gt_u32 s63, 5
    s_cselect_b32 s62, s62, 0
    s_add_u32 s68, s68, s62
    v_readlane_b32 s62, v5, 6
    s_nop 0
    s_max_u32 s62, s62, 32
    s_sub_u32 s62, s62, 32
    s_cmp_gt_u32 s63, 6
    s_cselect_b32 s62, s62, 0
    s_add_u32 s68, s68, s62
    s_mov_b32 s65, 0
    v_readlane_b32 s62, v5, 0
    s_nop 0
    s_min_u32 s62, s62, 32
    s_add_u32 s63, s62, s68
    s_add_u32 s64, s63, 0
    s_cmp_lt_u32 s63, 32
    s_cselect_b32 s65, s64, s65
    s_cselect_b32 s63, 0x10000, s63
    s_sub_u32 s68, s63, 32
    v_readlane_b32 s62, v5, 1
    s_nop 0
    s_min_u32 s62, s62, 32
    s_add_u32 s63, s62, s68
    s_add_u32 s64, s63, 32
    s_cmp_lt_u32 s63, 32
    s_cselect_b32 s65, s64, s65
    s_cselect_b32 s63, 0x10000, s63
    s_sub_u32 s68, s63, 32
    v_readlane_b32 s62, v5, 2
    s_nop 0
    s_min_u32 s62, s62, 32
    s_add_u32 s63, s62, s68
    s_add_u32 s64, s63, 64
    s_cmp_lt_u32 s63, 32
    s_cselect_b32 s65, s64, s65
    s_cselect_b32 s63, 0x10000, s63
    s_sub_u32 s68, s63, 32
    v_readlane_b32 s62, v5, 3
    s_nop 0
    s_min_u32 s62, s62, 32
    s_add_u32 s63, s62, s68
    s_add_u32 s64, s63, 96
    s_cmp_lt_u32 s63, 32
    s_cselect_b32 s65, s64, s65
    s_cselect_b32 s63, 0x10000, s63
    s_sub_u32 s68, s63, 32
    v_readlane_b32 s62, v5, 4
    s_nop 0
    s_min_u32 s62, s62, 32
    s_add_u32 s63, s62, s68
    s_add_u32 s64, s63, 128
    s_cmp_lt_u32 s63, 32
    s_cselect_b32 s65, s64, s65
    s_cselect_b32 s63, 0x10000, s63
    s_sub_u32 s68, s63, 32
    v_readlane_b32 s62, v5, 5
    s_nop 0
    s_min_u32 s62, s62, 32
    s_add_u32 s63, s62, s68
    s_add_u32 s64, s63, 160
    s_cmp_lt_u32 s63, 32
    s_cselect_b32 s65, s64, s65
    s_cselect_b32 s63, 0x10000, s63
    s_sub_u32 s68, s63, 32
    v_readlane_b32 s62, v5, 6
    s_nop 0
    s_min_u32 s62, s62, 32
    s_add_u32 s63, s62, s68
    s_add_u32 s64, s63, 192
    s_cmp_lt_u32 s63, 32
    s_cselect_b32 s65, s64, s65
    s_cselect_b32 s63, 0x10000, s63
    s_sub_u32 s68, s63, 32
    v_readlane_b32 s62, v5, 7
    s_nop 0
    s_min_u32 s62, s62, 32
    s_add_u32 s63, s62, s68
    s_add_u32 s64, s63, 224
    s_cmp_lt_u32 s63, 32
    s_cselect_b32 s65, s64, s65
    s_cselect_b32 s63, 0x10000, s63
    s_sub_u32 s68, s63, 32
adaLN_cond__spectral_gfnet__mixer_channel_mlp__prompt_kernel_rok39:
    s_bfe_u32 s59, s65, 0x10005
    s_lshl_b32 s59, s59, 3
    s_and_b32 s58, s65, 7
    s_add_u32 s59, s59, s58
    s_lshr_b32 s60, s65, 6
    s_lshl_b32 s60, s60, 2
    s_bfe_u32 s58, s65, 0x20003
    s_add_u32 s60, s60, s58
    s_lshl_b32 s58, s59, 4
    s_add_u32 s58, s58, s60
    v_lshlrev_b32 v3, 4, v2
    s_lshr_b32 s30, s3, 1
    s_and_b32 s31, s3, 1
    s_mov_b32 s43, s58
    s_lshl_b32 s32, s43, 1
    s_add_u32 s32, s32, s30
    s_and_b32 s42, s32, 31
    s_cmp_gt_u32 s42, 16
    s_cselect_b32 s42, 0x80008000, 0
    s_cmp_eq_u32 s32, 0
    s_cselect_b32 s45, 1, 0
    s_cselect_b32 s32, 512, s32
    s_mul_i32 s32, s32, 8192
    s_lshl_b32 s35, s31, 12
    s_add_u32 s35, s35, s32
    v_bfe_u32 v235, v2, 3, 2
    v_lshlrev_b32 v235, 4, v235
    v_xor_b32 v235, v235, v3
    s_lshr_b32 s33, s43, 1
    s_lshl_b32 s33, s33, 15
    s_and_b32 s34, s43, 1
    s_lshl_b32 s34, s34, 6
    s_add_u32 s33, s33, s34
    s_lshl_b32 s34, s3, 13
    v_and_b32 v236, 0x3c0, v235
    v_add_u32 v235, v235, v236
    s_add_u32 s33, s33, s34
    s_add_u32 s33, s33, 9453568
    s_add_u32 s35, s35, 5242880
    s_lshl_b32 s37, s3, 12
    s_add_u32 s37, s37, 126976
    v_and_b32 v5, 15, v2
    v_lshrrev_b32 v6, 4, v2
    s_lshl_b32 s38, s31, 4
    v_add_u32 v7, s38, v5
    v_cvt_f32_u32 v224, v7
    v_mul_f32 v224, 0x3a000000, v224
    v_add_f32 v225, 0x3c800000, v224
    v_lshlrev_b32 v7, 2, v6
    v_cvt_f32_u32 v226, v7
    v_mul_f32 v227, v226, v224
    v_mul_f32 v228, v226, v225
    v_cos_f32 v88, v227
    v_sin_f32 v104, v227
    v_fmamk_f32 v231, v224, 0x3f800000, v227
    v_cos_f32 v89, v231
    v_sin_f32 v105, v231
    v_fmamk_f32 v230, v224, 0x40000000, v227
    v_cos_f32 v90, v230
    v_sin_f32 v106, v230
    v_fmamk_f32 v231, v224, 0x40400000, v227
    v_cos_f32 v91, v231
    v_sin_f32 v107, v231
    v_fmamk_f32 v230, v224, 0x41800000, v227
    v_cos_f32 v92, v230
    v_sin_f32 v108, v230
    v_fmamk_f32 v231, v224, 0x41880000, v227
    v_cos_f32 v93, v231
    v_sin_f32 v109, v231
    v_fmamk_f32 v230, v224, 0x41900000, v227
    v_cos_f32 v94, v230
    v_sin_f32 v110, v230
    v_fmamk_f32 v231, v224, 0x41980000, v227
    v_cos_f32 v95, v231
    v_sin_f32 v111, v231
    v_cos_f32 v96, v228
    v_sin_f32 v112, v228
    v_fmamk_f32 v231, v225, 0x3f800000, v228
    v_cos_f32 v97, v231
    v_sin_f32 v113, v231
    v_fmamk_f32 v230, v225, 0x40000000, v228
    v_cos_f32 v98, v230
    v_sin_f32 v114, v230
    v_fmamk_f32 v231, v225, 0x40400000, v228
    v_cos_f32 v99, v231
    v_sin_f32 v115, v231
    v_fmamk_f32 v230, v225, 0x41800000, v228
    v_cos_f32 v100, v230
    v_sin_f32 v116, v230
    v_fmamk_f32 v231, v225, 0x41880000, v228
    v_cos_f32 v101, v231
    v_sin_f32 v117, v231
    v_fmamk_f32 v230, v225, 0x41900000, v228
    v_cos_f32 v102, v230
    v_sin_f32 v118, v230
    v_fmamk_f32 v231, v225, 0x41980000, v228
    v_cos_f32 v103, v231
    v_sin_f32 v119, v231
    v_cvt_f32_u32 v224, v5
    v_mul_f32 v224, 0x3a000000, v224
    v_add_f32 v225, 0x3c000000, v224
    v_add_u32 v7, s38, v7
    v_cvt_f32_u32 v226, v7
    v_mul_f32 v227, v226, v224
    v_mul_f32 v228, v226, v225
    s_cmp_eq_u32 s31, 1
    s_cselect_b32 s39, 0.5, 0
    v_add_f32 v232, s39, v227
    v_add_f32 v233, s39, v228
    v_cos_f32 v120, v227
    v_sin_f32 v136, v227
    v_fmamk_f32 v231, v224, 0x3f800000, v227
    v_cos_f32 v121, v231
    v_sin_f32 v137, v231
    v_fmamk_f32 v230, v224, 0x40000000, v227
    v_cos_f32 v122, v230
    v_sin_f32 v138, v230
    v_fmamk_f32 v231, v224, 0x40400000, v227
    v_cos_f32 v123, v231
    v_sin_f32 v139, v231
    v_cos_f32 v124, v228
    v_sin_f32 v140, v228
    v_fmamk_f32 v231, v225, 0x3f800000, v228
    v_cos_f32 v125, v231
    v_sin_f32 v141, v231
    v_fmamk_f32 v230, v225, 0x40000000, v228
    v_cos_f32 v126, v230
    v_sin_f32 v142, v230
    v_fmamk_f32 v231, v225, 0x40400000, v228
    v_cos_f32 v127, v231
    v_sin_f32 v143, v231
    v_fmamk_f32 v230, v224, 0x42000000, v232
    v_cos_f32 v128, v230
    v_sin_f32 v144, v230
    v_fmamk_f32 v231, v224, 0x42040000, v232
    v_cos_f32 v129, v231
    v_sin_f32 v145, v231
    v_fmamk_f32 v230, v224, 0x42080000, v232
    v_cos_f32 v130, v230
    v_sin_f32 v146, v230
    v_fmamk_f32 v231, v224, 0x420c0000, v232
    v_cos_f32 v131, v231
    v_sin_f32 v147, v231
    v_fmamk_f32 v230, v225, 0x42000000, v233
    v_cos_f32 v132, v230
    v_sin_f32 v148, v230
    v_fmamk_f32 v231, v225, 0x42040000, v233
    v_cos_f32 v133, v231
    v_sin_f32 v149, v231
    v_fmamk_f32 v230, v225, 0x42080000, v233
    v_cos_f32 v134, v230
    v_sin_f32 v150, v230
    v_fmamk_f32 v231, v225, 0x420c0000, v233
    v_cos_f32 v135, v231
    v_sin_f32 v151, v231
    v_add_u32 v0, 98304, v3
    s_mul_i32 s40, s31, 3072
    v_add_u32 v5, s40, v0
    s_mul_i32 s40, s31, 12288
    v_add_u32 v6, s40, v0
    v_lshlrev_b32 v7, 3, v2
    s_lshl_b32 s40, s3, 11
    s_add_u32 s40, s40, 118784
    v_add_u32 v1, s40, v7
    s_xor_b32 s40, s40, 2048
    v_add_u32 v7, s40, v7
    v_bfe_u32 v4, v2, 1, 2
    s_lshl_b32 s40, s30, 1
    v_xor_b32 v4, s40, v4
    v_lshlrev_b32 v4, 4, v4
    v_lshl_add_u32 v4, v2, 6, v4
    v_add_u32 v4, 126976, v4
    v_xor_b32 v234, 16, v4
    ds_read_b128 v[152:155], v5 offset:0
    ds_read_b128 v[156:159], v5 offset:1024
    ds_read_b128 v[160:163], v5 offset:2048
    ds_read_b128 v[164:167], v5 offset:6144
    ds_read_b128 v[168:171], v5 offset:7168
    ds_read_b128 v[172:175], v5 offset:8192
    ds_read_b128 v[176:179], v0 offset:0
    ds_read_b128 v[180:183], v0 offset:1024
    ds_read_b128 v[184:187], v0 offset:2048
    ds_read_b128 v[188:191], v0 offset:3072
    ds_read_b128 v[192:195], v0 offset:4096
    ds_read_b128 v[196:199], v0 offset:5120
    ds_read_b128 v[200:203], v6 offset:0
    ds_read_b128 v[204:207], v6 offset:1024
    ds_read_b128 v[208:211], v6 offset:2048
    ds_read_b128 v[212:215], v6 offset:3072
    ds_read_b128 v[216:219], v6 offset:4096
    ds_read_b128 v[220:223], v6 offset:5120
    s_mov_b32 m0, s37
    s_lshl_b32 s62, s3, 13
    s_add_u32 s62, s62, 458752
    v_lshlrev_b32 v236, 7, v2
    v_and_b32 v236, 8191, v236
    s_mov_b32 s64, 0
adaLN_cond__spectral_gfnet__mixer_channel_mlp__prompt_kernel_poll48:
    buffer_load_dword v237, v236, s[20:23], s62 offen sc1
    s_add_u32 s64, s64, 1
    s_waitcnt vmcnt(0)
    v_cmp_eq_u32 vcc, 0, v237
    s_cmp_ge_u32 s64, 100000
    s_cbranch_scc1 adaLN_cond__spectral_gfnet__mixer_channel_mlp__prompt_kernel_pollx49
    s_nop 2
    s_cbranch_vccnz adaLN_cond__spectral_gfnet__mixer_channel_mlp__prompt_kernel_poll48
adaLN_cond__spectral_gfnet__mixer_channel_mlp__prompt_kernel_pollx49:
    s_barrier
    s_mov_b32 m0, s37
    s_add_u32 s44, s33, 0
    buffer_load_dwordx4 v235, s[20:23], s44 offen offset:0 sc1 lds
    s_add_u32 s44, s33, 1024
    buffer_load_dwordx4 v235, s[20:23], s44 offen offset:1024 sc1 lds
    s_add_u32 s44, s33, 2048
    buffer_load_dwordx4 v235, s[20:23], s44 offen offset:2048 sc1 lds
    s_add_u32 s44, s33, 3072
    buffer_load_dwordx4 v235, s[20:23], s44 offen offset:3072 sc1 lds
    s_cmp_eq_u32 s45, 0
    s_cbranch_scc1 adaLN_cond__spectral_gfnet__mixer_channel_mlp__prompt_kernel_nb50
    s_add_u32 s46, s35, 8192
    s_lshl_b32 s44, s31, 12
    s_add_u32 m0, s44, 49152
    s_nop 0
    buffer_load_dwordx4 v3, s[20:23], s46 offen offset:0 sc1 lds
    buffer_load_dwordx4 v3, s[20:23], s46 offen offset:1024 sc1 lds
    buffer_load_dwordx4 v3, s[20:23], s46 offen offset:2048 sc1 lds
    buffer_load_dwordx4 v3, s[20:23], s46 offen offset:3072 sc1 lds
adaLN_cond__spectral_gfnet__mixer_channel_mlp__prompt_kernel_nb50:
    buffer_load_dwordx4 v[40:43], v3, s[20:23], s35 offen offset:0 sc1
    buffer_load_dwordx4 v[44:47], v3, s[20:23], s35 offen offset:1024 sc1
    buffer_load_dwordx4 v[48:51], v3, s[20:23], s35 offen offset:2048 sc1
    buffer_load_dwordx4 v[52:55], v3, s[20:23], s35 offen offset:3072 sc1
    s_waitcnt vmcnt(4)
    s_barrier
    ds_read_b128 v[8:11], v4 offset:0
    ds_read_b128 v[12:15], v234 offset:0
    ds_read_b128 v[24:27], v4 offset:8192
    ds_read_b128 v[28:31], v234 offset:8192
    ds_read_b128 v[16:19], v4 offset:4096
    ds_read_b128 v[20:23], v234 offset:4096
    ds_read_b128 v[32:35], v4 offset:12288
    ds_read_b128 v[36:39], v234 offset:12288
    s_waitcnt vmcnt(0) lgkmcnt(6)
    v_lshlrev_b32 v56, 16, v40
    v_mfma_f32_16x16x32_bf16 v[224:227], v[8:11], v[152:155], 0
    v_and_b32 v72, 0xffff0000, v40
    v_lshlrev_b32 v57, 16, v41
    v_mfma_f32_16x16x32_bf16 v[228:231], v[12:15], v[152:155], 0
    v_and_b32 v73, 0xffff0000, v41
    v_lshlrev_b32 v58, 16, v42
    v_mfma_f32_16x16x32_bf16 v[224:227], v[12:15], v[156:159], v[224:227]
    v_and_b32 v74, 0xffff0000, v42
    v_lshlrev_b32 v59, 16, v43
    v_mfma_f32_16x16x32_bf16 v[228:231], v[8:11], v[160:163], v[228:231]
    v_and_b32 v75, 0xffff0000, v43
    s_waitcnt lgkmcnt(4)
    v_lshlrev_b32 v60, 16, v44
    v_mfma_f32_16x16x32_bf16 v[240:243], v[24:27], v[164:167], 0
    v_and_b32 v76, 0xffff0000, v44
    v_lshlrev_b32 v61, 16, v45
    v_mfma_f32_16x16x32_bf16 v[244:247], v[28:31], v[164:167], 0
    v_and_b32 v77, 0xffff0000, v45
    v_lshlrev_b32 v62, 16, v46
    v_mfma_f32_16x16x32_bf16 v[240:243], v[28:31], v[168:171], v[240:243]
    v_and_b32 v78, 0xffff0000, v46
    v_lshlrev_b32 v63, 16, v47
    v_mfma_f32_16x16x32_bf16 v[244:247], v[24:27], v[172:175], v[244:247]
    v_and_b32 v79, 0xffff0000, v47
    s_waitcnt lgkmcnt(0)
    v_lshlrev_b32 v64, 16, v48
    v_mfma_f32_16x16x32_bf16 v[232:235], v[16:19], v[152:155], 0
    v_and_b32 v80, 0xffff0000, v48
    v_lshlrev_b32 v65, 16, v49
    v_mfma_f32_16x16x32_bf16 v[236:239], v[20:23], v[152:155], 0
    v_and_b32 v81, 0xffff0000, v49
    v_lshlrev_b32 v66, 16, v50
    v_mfma_f32_16x16x32_bf16 v[232:235], v[20:23], v[156:159], v[232:235]
    v_and_b32 v82, 0xffff0000, v50
    v_lshlrev_b32 v67, 16, v51
    v_mfma_f32_16x16x32_bf16 v[236:239], v[16:19], v[160:163], v[236:239]
    v_and_b32 v83, 0xffff0000, v51
    v_lshlrev_b32 v68, 16, v52
    v_mfma_f32_16x16x32_bf16 v[248:251], v[32:35], v[164:167], 0
    v_and_b32 v84, 0xffff0000, v52
    v_lshlrev_b32 v69, 16, v53
    v_mfma_f32_16x16x32_bf16 v[252:255], v[36:39], v[164:167], 0
    v_and_b32 v85, 0xffff0000, v53
    v_lshlrev_b32 v70, 16, v54
    v_mfma_f32_16x16x32_bf16 v[248:251], v[36:39], v[168:171], v[248:251]
    v_and_b32 v86, 0xffff0000, v54
    v_lshlrev_b32 v71, 16, v55
    v_mfma_f32_16x16x32_bf16 v[252:255], v[32:35], v[172:175], v[252:255]
    v_and_b32 v87, 0xffff0000, v55
    v_pk_add_f32 v[8:9], v[224:225], v[240:241]
    v_pk_add_f32 v[24:25], v[224:225], v[240:241] neg_lo:[0,1] neg_hi:[0,1]
    v_pk_add_f32 v[10:11], v[226:227], v[242:243]
    v_pk_add_f32 v[26:27], v[226:227], v[242:243] neg_lo:[0,1] neg_hi:[0,1]
    v_pk_add_f32 v[12:13], v[228:229], v[244:245]
    v_pk_add_f32 v[28:29], v[228:229], v[244:245] neg_lo:[0,1] neg_hi:[0,1]
    v_pk_add_f32 v[14:15], v[230:231], v[246:247]
    v_pk_add_f32 v[30:31], v[230:231], v[246:247] neg_lo:[0,1] neg_hi:[0,1]
    v_pk_add_f32 v[16:17], v[232:233], v[248:249]
    v_pk_add_f32 v[32:33], v[232:233], v[248:249] neg_lo:[0,1] neg_hi:[0,1]
    v_pk_add_f32 v[18:19], v[234:235], v[250:251]
    v_pk_add_f32 v[34:35], v[234:235], v[250:251] neg_lo:[0,1] neg_hi:[0,1]
    v_pk_add_f32 v[20:21], v[236:237], v[252:253]
    v_pk_add_f32 v[36:37], v[236:237], v[252:253] neg_lo:[0,1] neg_hi:[0,1]
    v_pk_add_f32 v[22:23], v[238:239], v[254:255]
    v_pk_add_f32 v[38:39], v[238:239], v[254:255] neg_lo:[0,1] neg_hi:[0,1]
    v_pk_mul_f32 v[224:225], v[8:9], v[88:89]
    v_pk_mul_f32 v[228:229], v[12:13], v[88:89]
    v_pk_mul_f32 v[226:227], v[10:11], v[90:91]
    v_pk_mul_f32 v[230:231], v[14:15], v[90:91]
    v_pk_mul_f32 v[232:233], v[16:17], v[92:93]
    v_pk_mul_f32 v[236:237], v[20:21], v[92:93]
    v_pk_mul_f32 v[234:235], v[18:19], v[94:95]
    v_pk_mul_f32 v[238:239], v[22:23], v[94:95]
    v_pk_fma_f32 v[228:229], v[8:9], v[104:105], v[228:229] neg_lo:[1,0,0] neg_hi:[1,0,0]
    v_pk_fma_f32 v[230:231], v[10:11], v[106:107], v[230:231] neg_lo:[1,0,0] neg_hi:[1,0,0]
    v_pk_fma_f32 v[236:237], v[16:17], v[108:109], v[236:237] neg_lo:[1,0,0] neg_hi:[1,0,0]
    v_pk_fma_f32 v[238:239], v[18:19], v[110:111], v[238:239] neg_lo:[1,0,0] neg_hi:[1,0,0]
    v_pk_fma_f32 v[224:225], v[12:13], v[104:105], v[224:225]
    v_pk_fma_f32 v[226:227], v[14:15], v[106:107], v[226:227]
    v_pk_fma_f32 v[232:233], v[20:21], v[108:109], v[232:233]
    v_pk_fma_f32 v[234:235], v[22:23], v[110:111], v[234:235]
    v_cvt_pk_bf16_f32 v40, v224, v225
    v_cvt_pk_bf16_f32 v41, v226, v227
    v_cvt_pk_bf16_f32 v42, v232, v233
    v_cvt_pk_bf16_f32 v43, v234, v235
    v_cvt_pk_bf16_f32 v44, v228, v229
    v_cvt_pk_bf16_f32 v45, v230, v231
    v_cvt_pk_bf16_f32 v46, v236, v237
    v_cvt_pk_bf16_f32 v47, v238, v239
    v_pk_mul_f32 v[240:241], v[24:25], v[96:97]
    v_pk_mul_f32 v[244:245], v[28:29], v[96:97]
    v_pk_mul_f32 v[242:243], v[26:27], v[98:99]
    v_pk_mul_f32 v[246:247], v[30:31], v[98:99]
    v_pk_mul_f32 v[248:249], v[32:33], v[100:101]
    v_pk_mul_f32 v[252:253], v[36:37], v[100:101]
    v_pk_mul_f32 v[250:251], v[34:35], v[102:103]
    v_pk_mul_f32 v[254:255], v[38:39], v[102:103]
    v_pk_fma_f32 v[244:245], v[24:25], v[112:113], v[244:245] neg_lo:[1,0,0] neg_hi:[1,0,0]
    v_pk_fma_f32 v[246:247], v[26:27], v[114:115], v[246:247] neg_lo:[1,0,0] neg_hi:[1,0,0]
    v_pk_fma_f32 v[252:253], v[32:33], v[116:117], v[252:253] neg_lo:[1,0,0] neg_hi:[1,0,0]
    v_pk_fma_f32 v[254:255], v[34:35], v[118:119], v[254:255] neg_lo:[1,0,0] neg_hi:[1,0,0]
    v_pk_fma_f32 v[240:241], v[28:29], v[112:113], v[240:241]
    v_pk_fma_f32 v[242:243], v[30:31], v[114:115], v[242:243]
    v_pk_fma_f32 v[248:249], v[36:37], v[116:117], v[248:249]
    v_pk_fma_f32 v[250:251], v[38:39], v[118:119], v[250:251]
    s_waitcnt lgkmcnt(6)
    v_cvt_pk_bf16_f32 v48, v240, v241
    v_mfma_f32_16x16x32_bf16 v[8:11], v[176:179], v[40:43], 0
    v_cvt_pk_bf16_f32 v49, v242, v243
    v_mfma_f32_16x16x32_bf16 v[12:15], v[176:179], v[44:47], 0
    v_cvt_pk_bf16_f32 v50, v248, v249
    v_mfma_f32_16x16x32_bf16 v[8:11], v[180:183], v[44:47], v[8:11]
    v_cvt_pk_bf16_f32 v51, v250, v251
    v_mfma_f32_16x16x32_bf16 v[12:15], v[184:187], v[40:43], v[12:15]
    v_cvt_pk_bf16_f32 v52, v244, v245
    v_mfma_f32_16x16x32_bf16 v[16:19], v[188:191], v[40:43], 0
    v_cvt_pk_bf16_f32 v53, v246, v247
    v_mfma_f32_16x16x32_bf16 v[20:23], v[188:191], v[44:47], 0
    v_cvt_pk_bf16_f32 v54, v252, v253
    v_mfma_f32_16x16x32_bf16 v[16:19], v[192:195], v[44:47], v[16:19]
    v_cvt_pk_bf16_f32 v55, v254, v255
    v_mfma_f32_16x16x32_bf16 v[20:23], v[196:199], v[40:43], v[20:23]
    s_cmp_eq_u32 s58, 0
    s_cbranch_scc1 adaLN_cond__spectral_gfnet__mixer_channel_mlp__prompt_kernel_packed51
    v_pk_mul_f32 v[224:225], v[8:9], v[56:57]
    v_pk_mul_f32 v[228:229], v[12:13], v[56:57]
    v_pk_mul_f32 v[226:227], v[10:11], v[58:59]
    v_pk_mul_f32 v[230:231], v[14:15], v[58:59]
    v_pk_mul_f32 v[232:233], v[16:17], v[60:61]
    s_nop 0
    v_pk_mul_f32 v[236:237], v[20:21], v[60:61]
    v_pk_mul_f32 v[234:235], v[18:19], v[62:63]
    v_pk_mul_f32 v[238:239], v[22:23], v[62:63]
    v_pk_fma_f32 v[224:225], v[12:13], v[72:73], v[224:225] neg_lo:[1,0,0] neg_hi:[1,0,0]
    v_pk_fma_f32 v[226:227], v[14:15], v[74:75], v[226:227] neg_lo:[1,0,0] neg_hi:[1,0,0]
    v_pk_fma_f32 v[232:233], v[20:21], v[76:77], v[232:233] neg_lo:[1,0,0] neg_hi:[1,0,0]
    v_pk_fma_f32 v[234:235], v[22:23], v[78:79], v[234:235] neg_lo:[1,0,0] neg_hi:[1,0,0]
    v_pk_fma_f32 v[228:229], v[8:9], v[72:73], v[228:229]
    v_pk_fma_f32 v[230:231], v[10:11], v[74:75], v[230:231]
    v_pk_fma_f32 v[236:237], v[16:17], v[76:77], v[236:237]
    v_pk_fma_f32 v[238:239], v[18:19], v[78:79], v[238:239]
    v_cvt_pk_bf16_f32 v40, v224, v225
    v_mfma_f32_16x16x32_bf16 v[24:27], v[176:179], v[48:51], 0
    v_cvt_pk_bf16_f32 v41, v226, v227
    v_mfma_f32_16x16x32_bf16 v[28:31], v[176:179], v[52:55], 0
    v_cvt_pk_bf16_f32 v42, v232, v233
    v_mfma_f32_16x16x32_bf16 v[24:27], v[180:183], v[52:55], v[24:27]
    v_cvt_pk_bf16_f32 v43, v234, v235
    v_mfma_f32_16x16x32_bf16 v[28:31], v[184:187], v[48:51], v[28:31]
    v_cvt_pk_bf16_f32 v44, v228, v229
    v_mfma_f32_16x16x32_bf16 v[32:35], v[188:191], v[48:51], 0
    v_cvt_pk_bf16_f32 v45, v230, v231
    v_mfma_f32_16x16x32_bf16 v[36:39], v[188:191], v[52:55], 0
    v_cvt_pk_bf16_f32 v46, v236, v237
    v_mfma_f32_16x16x32_bf16 v[32:35], v[192:195], v[52:55], v[32:35]
    v_cvt_pk_bf16_f32 v47, v238, v239
    v_mfma_f32_16x16x32_bf16 v[36:39], v[196:199], v[48:51], v[36:39]
    v_pk_mul_f32 v[240:241], v[24:25], v[64:65]
    v_pk_mul_f32 v[244:245], v[28:29], v[64:65]
    v_pk_mul_f32 v[242:243], v[26:27], v[66:67]
    v_pk_mul_f32 v[246:247], v[30:31], v[66:67]
    s_nop 1
    v_pk_mul_f32 v[248:249], v[32:33], v[68:69]
    s_nop 0
    v_pk_mul_f32 v[252:253], v[36:37], v[68:69]
    v_pk_mul_f32 v[250:251], v[34:35], v[70:71]
    v_pk_mul_f32 v[254:255], v[38:39], v[70:71]
    v_pk_fma_f32 v[240:241], v[28:29], v[80:81], v[240:241] neg_lo:[1,0,0] neg_hi:[1,0,0]
    v_pk_fma_f32 v[242:243], v[30:31], v[82:83], v[242:243] neg_lo:[1,0,0] neg_hi:[1,0,0]
    v_pk_fma_f32 v[248:249], v[36:37], v[84:85], v[248:249] neg_lo:[1,0,0] neg_hi:[1,0,0]
    v_pk_fma_f32 v[250:251], v[38:39], v[86:87], v[250:251] neg_lo:[1,0,0] neg_hi:[1,0,0]
    v_pk_fma_f32 v[244:245], v[24:25], v[80:81], v[244:245]
    v_pk_fma_f32 v[246:247], v[26:27], v[82:83], v[246:247]
    v_pk_fma_f32 v[252:253], v[32:33], v[84:85], v[252:253]
    v_pk_fma_f32 v[254:255], v[34:35], v[86:87], v[254:255]
adaLN_cond__spectral_gfnet__mixer_channel_mlp__prompt_kernel_join52:
    v_cvt_pk_bf16_f32 v48, v240, v241
    v_mfma_f32_16x16x32_bf16 v[8:11], v[40:43], v[176:179], 0
    v_cvt_pk_bf16_f32 v49, v242, v243
    v_mfma_f32_16x16x32_bf16 v[12:15], v[44:47], v[176:179], 0
    v_cvt_pk_bf16_f32 v50, v248, v249
    v_mfma_f32_16x16x32_bf16 v[8:11], v[44:47], v[184:187], v[8:11]
    v_cvt_pk_bf16_f32 v51, v250, v251
    v_mfma_f32_16x16x32_bf16 v[12:15], v[40:43], v[180:183], v[12:15]
    v_cvt_pk_bf16_f32 v52, v244, v245
    v_mfma_f32_16x16x32_bf16 v[16:19], v[40:43], v[188:191], 0
    v_cvt_pk_bf16_f32 v53, v246, v247
    v_mfma_f32_16x16x32_bf16 v[20:23], v[44:47], v[188:191], 0
    v_cvt_pk_bf16_f32 v54, v252, v253
    v_mfma_f32_16x16x32_bf16 v[16:19], v[44:47], v[196:199], v[16:19]
    v_cvt_pk_bf16_f32 v55, v254, v255
    v_mfma_f32_16x16x32_bf16 v[20:23], v[40:43], v[192:195], v[20:23]
    v_mfma_f32_16x16x32_bf16 v[24:27], v[48:51], v[176:179], 0
    v_mfma_f32_16x16x32_bf16 v[28:31], v[52:55], v[176:179], 0
    v_mul_f32 v224, v8, v120
    v_mfma_f32_16x16x32_bf16 v[24:27], v[52:55], v[184:187], v[24:27]
    v_mul_f32 v228, v12, v120
    v_mul_f32 v225, v9, v121
    v_mul_f32 v229, v13, v121
    v_mul_f32 v226, v10, v122
    v_mfma_f32_16x16x32_bf16 v[28:31], v[48:51], v[180:183], v[28:31]
    v_mul_f32 v230, v14, v122
    v_mul_f32 v227, v11, v123
    v_mul_f32 v231, v15, v123
    v_mul_f32 v232, v16, v124
    v_mfma_f32_16x16x32_bf16 v[32:35], v[48:51], v[188:191], 0
    v_mul_f32 v236, v20, v124
    v_mul_f32 v233, v17, v125
    v_mul_f32 v237, v21, v125
    v_mul_f32 v234, v18, v126
    v_mfma_f32_16x16x32_bf16 v[36:39], v[52:55], v[188:191], 0
    v_mul_f32 v238, v22, v126
    v_mul_f32 v235, v19, v127
    v_mul_f32 v239, v23, v127
    v_fma_f32 v224, -v12, v136, v224
    v_mfma_f32_16x16x32_bf16 v[32:35], v[52:55], v[196:199], v[32:35]
    v_fmac_f32 v228, v8, v136
    v_fma_f32 v225, -v13, v137, v225
    v_fmac_f32 v229, v9, v137
    v_fma_f32 v226, -v14, v138, v226
    v_mfma_f32_16x16x32_bf16 v[36:39], v[48:51], v[192:195], v[36:39]
    v_fmac_f32 v230, v10, v138
    v_fma_f32 v227, -v15, v139, v227
    v_fmac_f32 v231, v11, v139
    v_fma_f32 v232, -v20, v140, v232
    v_fmac_f32 v236, v16, v140
    v_fma_f32 v233, -v21, v141, v233
    v_fmac_f32 v237, v17, v141
    v_fma_f32 v234, -v22, v142, v234
    v_fmac_f32 v238, v18, v142
    v_fma_f32 v235, -v23, v143, v235
    v_fmac_f32 v239, v19, v143
    v_pk_mul_f32 v[240:241], v[24:25], v[128:129]
    v_pk_mul_f32 v[244:245], v[28:29], v[128:129]
    v_pk_mul_f32 v[242:243], v[26:27], v[130:131]
    v_pk_mul_f32 v[246:247], v[30:31], v[130:131]
    v_pk_mul_f32 v[248:249], v[32:33], v[132:133]
    v_pk_mul_f32 v[252:253], v[36:37], v[132:133]
    v_pk_mul_f32 v[250:251], v[34:35], v[134:135]
    v_pk_mul_f32 v[254:255], v[38:39], v[134:135]
    v_pk_fma_f32 v[240:241], v[28:29], v[144:145], v[240:241] neg_lo:[1,0,0] neg_hi:[1,0,0]
    v_pk_fma_f32 v[242:243], v[30:31], v[146:147], v[242:243] neg_lo:[1,0,0] neg_hi:[1,0,0]
    v_pk_fma_f32 v[248:249], v[36:37], v[148:149], v[248:249] neg_lo:[1,0,0] neg_hi:[1,0,0]
    v_pk_fma_f32 v[250:251], v[38:39], v[150:151], v[250:251] neg_lo:[1,0,0] neg_hi:[1,0,0]
    v_pk_fma_f32 v[244:245], v[24:25], v[144:145], v[244:245]
    v_pk_fma_f32 v[246:247], v[26:27], v[146:147], v[246:247]
    v_pk_fma_f32 v[252:253], v[32:33], v[148:149], v[252:253]
    v_pk_fma_f32 v[254:255], v[34:35], v[150:151], v[254:255]
    v_pk_add_f32 v[24:25], v[224:225], v[240:241] neg_lo:[0,1] neg_hi:[0,1]
    v_pk_add_f32 v[26:27], v[226:227], v[242:243] neg_lo:[0,1] neg_hi:[0,1]
    v_cvt_pk_bf16_f32 v56, v24, v25
    v_cvt_pk_bf16_f32 v57, v26, v27
    ds_write_b64 v1, v[56:57] offset:0
    v_pk_add_f32 v[28:29], v[228:229], v[244:245] neg_lo:[0,1] neg_hi:[0,1]
    v_pk_add_f32 v[30:31], v[230:231], v[246:247] neg_lo:[0,1] neg_hi:[0,1]
    v_cvt_pk_bf16_f32 v58, v28, v29
    v_cvt_pk_bf16_f32 v59, v30, v31
    ds_write_b64 v1, v[58:59] offset:512
    v_pk_add_f32 v[32:33], v[232:233], v[248:249] neg_lo:[0,1] neg_hi:[0,1]
    v_pk_add_f32 v[34:35], v[234:235], v[250:251] neg_lo:[0,1] neg_hi:[0,1]
    v_cvt_pk_bf16_f32 v60, v32, v33
    v_cvt_pk_bf16_f32 v61, v34, v35
    ds_write_b64 v1, v[60:61] offset:1024
    v_pk_add_f32 v[36:37], v[236:237], v[252:253] neg_lo:[0,1] neg_hi:[0,1]
    v_pk_add_f32 v[38:39], v[238:239], v[254:255] neg_lo:[0,1] neg_hi:[0,1]
    v_cvt_pk_bf16_f32 v62, v36, v37
    v_cvt_pk_bf16_f32 v63, v38, v39
    ds_write_b64 v1, v[62:63] offset:1536
    v_pk_add_f32 v[8:9], v[224:225], v[240:241]
    v_pk_add_f32 v[10:11], v[226:227], v[242:243]
    v_cvt_pk_bf16_f32 v40, v8, v9
    v_cvt_pk_bf16_f32 v41, v10, v11
    v_pk_add_f32 v[12:13], v[228:229], v[244:245]
    v_pk_add_f32 v[14:15], v[230:231], v[246:247]
    v_cvt_pk_bf16_f32 v44, v12, v13
    v_cvt_pk_bf16_f32 v45, v14, v15
    v_pk_add_f32 v[16:17], v[232:233], v[248:249]
    v_pk_add_f32 v[18:19], v[234:235], v[250:251]
    v_cvt_pk_bf16_f32 v48, v16, v17
    v_cvt_pk_bf16_f32 v49, v18, v19
    v_pk_add_f32 v[20:21], v[236:237], v[252:253]
    v_pk_add_f32 v[22:23], v[238:239], v[254:255]
    v_cvt_pk_bf16_f32 v52, v20, v21
    v_cvt_pk_bf16_f32 v53, v22, v23
    s_waitcnt lgkmcnt(0)
    s_barrier
    ds_read_b64 v[42:43], v7 offset:0
    ds_read_b64 v[46:47], v7 offset:512
    ds_read_b64 v[50:51], v7 offset:1024
    ds_read_b64 v[54:55], v7 offset:1536
    s_lshl_b32 s40, s31, 13
    v_add_u32 v4, s40, v4
    v_xor_b32 v5, 16, v4
    v_bfe_u32 v6, v2, 3, 2
    v_and_b32 v7, 3, v2
    v_xor_b32 v6, v6, v7
    v_lshlrev_b32 v6, 4, v6
    v_lshrrev_b32 v7, 2, v2
    v_lshl_add_u32 v6, v7, 6, v6
    v_add_u32 v6, s37, v6
    s_lshl_b32 s40, s43, 14
    s_lshl_b32 s41, s3, 12
    s_add_u32 s40, s40, s41
    s_add_u32 s40, s40, 15728640
    s_waitcnt lgkmcnt(2)
    v_mfma_f32_16x16x32_bf16 v[224:227], v[200:203], v[40:43], 0
    v_mfma_f32_16x16x32_bf16 v[228:231], v[200:203], v[44:47], 0
    v_mfma_f32_16x16x32_bf16 v[224:227], v[208:211], v[44:47], v[224:227]
    v_mfma_f32_16x16x32_bf16 v[228:231], v[204:207], v[40:43], v[228:231]
    v_mfma_f32_16x16x32_bf16 v[232:235], v[212:215], v[40:43], 0
    v_mfma_f32_16x16x32_bf16 v[236:239], v[212:215], v[44:47], 0
    v_mfma_f32_16x16x32_bf16 v[232:235], v[220:223], v[44:47], v[232:235]
    v_mfma_f32_16x16x32_bf16 v[236:239], v[216:219], v[40:43], v[236:239]
    s_waitcnt lgkmcnt(0)
    v_mfma_f32_16x16x32_bf16 v[240:243], v[200:203], v[48:51], 0
    v_mfma_f32_16x16x32_bf16 v[244:247], v[200:203], v[52:55], 0
    v_mfma_f32_16x16x32_bf16 v[240:243], v[208:211], v[52:55], v[240:243]
    v_mfma_f32_16x16x32_bf16 v[244:247], v[204:207], v[48:51], v[244:247]
    v_cvt_pk_bf16_f32 v8, v224, v225
    v_mfma_f32_16x16x32_bf16 v[248:251], v[212:215], v[48:51], 0
    v_cvt_pk_bf16_f32 v9, v228, v229
    v_xor_b32 v9, s42, v9
    v_cvt_pk_bf16_f32 v10, v226, v227
    v_mfma_f32_16x16x32_bf16 v[252:255], v[212:215], v[52:55], 0
    v_cvt_pk_bf16_f32 v11, v230, v231
    v_xor_b32 v11, s42, v11
    ds_write_b128 v4, v[8:11] offset:0
    v_cvt_pk_bf16_f32 v12, v232, v233
    v_mfma_f32_16x16x32_bf16 v[248:251], v[220:223], v[52:55], v[248:251]
    v_cvt_pk_bf16_f32 v13, v236, v237
    v_xor_b32 v13, s42, v13
    v_cvt_pk_bf16_f32 v14, v234, v235
    v_mfma_f32_16x16x32_bf16 v[252:255], v[216:219], v[48:51], v[252:255]
    v_cvt_pk_bf16_f32 v15, v238, v239
    v_xor_b32 v15, s42, v15
    ds_write_b128 v5, v[12:15] offset:0
    v_cvt_pk_bf16_f32 v16, v240, v241
    v_cvt_pk_bf16_f32 v17, v244, v245
    v_xor_b32 v17, s42, v17
    v_cvt_pk_bf16_f32 v18, v242, v243
    v_cvt_pk_bf16_f32 v19, v246, v247
    v_xor_b32 v19, s42, v19
    ds_write_b128 v4, v[16:19] offset:4096
    v_cvt_pk_bf16_f32 v20, v248, v249
    v_cvt_pk_bf16_f32 v21, v252, v253
    v_xor_b32 v21, s42, v21
    v_cvt_pk_bf16_f32 v22, v250, v251
    v_cvt_pk_bf16_f32 v23, v254, v255
    v_xor_b32 v23, s42, v23
    ds_write_b128 v5, v[20:23] offset:4096
    s_waitcnt lgkmcnt(0)
    s_barrier
    ds_read_b128 v[24:27], v6 offset:0
    ds_read_b128 v[28:31], v6 offset:1024
    ds_read_b128 v[32:35], v6 offset:2048
    ds_read_b128 v[36:39], v6 offset:3072
    s_waitcnt lgkmcnt(3)
    buffer_store_dwordx4 v[24:27], v3, s[20:23], s40 offen offset:0 sc1
    s_waitcnt lgkmcnt(2)
    buffer_store_dwordx4 v[28:31], v3, s[20:23], s40 offen offset:1024 sc1
    s_waitcnt lgkmcnt(1)
    buffer_store_dwordx4 v[32:35], v3, s[20:23], s40 offen offset:2048 sc1
    s_waitcnt lgkmcnt(0)
    buffer_store_dwordx4 v[36:39], v3, s[20:23], s40 offen offset:3072 sc1
    s_branch adaLN_cond__spectral_gfnet__mixer_channel_mlp__prompt_kernel_p2done53
adaLN_cond__spectral_gfnet__mixer_channel_mlp__prompt_kernel_packed51:
    v_mfma_f32_16x16x32_bf16 v[24:27], v[176:179], v[48:51], 0
    v_mfma_f32_16x16x32_bf16 v[28:31], v[176:179], v[52:55], 0
    v_mfma_f32_16x16x32_bf16 v[24:27], v[180:183], v[52:55], v[24:27]
    v_mfma_f32_16x16x32_bf16 v[28:31], v[184:187], v[48:51], v[28:31]
    v_mfma_f32_16x16x32_bf16 v[32:35], v[188:191], v[48:51], 0
    v_mfma_f32_16x16x32_bf16 v[36:39], v[188:191], v[52:55], 0
    v_mfma_f32_16x16x32_bf16 v[32:35], v[192:195], v[52:55], v[32:35]
    v_mfma_f32_16x16x32_bf16 v[36:39], v[196:199], v[48:51], v[36:39]
    s_cmp_eq_u32 s45, 0
    s_cbranch_scc1 adaLN_cond__spectral_gfnet__mixer_channel_mlp__prompt_kernel_nosp54
    s_lshl_b32 s44, s31, 12
    s_add_u32 s44, s44, 49152
    v_add_u32 v156, s44, v3
    ds_read_b128 v[88:91], v156 offset:0
    ds_read_b128 v[92:95], v156 offset:1024
    ds_read_b128 v[96:99], v156 offset:2048
    ds_read_b128 v[100:103], v156 offset:3072
    v_and_b32 v152, 15, v2
    v_add_u32 v152, s38, v152
    v_lshrrev_b32 v153, 4, v2
    v_lshl_add_u32 v152, v153, 8, v152
    v_sub_u32 v154, 832, v152
    v_lshlrev_b32 v152, 2, v152
    v_add_u32 v152, 143360, v152
    v_add_u32 v153, 128, v152
    v_lshlrev_b32 v154, 2, v154
    v_add_u32 v154, 143360, v154
    v_subrev_u32 v155, 128, v154
    ds_write2st64_b32 v152, v8, v12 offset0:0 offset1:33
    ds_write2st64_b32 v152, v9, v13 offset0:1 offset1:34
    ds_write2st64_b32 v152, v10, v14 offset0:2 offset1:35
    ds_write2st64_b32 v152, v11, v15 offset0:3 offset1:36
    ds_write2st64_b32 v152, v16, v20 offset0:16 offset1:49
    ds_write2st64_b32 v152, v17, v21 offset0:17 offset1:50
    ds_write2st64_b32 v152, v18, v22 offset0:18 offset1:51
    ds_write2st64_b32 v152, v19, v23 offset0:19 offset1:52
    ds_write2st64_b32 v153, v24, v28 offset0:0 offset1:33
    ds_write2st64_b32 v153, v25, v29 offset0:1 offset1:34
    ds_write2st64_b32 v153, v26, v30 offset0:2 offset1:35
    ds_write2st64_b32 v153, v27, v31 offset0:3 offset1:36
    ds_write2st64_b32 v153, v32, v36 offset0:16 offset1:49
    ds_write2st64_b32 v153, v33, v37 offset0:17 offset1:50
    ds_write2st64_b32 v153, v34, v38 offset0:18 offset1:51
    ds_write2st64_b32 v153, v35, v39 offset0:19 offset1:52
    s_cmp_lg_u32 s31, 0
    s_cbranch_scc1 adaLN_cond__spectral_gfnet__mixer_channel_mlp__prompt_kernel_w155
    s_mov_b64 exec, 1
    ds_write2st64_b32 v152, v8, v12 offset0:32 offset1:65
    s_mov_b64 exec, -1
adaLN_cond__spectral_gfnet__mixer_channel_mlp__prompt_kernel_w155:
adaLN_cond__spectral_gfnet__mixer_channel_mlp__prompt_kernel_nosp54:
    v_pk_mul_f32 v[224:225], v[8:9], v[56:57]
    v_pk_mul_f32 v[228:229], v[12:13], v[56:57]
    v_pk_mul_f32 v[226:227], v[10:11], v[58:59]
    v_pk_mul_f32 v[230:231], v[14:15], v[58:59]
    v_pk_mul_f32 v[232:233], v[16:17], v[60:61]
    v_pk_mul_f32 v[236:237], v[20:21], v[60:61]
    v_pk_mul_f32 v[234:235], v[18:19], v[62:63]
    v_pk_mul_f32 v[238:239], v[22:23], v[62:63]
    v_pk_fma_f32 v[224:225], v[12:13], v[72:73], v[224:225] neg_lo:[1,0,0] neg_hi:[1,0,0]
    v_pk_fma_f32 v[226:227], v[14:15], v[74:75], v[226:227] neg_lo:[1,0,0] neg_hi:[1,0,0]
    v_pk_fma_f32 v[232:233], v[20:21], v[76:77], v[232:233] neg_lo:[1,0,0] neg_hi:[1,0,0]
    v_pk_fma_f32 v[234:235], v[22:23], v[78:79], v[234:235] neg_lo:[1,0,0] neg_hi:[1,0,0]
    v_pk_fma_f32 v[228:229], v[8:9], v[72:73], v[228:229]
    v_pk_fma_f32 v[230:231], v[10:11], v[74:75], v[230:231]
    v_pk_fma_f32 v[236:237], v[16:17], v[76:77], v[236:237]
    v_pk_fma_f32 v[238:239], v[18:19], v[78:79], v[238:239]
    v_pk_mul_f32 v[240:241], v[24:25], v[64:65]
    v_pk_mul_f32 v[244:245], v[28:29], v[64:65]
    v_pk_mul_f32 v[242:243], v[26:27], v[66:67]
    v_pk_mul_f32 v[246:247], v[30:31], v[66:67]
    v_pk_mul_f32 v[248:249], v[32:33], v[68:69]
    v_pk_mul_f32 v[252:253], v[36:37], v[68:69]
    v_pk_mul_f32 v[250:251], v[34:35], v[70:71]
    v_pk_mul_f32 v[254:255], v[38:39], v[70:71]
    v_pk_fma_f32 v[240:241], v[28:29], v[80:81], v[240:241] neg_lo:[1,0,0] neg_hi:[1,0,0]
    v_pk_fma_f32 v[242:243], v[30:31], v[82:83], v[242:243] neg_lo:[1,0,0] neg_hi:[1,0,0]
    v_pk_fma_f32 v[248:249], v[36:37], v[84:85], v[248:249] neg_lo:[1,0,0] neg_hi:[1,0,0]
    v_pk_fma_f32 v[250:251], v[38:39], v[86:87], v[250:251] neg_lo:[1,0,0] neg_hi:[1,0,0]
    v_pk_fma_f32 v[244:245], v[24:25], v[80:81], v[244:245]
    v_pk_fma_f32 v[246:247], v[26:27], v[82:83], v[246:247]
    v_pk_fma_f32 v[252:253], v[32:33], v[84:85], v[252:253]
    v_pk_fma_f32 v[254:255], v[34:35], v[86:87], v[254:255]
    s_waitcnt lgkmcnt(0)
    s_barrier
    s_cmp_eq_u32 s45, 0
    s_cbranch_scc1 adaLN_cond__spectral_gfnet__mixer_channel_mlp__prompt_kernel_nosp256
    ds_read2st64_b32 v[8:9], v154 offset0:19 offset1:52
    ds_read2st64_b32 v[10:11], v154 offset0:18 offset1:51
    ds_read2st64_b32 v[12:13], v154 offset0:17 offset1:50
    ds_read2st64_b32 v[14:15], v154 offset0:16 offset1:49
    ds_read2st64_b32 v[16:17], v154 offset0:3 offset1:36
    ds_read2st64_b32 v[18:19], v154 offset0:2 offset1:35
    ds_read2st64_b32 v[20:21], v154 offset0:1 offset1:34
    ds_read2st64_b32 v[22:23], v154 offset0:0 offset1:33
    ds_read2st64_b32 v[24:25], v155 offset0:19 offset1:52
    ds_read2st64_b32 v[26:27], v155 offset0:18 offset1:51
    ds_read2st64_b32 v[28:29], v155 offset0:17 offset1:50
    ds_read2st64_b32 v[30:31], v155 offset0:16 offset1:49
    ds_read2st64_b32 v[32:33], v155 offset0:3 offset1:36
    ds_read2st64_b32 v[34:35], v155 offset0:2 offset1:35
    ds_read2st64_b32 v[36:37], v155 offset0:1 offset1:34
    ds_read2st64_b32 v[38:39], v155 offset0:0 offset1:33
    s_waitcnt vmcnt(0)
    v_lshlrev_b32 v56, 16, v88
    v_and_b32 v72, 0xffff0000, v88
    v_lshlrev_b32 v57, 16, v89
    v_and_b32 v73, 0xffff0000, v89
    v_lshlrev_b32 v58, 16, v90
    v_and_b32 v74, 0xffff0000, v90
    v_lshlrev_b32 v59, 16, v91
    v_and_b32 v75, 0xffff0000, v91
    v_lshlrev_b32 v60, 16, v92
    v_and_b32 v76, 0xffff0000, v92
    v_lshlrev_b32 v61, 16, v93
    v_and_b32 v77, 0xffff0000, v93
    v_lshlrev_b32 v62, 16, v94
    v_and_b32 v78, 0xffff0000, v94
    v_lshlrev_b32 v63, 16, v95
    v_and_b32 v79, 0xffff0000, v95
    v_lshlrev_b32 v64, 16, v96
    v_and_b32 v80, 0xffff0000, v96
    v_lshlrev_b32 v65, 16, v97
    v_and_b32 v81, 0xffff0000, v97
    v_lshlrev_b32 v66, 16, v98
    v_and_b32 v82, 0xffff0000, v98
    v_lshlrev_b32 v67, 16, v99
    v_and_b32 v83, 0xffff0000, v99
    v_lshlrev_b32 v68, 16, v100
    v_and_b32 v84, 0xffff0000, v100
    v_lshlrev_b32 v69, 16, v101
    v_and_b32 v85, 0xffff0000, v101
    v_lshlrev_b32 v70, 16, v102
    v_and_b32 v86, 0xffff0000, v102
    v_lshlrev_b32 v71, 16, v103
    v_and_b32 v87, 0xffff0000, v103
    s_waitcnt lgkmcnt(0)
    v_fmac_f32 v224, v8, v56
    v_fmac_f32 v228, v8, v72
    v_fmac_f32 v224, v9, v72
    v_fma_f32 v228, -v9, v56, v228
    v_fmac_f32 v225, v10, v57
    v_fmac_f32 v229, v10, v73
    v_fmac_f32 v225, v11, v73
    v_fma_f32 v229, -v11, v57, v229
    v_fmac_f32 v226, v12, v58
    v_fmac_f32 v230, v12, v74
    v_fmac_f32 v226, v13, v74
    v_fma_f32 v230, -v13, v58, v230
    v_fmac_f32 v227, v14, v59
    v_fmac_f32 v231, v14, v75
    v_fmac_f32 v227, v15, v75
    v_fma_f32 v231, -v15, v59, v231
    v_fmac_f32 v232, v16, v60
    v_fmac_f32 v236, v16, v76
    v_fmac_f32 v232, v17, v76
    v_fma_f32 v236, -v17, v60, v236
    v_fmac_f32 v233, v18, v61
    v_fmac_f32 v237, v18, v77
    v_fmac_f32 v233, v19, v77
    v_fma_f32 v237, -v19, v61, v237
    v_fmac_f32 v234, v20, v62
    v_fmac_f32 v238, v20, v78
    v_fmac_f32 v234, v21, v78
    v_fma_f32 v238, -v21, v62, v238
    v_fmac_f32 v235, v22, v63
    v_fmac_f32 v239, v22, v79
    v_fmac_f32 v235, v23, v79
    v_fma_f32 v239, -v23, v63, v239
    v_fmac_f32 v240, v24, v64
    v_fmac_f32 v244, v24, v80
    v_fmac_f32 v240, v25, v80
    v_fma_f32 v244, -v25, v64, v244
    v_fmac_f32 v241, v26, v65
    v_fmac_f32 v245, v26, v81
    v_fmac_f32 v241, v27, v81
    v_fma_f32 v245, -v27, v65, v245
    v_fmac_f32 v242, v28, v66
    v_fmac_f32 v246, v28, v82
    v_fmac_f32 v242, v29, v82
    v_fma_f32 v246, -v29, v66, v246
    v_fmac_f32 v243, v30, v67
    v_fmac_f32 v247, v30, v83
    v_fmac_f32 v243, v31, v83
    v_fma_f32 v247, -v31, v67, v247
    v_fmac_f32 v248, v32, v68
    v_fmac_f32 v252, v32, v84
    v_fmac_f32 v248, v33, v84
    v_fma_f32 v252, -v33, v68, v252
    v_fmac_f32 v249, v34, v69
    v_fmac_f32 v253, v34, v85
    v_fmac_f32 v249, v35, v85
    v_fma_f32 v253, -v35, v69, v253
    v_fmac_f32 v250, v36, v70
    v_fmac_f32 v254, v36, v86
    v_fmac_f32 v250, v37, v86
    v_fma_f32 v254, -v37, v70, v254
    v_fmac_f32 v251, v38, v71
    v_fmac_f32 v255, v38, v87
    v_fmac_f32 v251, v39, v87
    v_fma_f32 v255, -v39, v71, v255
adaLN_cond__spectral_gfnet__mixer_channel_mlp__prompt_kernel_nosp256:
    v_cvt_pk_bf16_f32 v40, v224, v225
    v_cvt_pk_bf16_f32 v41, v226, v227
    v_cvt_pk_bf16_f32 v42, v232, v233
    v_cvt_pk_bf16_f32 v43, v234, v235
    v_cvt_pk_bf16_f32 v44, v228, v229
    v_cvt_pk_bf16_f32 v45, v230, v231
    v_cvt_pk_bf16_f32 v46, v236, v237
    v_cvt_pk_bf16_f32 v47, v238, v239
    s_branch adaLN_cond__spectral_gfnet__mixer_channel_mlp__prompt_kernel_join52
adaLN_cond__spectral_gfnet__mixer_channel_mlp__prompt_kernel_p2done53:
    s_lshl_b32 s64, s58, 5
    s_add_u32 s64, s64, s3
    s_lshl_b32 s64, s64, 2
    s_add_u32 s64, s64, 491520
    v_mov_b32 v4, 1
    s_waitcnt vmcnt(0)
    s_mov_b64 exec, 1
    buffer_store_dword v4, off, s[20:23], s64 sc1
    s_mov_b64 exec, -1
    s_barrier
    v_and_b32 v6, 15, v2
    v_lshrrev_b32 v7, 4, v2
    v_lshlrev_b32 v3, 4, v2
    s_lshr_b32 s32, s3, 1
    s_lshl_b32 s32, s32, 4
    s_and_b32 s31, s3, 1
    s_lshl_b32 s31, s31, 1
    s_add_u32 s32, s32, s31
    s_bfe_u32 s31, s58, 0x20004
    s_lshl_b32 s31, s31, 2
    s_add_u32 s32, s32, s31
    s_lshl_b32 s32, s32, 6
    s_lshr_b32 s31, s58, 6
    s_lshl_b32 s31, s31, 4
    s_add_u32 s32, s32, s31
    s_add_u32 s32, s32, s60
    s_lshl_b32 s32, s32, 11
    s_add_u32 s33, s32, 131072
    v_lshrrev_b32 v4, 2, v2
    v_lshlrev_b32 v4, 14, v4
    v_and_b32 v5, 3, v2
    v_lshl_add_u32 v4, v5, 4, v4
    s_lshl_b32 s34, s58, 6
    s_add_u32 s34, s34, 15728640
    s_lshl_b32 s35, s3, 20
    s_add_u32 s35, s35, s34
    s_mul_i32 s38, s3, 5120
    v_lshlrev_b32 v8, 6, v6
    v_lshl_add_u32 v9, v7, 4, v8
    v_lshl_add_u32 v8, v7, 3, v8
    s_mov_b32 s16, s10
    s_mov_b32 s17, s11
    s_mov_b32 s18, 4194304
    s_mov_b32 s19, 0x20000
    s_mov_b32 s61, s38
    v_cvt_f32_u32 v48, v6
    v_mul_f32 v48, 0x3a800000, v48
    v_add_f32 v49, 0x3c800000, v48
    v_cvt_f32_u32 v50, v7
    v_mul_f32 v51, v50, v48
    v_mul_f32 v52, v50, v49
    v_cos_f32 v32, v51
    v_sin_f32 v33, v51
    v_cos_f32 v34, v52
    v_sin_f32 v35, v52
    v_fmamk_f32 v53, v48, 0x40800000, v51
    v_cos_f32 v36, v53
    v_sin_f32 v37, v53
    v_fmamk_f32 v54, v49, 0x40800000, v52
    v_cos_f32 v38, v54
    v_sin_f32 v39, v54
    v_fmamk_f32 v53, v48, 0x41000000, v51
    v_cos_f32 v40, v53
    v_sin_f32 v41, v53
    v_fmamk_f32 v54, v49, 0x41000000, v52
    v_cos_f32 v42, v54
    v_sin_f32 v43, v54
    v_fmamk_f32 v53, v48, 0x41400000, v51
    v_cos_f32 v44, v53
    v_sin_f32 v45, v53
    v_fmamk_f32 v54, v49, 0x41400000, v52
    v_cos_f32 v46, v54
    v_sin_f32 v47, v54
    v_lshrrev_b32 v12, 2, v2
    v_mul_u32_u24 v13, 1280, v12
    v_and_b32 v14, 1, v12
    v_lshl_add_u32 v13, v14, 4, v13
    v_bfe_u32 v14, v12, 1, 1
    v_lshl_add_u32 v13, v14, 7, v13
    s_lshl_b32 s39, s3, 3
    s_add_u32 s39, s39, 28672
    v_add_u32 v13, s39, v13
    v_lshl_add_u32 v12, v5, 5, v13
    v_lshlrev_b32 v14, 5, v5
    v_sub_u32 v14, v13, v14
    v_cmp_eq_u32 vcc, 0, v5
    v_add_u32 v15, 1024, v14
    v_add_u32 v13, 512, v13
    v_cndmask_b32 v15, v15, v13, vcc
    v_lshlrev_b32 v10, 7, v6
    v_lshl_add_u32 v10, v7, 4, v10
    s_lshl_b32 s62, s3, 13
    s_add_u32 s62, s62, 491520
    v_lshlrev_b32 v56, 7, v2
    v_and_b32 v56, 8191, v56
    s_mov_b32 s64, 0
adaLN_cond__spectral_gfnet__mixer_channel_mlp__prompt_kernel_poll57:
    buffer_load_dwordx4 v[60:63], v56, s[20:23], s62 offen sc1
    s_add_u32 s64, s64, 1
    s_waitcnt vmcnt(0)
    v_min3_u32 v60, v60, v61, v62
    v_min_u32 v60, v60, v63
    v_cmp_eq_u32 vcc, 0, v60
    s_cmp_ge_u32 s64, 100000
    s_cbranch_scc1 adaLN_cond__spectral_gfnet__mixer_channel_mlp__prompt_kernel_pollx58
    s_nop 2
    s_cbranch_vccnz adaLN_cond__spectral_gfnet__mixer_channel_mlp__prompt_kernel_poll57
adaLN_cond__spectral_gfnet__mixer_channel_mlp__prompt_kernel_pollx58:
    s_barrier
    s_add_u32 m0, s61, 28672
    s_add_u32 s44, s35, 0
    buffer_load_dwordx4 v4, s[20:23], s44 offen sc1 lds
    s_add_u32 m0, s61, 29968
    s_add_u32 s44, s35, 262144
    buffer_load_dwordx4 v4, s[20:23], s44 offen sc1 lds
    s_add_u32 m0, s61, 31360
    s_add_u32 s44, s35, 524288
    buffer_load_dwordx4 v4, s[20:23], s44 offen sc1 lds
    s_add_u32 m0, s61, 32656
    s_add_u32 s44, s35, 786432
    buffer_load_dwordx4 v4, s[20:23], s44 offen sc1 lds
    ds_read_b128 v[72:75], v3 offset:0
    ds_read_b128 v[76:79], v3 offset:1024
    ds_read_b128 v[80:83], v3 offset:2048
    ds_read_b128 v[84:87], v3 offset:3072
    ds_read_b128 v[88:91], v3 offset:4096
    ds_read_b128 v[92:95], v3 offset:5120
    ds_read_b128 v[96:99], v3 offset:6144
    ds_read_b128 v[100:103], v3 offset:7168
    ds_read_b128 v[104:107], v3 offset:8192
    ds_read_b128 v[108:111], v3 offset:9216
    ds_read_b128 v[112:115], v3 offset:10240
    ds_read_b128 v[116:119], v3 offset:11264
    ds_read_b128 v[120:123], v3 offset:12288
    ds_read_b128 v[124:127], v3 offset:13312
    buffer_load_dwordx2 v[16:17], v8, s[16:19], s32 offen offset:0
    buffer_load_dwordx2 v[18:19], v8, s[16:19], s32 offen offset:32
    buffer_load_dwordx2 v[20:21], v8, s[16:19], s32 offen offset:1024
    buffer_load_dwordx2 v[22:23], v8, s[16:19], s32 offen offset:1056
    buffer_load_dwordx2 v[24:25], v8, s[16:19], s33 offen offset:0
    buffer_load_dwordx2 v[26:27], v8, s[16:19], s33 offen offset:32
    buffer_load_dwordx2 v[28:29], v8, s[16:19], s33 offen offset:1024
    buffer_load_dwordx2 v[30:31], v8, s[16:19], s33 offen offset:1056
    s_lshr_b32 s36, s3, 1
    s_mul_i32 s37, s60, 448
    s_lshl_b32 s38, s36, 8
    s_add_u32 s38, s38, s37
    s_lshl_b32 s39, s36, 5
    s_add_u32 s39, s39, s37
    v_lshlrev_b32 v254, 3, v7
    s_mov_b32 s24, s6
    s_mov_b32 s25, s7
    s_mov_b32 s26, 7168
    s_mov_b32 s27, 0x20000
    buffer_load_dwordx2 v[240:241], v254, s[24:27], s38 offen offset:0
    buffer_load_dwordx2 v[242:243], v254, s[24:27], s38 offen offset:32
    buffer_load_dwordx2 v[244:245], v254, s[24:27], s38 offen offset:64
    buffer_load_dwordx2 v[246:247], v254, s[24:27], s38 offen offset:96
    buffer_load_dwordx2 v[248:249], v254, s[24:27], s38 offen offset:128
    buffer_load_dwordx2 v[250:251], v254, s[24:27], s38 offen offset:160
    buffer_load_dwordx2 v[252:253], v254, s[24:27], s39 offen offset:192
    s_waitcnt vmcnt(15)
    s_barrier
    ds_read_b64_tr_b16 v[56:57], v12 offset:0
    ds_read_b64_tr_b16 v[58:59], v15
    ds_read_b64_tr_b16 v[60:61], v12 offset:128
    ds_read_b64_tr_b16 v[62:63], v14 offset:896
    ds_read_b64_tr_b16 v[64:65], v12 offset:256
    ds_read_b64_tr_b16 v[66:67], v14 offset:768
    ds_read_b64_tr_b16 v[68:69], v12 offset:384
    ds_read_b64_tr_b16 v[70:71], v14 offset:640
    s_waitcnt lgkmcnt(6)
    v_mfma_f32_16x16x32_bf16 v[132:135], v[56:59], v[72:75], 0
    v_mfma_f32_16x16x32_bf16 v[128:131], v[56:59], v[76:79], 0
    v_mfma_f32_16x16x32_bf16 v[140:143], v[56:59], v[80:83], 0
    v_mfma_f32_16x16x32_bf16 v[136:139], v[56:59], v[84:87], 0
    s_waitcnt lgkmcnt(4)
    v_mfma_f32_16x16x32_bf16 v[148:151], v[60:63], v[72:75], 0
    v_mfma_f32_16x16x32_bf16 v[144:147], v[60:63], v[76:79], 0
    v_mfma_f32_16x16x32_bf16 v[156:159], v[60:63], v[80:83], 0
    v_mfma_f32_16x16x32_bf16 v[152:155], v[60:63], v[84:87], 0
    s_waitcnt lgkmcnt(2)
    v_mfma_f32_16x16x32_bf16 v[164:167], v[64:67], v[72:75], 0
    v_mfma_f32_16x16x32_bf16 v[160:163], v[64:67], v[76:79], 0
    v_mfma_f32_16x16x32_bf16 v[172:175], v[64:67], v[80:83], 0
    v_mfma_f32_16x16x32_bf16 v[168:171], v[64:67], v[84:87], 0
    s_waitcnt lgkmcnt(0)
    v_mfma_f32_16x16x32_bf16 v[180:183], v[68:71], v[72:75], 0
    v_mfma_f32_16x16x32_bf16 v[176:179], v[68:71], v[76:79], 0
    v_mfma_f32_16x16x32_bf16 v[188:191], v[68:71], v[80:83], 0
    v_mfma_f32_16x16x32_bf16 v[184:187], v[68:71], v[84:87], 0
    s_waitcnt lgkmcnt(2)
    v_mfma_f32_16x16x32_bf16 v[192:195], v[56:59], v[88:91], 0
    v_mfma_f32_16x16x32_bf16 v[196:199], v[56:59], v[92:95], 0
    v_mfma_f32_16x16x32_bf16 v[200:203], v[56:59], v[96:99], 0
    v_mfma_f32_16x16x32_bf16 v[204:207], v[56:59], v[100:103], 0
    v_mfma_f32_16x16x32_bf16 v[208:211], v[56:59], v[104:107], 0
    v_mfma_f32_16x16x32_bf16 v[212:215], v[56:59], v[108:111], 0
    v_mfma_f32_16x16x32_bf16 v[216:219], v[56:59], v[112:115], 0
    v_mfma_f32_16x16x32_bf16 v[220:223], v[56:59], v[116:119], 0
    v_pk_add_f32 v[224:225], v[132:133], v[130:131] neg_lo:[0,1] neg_hi:[0,1]
    v_pk_add_f32 v[226:227], v[134:135], v[128:129]
    v_pk_mul_f32 v[132:133], v[224:225], v[32:33] op_sel_hi:[1,0]
    v_pk_mul_f32 v[134:135], v[226:227], v[32:33] op_sel_hi:[1,0]
    v_pk_fma_f32 v[132:133], v[226:227], v[32:33], v[132:133] op_sel:[0,1,0] op_sel_hi:[1,1,1] neg_lo:[1,0,0] neg_hi:[1,0,0]
    v_pk_fma_f32 v[134:135], v[224:225], v[32:33], v[134:135] op_sel:[0,1,0] op_sel_hi:[1,1,1]
    v_pk_add_f32 v[224:225], v[140:141], v[138:139] neg_lo:[0,1] neg_hi:[0,1]
    v_pk_add_f32 v[226:227], v[142:143], v[136:137]
    v_pk_mul_f32 v[140:141], v[224:225], v[34:35] op_sel_hi:[1,0]
    v_pk_mul_f32 v[142:143], v[226:227], v[34:35] op_sel_hi:[1,0]
    v_pk_fma_f32 v[140:141], v[226:227], v[34:35], v[140:141] op_sel:[0,1,0] op_sel_hi:[1,1,1] neg_lo:[1,0,0] neg_hi:[1,0,0]
    v_pk_fma_f32 v[142:143], v[224:225], v[34:35], v[142:143] op_sel:[0,1,0] op_sel_hi:[1,1,1]
    v_pk_add_f32 v[224:225], v[148:149], v[146:147] neg_lo:[0,1] neg_hi:[0,1]
    v_pk_add_f32 v[226:227], v[150:151], v[144:145]
    v_pk_mul_f32 v[148:149], v[224:225], v[36:37] op_sel_hi:[1,0]
    v_pk_mul_f32 v[150:151], v[226:227], v[36:37] op_sel_hi:[1,0]
    v_pk_fma_f32 v[148:149], v[226:227], v[36:37], v[148:149] op_sel:[0,1,0] op_sel_hi:[1,1,1] neg_lo:[1,0,0] neg_hi:[1,0,0]
    v_pk_fma_f32 v[150:151], v[224:225], v[36:37], v[150:151] op_sel:[0,1,0] op_sel_hi:[1,1,1]
    v_pk_add_f32 v[224:225], v[156:157], v[154:155] neg_lo:[0,1] neg_hi:[0,1]
    v_pk_add_f32 v[226:227], v[158:159], v[152:153]
    v_pk_mul_f32 v[156:157], v[224:225], v[38:39] op_sel_hi:[1,0]
    v_pk_mul_f32 v[158:159], v[226:227], v[38:39] op_sel_hi:[1,0]
    v_pk_fma_f32 v[156:157], v[226:227], v[38:39], v[156:157] op_sel:[0,1,0] op_sel_hi:[1,1,1] neg_lo:[1,0,0] neg_hi:[1,0,0]
    v_pk_fma_f32 v[158:159], v[224:225], v[38:39], v[158:159] op_sel:[0,1,0] op_sel_hi:[1,1,1]
    v_pk_add_f32 v[224:225], v[164:165], v[162:163] neg_lo:[0,1] neg_hi:[0,1]
    v_pk_add_f32 v[226:227], v[166:167], v[160:161]
    v_pk_mul_f32 v[164:165], v[224:225], v[40:41] op_sel_hi:[1,0]
    v_pk_mul_f32 v[166:167], v[226:227], v[40:41] op_sel_hi:[1,0]
    v_pk_fma_f32 v[164:165], v[226:227], v[40:41], v[164:165] op_sel:[0,1,0] op_sel_hi:[1,1,1] neg_lo:[1,0,0] neg_hi:[1,0,0]
    v_pk_fma_f32 v[166:167], v[224:225], v[40:41], v[166:167] op_sel:[0,1,0] op_sel_hi:[1,1,1]
    v_pk_add_f32 v[224:225], v[172:173], v[170:171] neg_lo:[0,1] neg_hi:[0,1]
    v_pk_add_f32 v[226:227], v[174:175], v[168:169]
    v_pk_mul_f32 v[172:173], v[224:225], v[42:43] op_sel_hi:[1,0]
    v_pk_mul_f32 v[174:175], v[226:227], v[42:43] op_sel_hi:[1,0]
    v_pk_fma_f32 v[172:173], v[226:227], v[42:43], v[172:173] op_sel:[0,1,0] op_sel_hi:[1,1,1] neg_lo:[1,0,0] neg_hi:[1,0,0]
    v_pk_fma_f32 v[174:175], v[224:225], v[42:43], v[174:175] op_sel:[0,1,0] op_sel_hi:[1,1,1]
    v_pk_add_f32 v[224:225], v[180:181], v[178:179] neg_lo:[0,1] neg_hi:[0,1]
    v_pk_add_f32 v[226:227], v[182:183], v[176:177]
    v_pk_mul_f32 v[180:181], v[224:225], v[44:45] op_sel_hi:[1,0]
    v_pk_mul_f32 v[182:183], v[226:227], v[44:45] op_sel_hi:[1,0]
    v_pk_fma_f32 v[180:181], v[226:227], v[44:45], v[180:181] op_sel:[0,1,0] op_sel_hi:[1,1,1] neg_lo:[1,0,0] neg_hi:[1,0,0]
    v_pk_fma_f32 v[182:183], v[224:225], v[44:45], v[182:183] op_sel:[0,1,0] op_sel_hi:[1,1,1]
    v_pk_add_f32 v[224:225], v[188:189], v[186:187] neg_lo:[0,1] neg_hi:[0,1]
    v_pk_add_f32 v[226:227], v[190:191], v[184:185]
    v_pk_mul_f32 v[188:189], v[224:225], v[46:47] op_sel_hi:[1,0]
    v_pk_mul_f32 v[190:191], v[226:227], v[46:47] op_sel_hi:[1,0]
    v_pk_fma_f32 v[188:189], v[226:227], v[46:47], v[188:189] op_sel:[0,1,0] op_sel_hi:[1,1,1] neg_lo:[1,0,0] neg_hi:[1,0,0]
    v_pk_fma_f32 v[190:191], v[224:225], v[46:47], v[190:191] op_sel:[0,1,0] op_sel_hi:[1,1,1]
    s_mov_b64 exec, 0xffff
    v_pk_add_f32 v[132:133], v[192:193], v[198:199]
    v_pk_add_f32 v[134:135], v[200:201], v[206:207]
    v_pk_add_f32 v[140:141], v[208:209], v[214:215]
    v_pk_add_f32 v[142:143], v[216:217], v[222:223]
    s_mov_b64 exec, -1
    ds_read_b128 v[192:195], v10 offset:16384
    ds_read_b128 v[196:199], v10 offset:16448
    ds_read_b128 v[200:203], v10 offset:18432
    ds_read_b128 v[204:207], v10 offset:18496
    ds_read_b128 v[208:211], v10 offset:20480
    ds_read_b128 v[212:215], v10 offset:20544
    ds_read_b128 v[216:219], v10 offset:22528
    ds_read_b128 v[220:223], v10 offset:22592
    ds_read_b128 v[224:227], v10 offset:24576
    ds_read_b128 v[228:231], v10 offset:24640
    ds_read_b128 v[232:235], v10 offset:26624
    ds_read_b128 v[236:239], v10 offset:26688
    s_waitcnt lgkmcnt(12)
    v_cvt_pk_bf16_f32 v56, v132, v148
    v_cvt_pk_bf16_f32 v57, v164, v180
    v_cvt_pk_bf16_f32 v58, v134, v150
    v_cvt_pk_bf16_f32 v59, v166, v182
    s_nop 1
    v_mfma_f32_16x16x32_bf16 v[72:75], v[56:59], v[120:123], 0
    v_mfma_f32_16x16x32_bf16 v[80:83], v[56:59], v[124:127], 0
    v_cvt_pk_bf16_f32 v60, v140, v156
    v_cvt_pk_bf16_f32 v61, v172, v188
    v_cvt_pk_bf16_f32 v62, v142, v158
    v_cvt_pk_bf16_f32 v63, v174, v190
    s_nop 1
    v_mfma_f32_16x16x32_bf16 v[76:79], v[60:63], v[120:123], 0
    v_mfma_f32_16x16x32_bf16 v[84:87], v[60:63], v[124:127], 0
    v_cvt_pk_bf16_f32 v64, v133, v149
    v_cvt_pk_bf16_f32 v65, v165, v181
    v_cvt_pk_bf16_f32 v66, v135, v151
    v_cvt_pk_bf16_f32 v67, v167, v183
    s_nop 1
    v_mfma_f32_16x16x32_bf16 v[88:91], v[64:67], v[120:123], 0
    v_mfma_f32_16x16x32_bf16 v[96:99], v[64:67], v[124:127], 0
    v_cvt_pk_bf16_f32 v68, v141, v157
    v_cvt_pk_bf16_f32 v69, v173, v189
    v_cvt_pk_bf16_f32 v70, v143, v159
    v_cvt_pk_bf16_f32 v71, v175, v191
    s_nop 1
    v_mfma_f32_16x16x32_bf16 v[92:95], v[68:71], v[120:123], 0
    v_mfma_f32_16x16x32_bf16 v[100:103], v[68:71], v[124:127], 0
    s_waitcnt vmcnt(7)
    v_lshlrev_b32 v130, 16, v16
    v_and_b32 v131, 0xffff0000, v16
    v_lshlrev_b32 v132, 16, v17
    v_and_b32 v133, 0xffff0000, v17
    v_lshlrev_b32 v134, 16, v18
    v_and_b32 v135, 0xffff0000, v18
    v_lshlrev_b32 v136, 16, v19
    v_and_b32 v137, 0xffff0000, v19
    v_lshlrev_b32 v138, 16, v20
    v_and_b32 v139, 0xffff0000, v20
    v_lshlrev_b32 v140, 16, v21
    v_and_b32 v141, 0xffff0000, v21
    v_lshlrev_b32 v142, 16, v22
    v_and_b32 v143, 0xffff0000, v22
    v_lshlrev_b32 v144, 16, v23
    v_and_b32 v145, 0xffff0000, v23
    v_lshlrev_b32 v146, 16, v24
    v_and_b32 v147, 0xffff0000, v24
    v_lshlrev_b32 v148, 16, v25
    v_and_b32 v149, 0xffff0000, v25
    v_lshlrev_b32 v150, 16, v26
    v_and_b32 v151, 0xffff0000, v26
    v_lshlrev_b32 v152, 16, v27
    v_and_b32 v153, 0xffff0000, v27
    v_lshlrev_b32 v154, 16, v28
    v_and_b32 v155, 0xffff0000, v28
    v_lshlrev_b32 v156, 16, v29
    v_and_b32 v157, 0xffff0000, v29
    v_lshlrev_b32 v158, 16, v30
    v_and_b32 v159, 0xffff0000, v30
    v_lshlrev_b32 v160, 16, v31
    v_and_b32 v161, 0xffff0000, v31
    s_waitcnt lgkmcnt(0)
    s_lshl_b32 s40, s58, 2
    s_add_u32 s40, s40, s3
    s_lshl_b32 s40, s40, 12
    s_add_u32 s42, s40, 25165824
    s_add_u32 s40, s40, 20971520
    v_pk_fma_f32 v[130:131], v[72:73], v[192:193], v[130:131]
    v_pk_fma_f32 v[132:133], v[74:75], v[194:195], v[132:133]
    v_pk_mul_f32 v[164:165], v[130:131], v[130:131]
    v_pk_add_f32 v[162:163], v[130:131], v[132:133]
    v_pk_fma_f32 v[164:165], v[132:133], v[132:133], v[164:165]
    v_pk_fma_f32 v[134:135], v[76:77], v[196:197], v[134:135]
    v_pk_fma_f32 v[136:137], v[78:79], v[198:199], v[136:137]
    v_pk_add_f32 v[162:163], v[162:163], v[134:135]
    v_pk_fma_f32 v[164:165], v[134:135], v[134:135], v[164:165]
    v_pk_add_f32 v[162:163], v[162:163], v[136:137]
    v_pk_fma_f32 v[164:165], v[136:137], v[136:137], v[164:165]
    v_pk_fma_f32 v[138:139], v[80:81], v[200:201], v[138:139]
    v_pk_fma_f32 v[140:141], v[82:83], v[202:203], v[140:141]
    v_pk_add_f32 v[162:163], v[162:163], v[138:139]
    v_pk_fma_f32 v[164:165], v[138:139], v[138:139], v[164:165]
    v_pk_add_f32 v[162:163], v[162:163], v[140:141]
    v_pk_fma_f32 v[164:165], v[140:141], v[140:141], v[164:165]
    v_pk_fma_f32 v[142:143], v[84:85], v[204:205], v[142:143]
    v_pk_fma_f32 v[144:145], v[86:87], v[206:207], v[144:145]
    v_pk_add_f32 v[162:163], v[162:163], v[142:143]
    v_pk_fma_f32 v[164:165], v[142:143], v[142:143], v[164:165]
    v_pk_add_f32 v[162:163], v[162:163], v[144:145]
    v_pk_fma_f32 v[164:165], v[144:145], v[144:145], v[164:165]
    v_pk_fma_f32 v[146:147], v[88:89], v[192:193], v[146:147]
    v_pk_fma_f32 v[148:149], v[90:91], v[194:195], v[148:149]
    v_pk_mul_f32 v[168:169], v[146:147], v[146:147]
    v_pk_add_f32 v[166:167], v[146:147], v[148:149]
    v_pk_fma_f32 v[168:169], v[148:149], v[148:149], v[168:169]
    v_pk_fma_f32 v[150:151], v[92:93], v[196:197], v[150:151]
    v_pk_fma_f32 v[152:153], v[94:95], v[198:199], v[152:153]
    v_pk_add_f32 v[166:167], v[166:167], v[150:151]
    v_pk_fma_f32 v[168:169], v[150:151], v[150:151], v[168:169]
    v_pk_add_f32 v[166:167], v[166:167], v[152:153]
    v_pk_fma_f32 v[168:169], v[152:153], v[152:153], v[168:169]
    v_pk_fma_f32 v[154:155], v[96:97], v[200:201], v[154:155]
    v_pk_fma_f32 v[156:157], v[98:99], v[202:203], v[156:157]
    v_pk_add_f32 v[166:167], v[166:167], v[154:155]
    v_pk_fma_f32 v[168:169], v[154:155], v[154:155], v[168:169]
    v_pk_add_f32 v[166:167], v[166:167], v[156:157]
    v_pk_fma_f32 v[168:169], v[156:157], v[156:157], v[168:169]
    v_pk_fma_f32 v[158:159], v[100:101], v[204:205], v[158:159]
    v_pk_fma_f32 v[160:161], v[102:103], v[206:207], v[160:161]
    v_pk_add_f32 v[166:167], v[166:167], v[158:159]
    v_pk_fma_f32 v[168:169], v[158:159], v[158:159], v[168:169]
    v_pk_add_f32 v[166:167], v[166:167], v[160:161]
    v_pk_fma_f32 v[168:169], v[160:161], v[160:161], v[168:169]
    v_add_f32 v162, v162, v163
    v_add_f32 v164, v164, v165
    v_add_f32 v166, v166, v167
    v_add_f32 v168, v168, v169
    s_nop 0
    v_permlane32_swap_b32 v162, v166
    v_permlane32_swap_b32 v164, v168
    v_add_f32 v162, v162, v166
    v_add_f32 v164, v164, v168
    s_nop 1
    v_permlane16_swap_b32 v162, v164
    v_add_f32 v162, v162, v164
    s_nop 1
    v_add_f32_dpp v162, v162, v162 quad_perm:[1,0,3,2] row_mask:0xf bank_mask:0xf
    s_nop 1
    v_add_f32_dpp v162, v162, v162 quad_perm:[2,3,0,1] row_mask:0xf bank_mask:0xf
    s_nop 1
    v_add_f32_dpp v162, v162, v162 row_ror:4 row_mask:0xf bank_mask:0xf
    s_nop 1
    v_add_f32_dpp v162, v162, v162 row_ror:8 row_mask:0xf bank_mask:0xf
    v_mov_b32 v166, v162
    s_nop 1
    v_permlane16_swap_b32 v166, v162
    v_mul_f32 v166, 0x3a800000, v166
    v_mul_f32 v174, v166, v166
    v_mul_f32 v162, 0x3a800000, v162
    v_sub_f32 v162, v162, v174
    v_max_f32 v162, 0, v162
    v_cvt_pk_bf16_f32 v174, v166, v162
    v_and_b32 v162, 0xffff0000, v174
    v_lshlrev_b32 v166, 16, v174
    v_add_f32 v162, 0x3727c5ac, v162
    v_cvt_pk_bf16_f32 v162, v162, v162
    v_and_b32 v162, 0xffff0000, v162
    v_sqrt_f32 v162, v162
    s_nop 0
    v_cvt_pk_bf16_f32 v162, v162, v162
    v_and_b32 v162, 0xffff0000, v162
    v_rcp_f32 v172, v162
    s_nop 0
    v_mul_f32 v173, v166, v172
    v_sub_f32 v173, 0, v173
    v_mov_b32 v170, v172
    v_mov_b32 v171, v173
    s_nop 0
    v_permlane32_swap_b32 v170, v172
    v_permlane32_swap_b32 v171, v173
    v_cvt_pk_bf16_f32 v104, v130, v131
    v_cvt_pk_bf16_f32 v105, v132, v133
    v_cvt_pk_bf16_f32 v106, v134, v135
    v_cvt_pk_bf16_f32 v107, v136, v137
    v_cvt_pk_bf16_f32 v108, v138, v139
    v_cvt_pk_bf16_f32 v109, v140, v141
    v_cvt_pk_bf16_f32 v110, v142, v143
    v_cvt_pk_bf16_f32 v111, v144, v145
    v_cvt_pk_bf16_f32 v112, v146, v147
    v_cvt_pk_bf16_f32 v113, v148, v149
    v_cvt_pk_bf16_f32 v114, v150, v151
    v_cvt_pk_bf16_f32 v115, v152, v153
    v_cvt_pk_bf16_f32 v116, v154, v155
    v_cvt_pk_bf16_f32 v117, v156, v157
    v_cvt_pk_bf16_f32 v118, v158, v159
    v_cvt_pk_bf16_f32 v119, v160, v161
    v_pk_fma_f32 v[130:131], v[130:131], v[170:171], v[170:171] op_sel:[0,0,1] op_sel_hi:[1,0,1]
    v_pk_fma_f32 v[130:131], v[130:131], v[208:209], v[224:225]
    v_pk_fma_f32 v[132:133], v[132:133], v[170:171], v[170:171] op_sel:[0,0,1] op_sel_hi:[1,0,1]
    v_pk_fma_f32 v[132:133], v[132:133], v[210:211], v[226:227]
    v_pk_mul_f32 v[164:165], v[130:131], v[130:131]
    v_pk_add_f32 v[162:163], v[130:131], v[132:133]
    v_pk_fma_f32 v[164:165], v[132:133], v[132:133], v[164:165]
    v_pk_fma_f32 v[134:135], v[134:135], v[170:171], v[170:171] op_sel:[0,0,1] op_sel_hi:[1,0,1]
    v_pk_fma_f32 v[134:135], v[134:135], v[212:213], v[228:229]
    v_pk_fma_f32 v[136:137], v[136:137], v[170:171], v[170:171] op_sel:[0,0,1] op_sel_hi:[1,0,1]
    v_pk_fma_f32 v[136:137], v[136:137], v[214:215], v[230:231]
    v_pk_add_f32 v[162:163], v[162:163], v[134:135]
    v_pk_fma_f32 v[164:165], v[134:135], v[134:135], v[164:165]
    v_pk_add_f32 v[162:163], v[162:163], v[136:137]
    v_pk_fma_f32 v[164:165], v[136:137], v[136:137], v[164:165]
    v_pk_fma_f32 v[138:139], v[138:139], v[170:171], v[170:171] op_sel:[0,0,1] op_sel_hi:[1,0,1]
    v_pk_fma_f32 v[138:139], v[138:139], v[216:217], v[232:233]
    v_pk_fma_f32 v[140:141], v[140:141], v[170:171], v[170:171] op_sel:[0,0,1] op_sel_hi:[1,0,1]
    v_pk_fma_f32 v[140:141], v[140:141], v[218:219], v[234:235]
    v_pk_add_f32 v[162:163], v[162:163], v[138:139]
    v_pk_fma_f32 v[164:165], v[138:139], v[138:139], v[164:165]
    v_pk_add_f32 v[162:163], v[162:163], v[140:141]
    v_pk_fma_f32 v[164:165], v[140:141], v[140:141], v[164:165]
    v_pk_fma_f32 v[142:143], v[142:143], v[170:171], v[170:171] op_sel:[0,0,1] op_sel_hi:[1,0,1]
    v_pk_fma_f32 v[142:143], v[142:143], v[220:221], v[236:237]
    v_pk_fma_f32 v[144:145], v[144:145], v[170:171], v[170:171] op_sel:[0,0,1] op_sel_hi:[1,0,1]
    v_pk_fma_f32 v[144:145], v[144:145], v[222:223], v[238:239]
    v_pk_add_f32 v[162:163], v[162:163], v[142:143]
    v_pk_fma_f32 v[164:165], v[142:143], v[142:143], v[164:165]
    v_pk_add_f32 v[162:163], v[162:163], v[144:145]
    v_pk_fma_f32 v[164:165], v[144:145], v[144:145], v[164:165]
    v_pk_fma_f32 v[146:147], v[146:147], v[172:173], v[172:173] op_sel:[0,0,1] op_sel_hi:[1,0,1]
    v_pk_fma_f32 v[146:147], v[146:147], v[208:209], v[224:225]
    v_pk_fma_f32 v[148:149], v[148:149], v[172:173], v[172:173] op_sel:[0,0,1] op_sel_hi:[1,0,1]
    v_pk_fma_f32 v[148:149], v[148:149], v[210:211], v[226:227]
    v_pk_mul_f32 v[168:169], v[146:147], v[146:147]
    v_pk_add_f32 v[166:167], v[146:147], v[148:149]
    v_pk_fma_f32 v[168:169], v[148:149], v[148:149], v[168:169]
    v_pk_fma_f32 v[150:151], v[150:151], v[172:173], v[172:173] op_sel:[0,0,1] op_sel_hi:[1,0,1]
    v_pk_fma_f32 v[150:151], v[150:151], v[212:213], v[228:229]
    v_pk_fma_f32 v[152:153], v[152:153], v[172:173], v[172:173] op_sel:[0,0,1] op_sel_hi:[1,0,1]
    v_pk_fma_f32 v[152:153], v[152:153], v[214:215], v[230:231]
    v_pk_add_f32 v[166:167], v[166:167], v[150:151]
    v_pk_fma_f32 v[168:169], v[150:151], v[150:151], v[168:169]
    v_pk_add_f32 v[166:167], v[166:167], v[152:153]
    v_pk_fma_f32 v[168:169], v[152:153], v[152:153], v[168:169]
    v_pk_fma_f32 v[154:155], v[154:155], v[172:173], v[172:173] op_sel:[0,0,1] op_sel_hi:[1,0,1]
    v_pk_fma_f32 v[154:155], v[154:155], v[216:217], v[232:233]
    v_pk_fma_f32 v[156:157], v[156:157], v[172:173], v[172:173] op_sel:[0,0,1] op_sel_hi:[1,0,1]
    v_pk_fma_f32 v[156:157], v[156:157], v[218:219], v[234:235]
    v_pk_add_f32 v[166:167], v[166:167], v[154:155]
    v_pk_fma_f32 v[168:169], v[154:155], v[154:155], v[168:169]
    v_pk_add_f32 v[166:167], v[166:167], v[156:157]
    v_pk_fma_f32 v[168:169], v[156:157], v[156:157], v[168:169]
    v_pk_fma_f32 v[158:159], v[158:159], v[172:173], v[172:173] op_sel:[0,0,1] op_sel_hi:[1,0,1]
    v_pk_fma_f32 v[158:159], v[158:159], v[220:221], v[236:237]
    v_pk_fma_f32 v[160:161], v[160:161], v[172:173], v[172:173] op_sel:[0,0,1] op_sel_hi:[1,0,1]
    v_pk_fma_f32 v[160:161], v[160:161], v[222:223], v[238:239]
    v_pk_add_f32 v[166:167], v[166:167], v[158:159]
    v_pk_fma_f32 v[168:169], v[158:159], v[158:159], v[168:169]
    v_pk_add_f32 v[166:167], v[166:167], v[160:161]
    v_pk_fma_f32 v[168:169], v[160:161], v[160:161], v[168:169]
    v_add_f32 v162, v162, v163
    v_add_f32 v164, v164, v165
    v_add_f32 v166, v166, v167
    v_add_f32 v168, v168, v169
    s_nop 0
    v_permlane32_swap_b32 v162, v166
    v_permlane32_swap_b32 v164, v168
    v_add_f32 v162, v162, v166
    v_add_f32 v164, v164, v168
    s_nop 1
    v_permlane16_swap_b32 v162, v164
    v_add_f32 v162, v162, v164
    s_nop 1
    v_add_f32_dpp v162, v162, v162 quad_perm:[1,0,3,2] row_mask:0xf bank_mask:0xf
    s_nop 1
    v_add_f32_dpp v162, v162, v162 quad_perm:[2,3,0,1] row_mask:0xf bank_mask:0xf
    s_nop 1
    v_add_f32_dpp v162, v162, v162 row_ror:4 row_mask:0xf bank_mask:0xf
    s_nop 1
    v_add_f32_dpp v162, v162, v162 row_ror:8 row_mask:0xf bank_mask:0xf
    v_mov_b32 v166, v162
    s_nop 1
    v_permlane16_swap_b32 v166, v162
    v_mul_f32 v166, 0x3a800000, v166
    v_mul_f32 v174, v166, v166
    v_mul_f32 v162, 0x3a800000, v162
    v_sub_f32 v162, v162, v174
    v_max_f32 v162, 0, v162
    v_cvt_pk_bf16_f32 v174, v166, v162
    v_and_b32 v162, 0xffff0000, v174
    v_lshlrev_b32 v166, 16, v174
    v_add_f32 v162, 0x3727c5ac, v162
    v_cvt_pk_bf16_f32 v162, v162, v162
    v_and_b32 v162, 0xffff0000, v162
    v_sqrt_f32 v162, v162
    s_nop 0
    v_cvt_pk_bf16_f32 v162, v162, v162
    v_and_b32 v162, 0xffff0000, v162
    v_rcp_f32 v172, v162
    s_nop 0
    v_mul_f32 v173, v166, v172
    v_sub_f32 v173, 0, v173
    v_mov_b32 v170, v172
    v_mov_b32 v171, v173
    s_nop 0
    v_permlane32_swap_b32 v170, v172
    v_permlane32_swap_b32 v171, v173
    v_mul_f32 v170, 0x3eeff558, v170
    v_mul_f32 v171, 0x3eeff558, v171
    v_mul_f32 v172, 0x3eeff558, v172
    v_mul_f32 v173, 0x3eeff558, v173
    v_pk_fma_f32 v[130:131], v[130:131], v[170:171], v[170:171] op_sel:[0,0,1] op_sel_hi:[1,0,1]
    v_pk_fma_f32 v[132:133], v[132:133], v[170:171], v[170:171] op_sel:[0,0,1] op_sel_hi:[1,0,1]
    v_cvt_pk_bf16_f32 v32, v130, v131
    v_cvt_pk_bf16_f32 v33, v132, v133
    v_pk_fma_f32 v[134:135], v[134:135], v[170:171], v[170:171] op_sel:[0,0,1] op_sel_hi:[1,0,1]
    v_pk_fma_f32 v[136:137], v[136:137], v[170:171], v[170:171] op_sel:[0,0,1] op_sel_hi:[1,0,1]
    v_cvt_pk_bf16_f32 v34, v134, v135
    v_cvt_pk_bf16_f32 v35, v136, v137
    buffer_store_dwordx4 v[32:35], v9, s[20:23], s42 offen offset:0 sc1
    v_pk_fma_f32 v[138:139], v[138:139], v[170:171], v[170:171] op_sel:[0,0,1] op_sel_hi:[1,0,1]
    v_pk_fma_f32 v[140:141], v[140:141], v[170:171], v[170:171] op_sel:[0,0,1] op_sel_hi:[1,0,1]
    v_cvt_pk_bf16_f32 v36, v138, v139
    v_cvt_pk_bf16_f32 v37, v140, v141
    v_pk_fma_f32 v[142:143], v[142:143], v[170:171], v[170:171] op_sel:[0,0,1] op_sel_hi:[1,0,1]
    v_pk_fma_f32 v[144:145], v[144:145], v[170:171], v[170:171] op_sel:[0,0,1] op_sel_hi:[1,0,1]
    v_cvt_pk_bf16_f32 v38, v142, v143
    v_cvt_pk_bf16_f32 v39, v144, v145
    buffer_store_dwordx4 v[36:39], v9, s[20:23], s42 offen offset:1024 sc1
    v_pk_fma_f32 v[146:147], v[146:147], v[172:173], v[172:173] op_sel:[0,0,1] op_sel_hi:[1,0,1]
    v_pk_fma_f32 v[148:149], v[148:149], v[172:173], v[172:173] op_sel:[0,0,1] op_sel_hi:[1,0,1]
    v_cvt_pk_bf16_f32 v40, v146, v147
    v_cvt_pk_bf16_f32 v41, v148, v149
    v_pk_fma_f32 v[150:151], v[150:151], v[172:173], v[172:173] op_sel:[0,0,1] op_sel_hi:[1,0,1]
    v_pk_fma_f32 v[152:153], v[152:153], v[172:173], v[172:173] op_sel:[0,0,1] op_sel_hi:[1,0,1]
    v_cvt_pk_bf16_f32 v42, v150, v151
    v_cvt_pk_bf16_f32 v43, v152, v153
    buffer_store_dwordx4 v[40:43], v9, s[20:23], s42 offen offset:2048 sc1
    v_pk_fma_f32 v[154:155], v[154:155], v[172:173], v[172:173] op_sel:[0,0,1] op_sel_hi:[1,0,1]
    v_pk_fma_f32 v[156:157], v[156:157], v[172:173], v[172:173] op_sel:[0,0,1] op_sel_hi:[1,0,1]
    v_cvt_pk_bf16_f32 v44, v154, v155
    v_cvt_pk_bf16_f32 v45, v156, v157
    v_pk_fma_f32 v[158:159], v[158:159], v[172:173], v[172:173] op_sel:[0,0,1] op_sel_hi:[1,0,1]
    v_pk_fma_f32 v[160:161], v[160:161], v[172:173], v[172:173] op_sel:[0,0,1] op_sel_hi:[1,0,1]
    v_cvt_pk_bf16_f32 v46, v158, v159
    v_cvt_pk_bf16_f32 v47, v160, v161
    buffer_store_dwordx4 v[44:47], v9, s[20:23], s42 offen offset:3072 sc1
    v_mov_b32 v31, v9
    s_mov_b32 s63, s40
    s_lshl_b32 s64, s58, 5
    s_add_u32 s64, s64, s3
    s_lshl_b32 s64, s64, 2
    s_add_u32 s64, s64, 393216
    v_mov_b32 v4, 1
    s_waitcnt vmcnt(0)
    s_mov_b64 exec, 1
    buffer_store_dword v4, off, s[20:23], s64 sc1
    s_mov_b64 exec, -1
    s_and_b32 s35, s3, 1
    s_lshr_b32 s36, s3, 1
    v_lshrrev_b32 v4, 1, v6
    v_xor_b32 v4, v4, v7
    v_lshlrev_b32 v4, 4, v4
    v_lshl_add_u32 v4, v6, 7, v4
    s_lshl_b32 s40, s35, 13
    v_add_u32 v16, s40, v4
    v_xor_b32 v17, 64, v16
    v_lshrrev_b32 v4, 2, v2
    v_lshlrev_b32 v4, 6, v4
    v_and_b32 v5, 3, v2
    v_lshl_add_u32 v4, v5, 3, v4
    v_and_b32 v5, 1, v7
    v_lshl_add_u32 v4, v5, 5, v4
    s_lshl_b32 s40, s36, 14
    s_add_u32 s40, s40, 49152
    v_add_u32 v18, s40, v4
    v_xor_b32 v19, 32, v18
    s_lshl_b32 s40, s36, 5
    v_xor_b32 v20, s40, v4
    v_add_u32 v20, 61440, v20
    s_mov_b32 s44, 0x3eeff558
    s_mov_b32 s45, 0x3eeff558
    v_lshlrev_b32 v128, 16, v240
    v_and_b32 v129, 0xffff0000, v240
    v_lshlrev_b32 v130, 16, v241
    v_and_b32 v131, 0xffff0000, v241
    v_lshlrev_b32 v132, 16, v242
    v_and_b32 v133, 0xffff0000, v242
    v_lshlrev_b32 v134, 16, v243
    v_and_b32 v135, 0xffff0000, v243
    v_lshlrev_b32 v136, 16, v244
    v_and_b32 v137, 0xffff0000, v244
    v_lshlrev_b32 v138, 16, v245
    v_and_b32 v139, 0xffff0000, v245
    v_lshlrev_b32 v140, 16, v246
    v_and_b32 v141, 0xffff0000, v246
    v_lshlrev_b32 v142, 16, v247
    v_and_b32 v143, 0xffff0000, v247
    v_lshlrev_b32 v144, 16, v248
    v_and_b32 v145, 0xffff0000, v248
    v_lshlrev_b32 v146, 16, v249
    v_and_b32 v147, 0xffff0000, v249
    v_lshlrev_b32 v148, 16, v250
    v_and_b32 v149, 0xffff0000, v250
    v_lshlrev_b32 v150, 16, v251
    v_and_b32 v151, 0xffff0000, v251
    v_lshlrev_b32 v152, 16, v252
    v_and_b32 v153, 0xffff0000, v252
    v_lshlrev_b32 v154, 16, v253
    v_and_b32 v155, 0xffff0000, v253
    v_pk_mul_f32 v[212:213], v[128:129], s[44:45]
    v_pk_mul_f32 v[214:215], v[130:131], s[44:45]
    v_pk_mul_f32 v[216:217], v[132:133], s[44:45]
    v_pk_mul_f32 v[218:219], v[134:135], s[44:45]
    v_pk_mul_f32 v[220:221], v[136:137], s[44:45]
    v_pk_mul_f32 v[222:223], v[138:139], s[44:45]
    v_pk_mul_f32 v[224:225], v[140:141], s[44:45]
    v_pk_mul_f32 v[226:227], v[142:143], s[44:45]
    v_pk_mul_f32 v[228:229], v[144:145], s[44:45]
    v_pk_mul_f32 v[230:231], v[146:147], s[44:45]
    v_pk_mul_f32 v[232:233], v[148:149], s[44:45]
    v_pk_mul_f32 v[234:235], v[150:151], s[44:45]
    v_pk_mul_f32 v[236:237], v[152:153], s[44:45]
    v_pk_mul_f32 v[238:239], v[154:155], s[44:45]
    v_pk_mul_f32 v[184:185], v[128:129], s[44:45]
    v_pk_mul_f32 v[186:187], v[130:131], s[44:45]
    v_pk_mul_f32 v[188:189], v[132:133], s[44:45]
    v_pk_mul_f32 v[190:191], v[134:135], s[44:45]
    v_pk_mul_f32 v[192:193], v[136:137], s[44:45]
    v_pk_mul_f32 v[194:195], v[138:139], s[44:45]
    v_pk_mul_f32 v[196:197], v[140:141], s[44:45]
    v_pk_mul_f32 v[198:199], v[142:143], s[44:45]
    v_pk_mul_f32 v[200:201], v[144:145], s[44:45]
    v_pk_mul_f32 v[202:203], v[146:147], s[44:45]
    v_pk_mul_f32 v[204:205], v[148:149], s[44:45]
    v_pk_mul_f32 v[206:207], v[150:151], s[44:45]
    v_pk_mul_f32 v[208:209], v[152:153], s[44:45]
    v_pk_mul_f32 v[210:211], v[154:155], s[44:45]
    v_pk_mul_f32 v[156:157], v[128:129], s[44:45]
    v_pk_mul_f32 v[158:159], v[130:131], s[44:45]
    v_pk_mul_f32 v[160:161], v[132:133], s[44:45]
    v_pk_mul_f32 v[162:163], v[134:135], s[44:45]
    v_pk_mul_f32 v[164:165], v[136:137], s[44:45]
    v_pk_mul_f32 v[166:167], v[138:139], s[44:45]
    v_pk_mul_f32 v[168:169], v[140:141], s[44:45]
    v_pk_mul_f32 v[170:171], v[142:143], s[44:45]
    v_pk_mul_f32 v[172:173], v[144:145], s[44:45]
    v_pk_mul_f32 v[174:175], v[146:147], s[44:45]
    v_pk_mul_f32 v[176:177], v[148:149], s[44:45]
    v_pk_mul_f32 v[178:179], v[150:151], s[44:45]
    v_pk_mul_f32 v[180:181], v[152:153], s[44:45]
    v_pk_mul_f32 v[182:183], v[154:155], s[44:45]
    v_pk_mul_f32 v[128:129], v[128:129], s[44:45]
    v_pk_mul_f32 v[130:131], v[130:131], s[44:45]
    v_pk_mul_f32 v[132:133], v[132:133], s[44:45]
    v_pk_mul_f32 v[134:135], v[134:135], s[44:45]
    v_pk_mul_f32 v[136:137], v[136:137], s[44:45]
    v_pk_mul_f32 v[138:139], v[138:139], s[44:45]
    v_pk_mul_f32 v[140:141], v[140:141], s[44:45]
    v_pk_mul_f32 v[142:143], v[142:143], s[44:45]
    v_pk_mul_f32 v[144:145], v[144:145], s[44:45]
    v_pk_mul_f32 v[146:147], v[146:147], s[44:45]
    v_pk_mul_f32 v[148:149], v[148:149], s[44:45]
    v_pk_mul_f32 v[150:151], v[150:151], s[44:45]
    v_pk_mul_f32 v[152:153], v[152:153], s[44:45]
    v_pk_mul_f32 v[154:155], v[154:155], s[44:45]
    s_mov_b32 s44, 0x409d30fc
    s_mov_b32 s45, 0x409d30fc
    v_lshlrev_b32 v3, 4, v2
    s_lshr_b32 s37, s60, 3
    s_and_b32 s38, s60, 7
    s_lshl_b32 s40, s35, 12
    v_add_u32 v21, s40, v3
    v_lshrrev_b32 v4, 2, v2
    v_lshlrev_b32 v4, 7, v4
    v_and_b32 v5, 3, v2
    v_lshl_add_u32 v4, v5, 3, v4
    v_bfe_u32 v5, v2, 3, 2
    s_lshl_b32 s40, s37, 1
    v_xor_b32 v5, s40, v5
    v_lshl_add_u32 v4, v5, 5, v4
    s_lshl_b32 s40, s36, 13
    s_add_u32 s40, s40, 16384
    v_add_u32 v22, s40, v4
    s_lshl_b32 s39, s38, 2
    s_lshl_b32 s40, s36, 1
    s_add_u32 s39, s39, s40
    s_add_u32 s39, s39, s37
    s_lshl_b32 s41, s39, 6
    s_and_b32 s42, s39, 3
    s_lshl_b32 s40, s58, 2
    s_add_u32 s42, s42, s40
    s_lshl_b32 s42, s42, 7
    s_add_u32 s42, s42, 655360
    s_mov_b32 s16, s54
    s_mov_b32 s17, s55
    s_mov_b32 s18, 2048
    s_mov_b32 s19, 0x20000
    s_mov_b32 s12, s56
    s_mov_b32 s13, s57
    s_mov_b32 s14, 4194304
    s_mov_b32 s15, 0x20000
    s_lshl_b32 s43, s59, 1
    s_add_u32 s43, s43, s35
    s_lshl_b32 s43, s43, 17
    s_add_u32 s43, s43, s41
    s_add_u32 s43, s43, 20971520
    v_bfe_u32 v23, v6, 2, 1
    v_lshlrev_b32 v23, 4, v23
    v_and_b32 v4, 3, v6
    v_add_u32 v23, v23, v4
    v_lshlrev_b32 v23, 6, v23
    v_lshrrev_b32 v4, 3, v6
    v_add_u32 v23, v23, v4
    v_lshlrev_b32 v23, 11, v23
    v_and_b32 v4, 1, v7
    v_lshl_add_u32 v23, v4, 5, v23
    v_lshrrev_b32 v4, 1, v7
    v_lshl_add_u32 v23, v4, 4, v23
    s_and_b32 s50, s59, 3
    s_lshl_b32 s50, s50, 8
    s_lshr_b32 s51, s59, 2
    s_lshl_b32 s51, s51, 4
    s_add_u32 s50, s50, s51
    s_lshl_b32 s51, s35, 3
    s_add_u32 s50, s50, s51
    s_lshl_b32 s50, s50, 11
    s_add_u32 s50, s50, s41
    s_mov_b32 s46, 0
    s_mov_b32 s49, 0
    s_mov_b32 s47, 0
    v_mov_b32 v8, v17
    v_mov_b32 v9, v18
    v_mov_b32 v10, v19
    v_mov_b32 v11, v20
    s_cmp_lg_u32 s3, 1
    s_cbranch_scc1 adaLN_cond__spectral_gfnet__mixer_channel_mlp__prompt_kernel_w059
    s_lshl_b32 s62, s59, 11
    s_add_u32 s62, s62, 393216
    v_lshlrev_b32 v4, 7, v2
    v_and_b32 v4, 2047, v4
    s_mov_b32 s64, 0
adaLN_cond__spectral_gfnet__mixer_channel_mlp__prompt_kernel_poll60:
    buffer_load_dwordx4 v[32:35], v4, s[20:23], s62 offen sc1
    s_add_u32 s64, s64, 1
    s_waitcnt vmcnt(0)
    v_min3_u32 v32, v32, v33, v34
    v_min_u32 v32, v32, v35
    v_cmp_eq_u32 vcc, 0, v32
    s_cmp_ge_u32 s64, 100000
    s_cbranch_scc1 adaLN_cond__spectral_gfnet__mixer_channel_mlp__prompt_kernel_pollx61
    s_nop 2
    s_cbranch_vccnz adaLN_cond__spectral_gfnet__mixer_channel_mlp__prompt_kernel_poll60
adaLN_cond__spectral_gfnet__mixer_channel_mlp__prompt_kernel_pollx61:
adaLN_cond__spectral_gfnet__mixer_channel_mlp__prompt_kernel_w059:
    s_barrier
    buffer_store_dwordx4 v[104:107], v31, s[20:23], s63 offen offset:0 sc1
    buffer_store_dwordx4 v[108:111], v31, s[20:23], s63 offen offset:1024 sc1
    buffer_store_dwordx4 v[112:115], v31, s[20:23], s63 offen offset:2048 sc1
    buffer_store_dwordx4 v[116:119], v31, s[20:23], s63 offen offset:3072 sc1
    s_mov_b32 s37, s41
    s_mov_b32 s38, s42
    s_mov_b32 s39, s43
    s_mul_i32 s40, s59, 112
    s_mul_i32 s41, s60, 7
    s_add_u32 s40, s40, s41
    s_lshl_b32 s40, s40, 13
    s_lshl_b32 s41, s35, 12
    s_add_u32 s40, s40, s41
    s_add_u32 s40, s40, 1048576
    s_lshl_b32 s41, s36, 15
    s_add_u32 s41, s41, s40
    s_lshl_b32 s43, s36, 16
    v_add_u32 v4, s43, v21
    s_lshl_b32 s43, s36, 3
    v_add_u32 v5, s43, v21
    s_barrier
    ds_read_b64_tr_b16 v[32:33], v18 offset:0
    ds_read_b64_tr_b16 v[34:35], v18 offset:1024
    ds_read_b128 v[60:63], v16 offset:0
    ds_read_b128 v[64:67], v16 offset:2048
    ds_read_b128 v[68:71], v16 offset:4096
    ds_read_b128 v[72:75], v16 offset:6144
    ds_read_b64_tr_b16 v[36:37], v19 offset:0
    ds_read_b64_tr_b16 v[38:39], v19 offset:1024
    ds_read_b64_tr_b16 v[40:41], v18 offset:4096
    ds_read_b64_tr_b16 v[42:43], v18 offset:5120
    ds_read_b64_tr_b16 v[44:45], v19 offset:4096
    ds_read_b64_tr_b16 v[46:47], v19 offset:5120
    ds_read_b64_tr_b16 v[48:49], v18 offset:8192
    ds_read_b64_tr_b16 v[50:51], v18 offset:9216
    ds_read_b64_tr_b16 v[52:53], v19 offset:8192
    ds_read_b64_tr_b16 v[54:55], v19 offset:9216
    ds_read_b64_tr_b16 v[56:57], v20 offset:0
    ds_read_b64_tr_b16 v[58:59], v20 offset:1024
    s_waitcnt lgkmcnt(0)
adaLN_cond__spectral_gfnet__mixer_channel_mlp__prompt_kernel_loop62:
    v_mfma_f32_16x16x32_bf16 v[128:131], v[32:35], v[60:63], v[128:131]
    ds_read_b64_tr_b16 v[76:77], v9 offset:2048
    v_mfma_f32_16x16x32_bf16 v[156:159], v[32:35], v[64:67], v[156:159]
    ds_read_b64_tr_b16 v[78:79], v9 offset:3072
    v_mfma_f32_16x16x32_bf16 v[184:187], v[32:35], v[68:71], v[184:187]
    ds_read_b128 v[104:107], v8 offset:0
    v_mfma_f32_16x16x32_bf16 v[212:215], v[32:35], v[72:75], v[212:215]
    ds_read_b128 v[108:111], v8 offset:2048
    v_mfma_f32_16x16x32_bf16 v[216:219], v[36:39], v[72:75], v[216:219]
    ds_read_b128 v[112:115], v8 offset:4096
    v_mfma_f32_16x16x32_bf16 v[188:191], v[36:39], v[68:71], v[188:191]
    ds_read_b128 v[116:119], v8 offset:6144
    v_mfma_f32_16x16x32_bf16 v[160:163], v[36:39], v[64:67], v[160:163]
    ds_read_b64_tr_b16 v[80:81], v10 offset:2048
    v_mfma_f32_16x16x32_bf16 v[132:135], v[36:39], v[60:63], v[132:135]
    ds_read_b64_tr_b16 v[82:83], v10 offset:3072
    v_mfma_f32_16x16x32_bf16 v[136:139], v[40:43], v[60:63], v[136:139]
    ds_read_b64_tr_b16 v[84:85], v9 offset:6144
    v_mfma_f32_16x16x32_bf16 v[164:167], v[40:43], v[64:67], v[164:167]
    ds_read_b64_tr_b16 v[86:87], v9 offset:7168
    v_mfma_f32_16x16x32_bf16 v[192:195], v[40:43], v[68:71], v[192:195]
    ds_read_b64_tr_b16 v[88:89], v10 offset:6144
    v_mfma_f32_16x16x32_bf16 v[220:223], v[40:43], v[72:75], v[220:223]
    ds_read_b64_tr_b16 v[90:91], v10 offset:7168
    v_mfma_f32_16x16x32_bf16 v[224:227], v[44:47], v[72:75], v[224:227]
    ds_read_b64_tr_b16 v[92:93], v9 offset:10240
    v_mfma_f32_16x16x32_bf16 v[196:199], v[44:47], v[68:71], v[196:199]
    ds_read_b64_tr_b16 v[94:95], v9 offset:11264
    v_mfma_f32_16x16x32_bf16 v[168:171], v[44:47], v[64:67], v[168:171]
    ds_read_b64_tr_b16 v[96:97], v10 offset:10240
    v_mfma_f32_16x16x32_bf16 v[140:143], v[44:47], v[60:63], v[140:143]
    ds_read_b64_tr_b16 v[98:99], v10 offset:11264
    v_mfma_f32_16x16x32_bf16 v[144:147], v[48:51], v[60:63], v[144:147]
    ds_read_b64_tr_b16 v[100:101], v11 offset:2048
    v_mfma_f32_16x16x32_bf16 v[172:175], v[48:51], v[64:67], v[172:175]
    ds_read_b64_tr_b16 v[102:103], v11 offset:3072
    v_mfma_f32_16x16x32_bf16 v[200:203], v[48:51], v[68:71], v[200:203]
    s_add_u32 s46, s46, 16384
    s_add_u32 s49, s49, 28672
    v_mfma_f32_16x16x32_bf16 v[228:231], v[48:51], v[72:75], v[228:231]
    s_cmp_ge_u32 s46, 49152
    s_cselect_b32 s46, 0, s46
    v_mfma_f32_16x16x32_bf16 v[232:235], v[52:55], v[72:75], v[232:235]
    s_cmp_ge_u32 s49, 86016
    s_cselect_b32 s49, 0, s49
    v_mfma_f32_16x16x32_bf16 v[204:207], v[52:55], v[68:71], v[204:207]
    v_add_u32 v12, s46, v16
    v_add_u32 v13, s49, v18
    v_mfma_f32_16x16x32_bf16 v[176:179], v[52:55], v[64:67], v[176:179]
    v_add_u32 v14, s49, v19
    v_add_u32 v15, s49, v20
    v_mfma_f32_16x16x32_bf16 v[148:151], v[52:55], v[60:63], v[148:151]
    s_waitcnt lgkmcnt(0)
    s_barrier
    v_mfma_f32_16x16x32_bf16 v[152:155], v[56:59], v[60:63], v[152:155]
    v_mfma_f32_16x16x32_bf16 v[180:183], v[56:59], v[64:67], v[180:183]
    v_mfma_f32_16x16x32_bf16 v[208:211], v[56:59], v[68:71], v[208:211]
    v_mfma_f32_16x16x32_bf16 v[236:239], v[56:59], v[72:75], v[236:239]
    v_mfma_f32_16x16x32_bf16 v[128:131], v[76:79], v[104:107], v[128:131]
    ds_read_b64_tr_b16 v[32:33], v13 offset:0
    v_mfma_f32_16x16x32_bf16 v[156:159], v[76:79], v[108:111], v[156:159]
    ds_read_b64_tr_b16 v[34:35], v13 offset:1024
    v_mfma_f32_16x16x32_bf16 v[184:187], v[76:79], v[112:115], v[184:187]
    ds_read_b128 v[60:63], v12 offset:0
    v_mfma_f32_16x16x32_bf16 v[212:215], v[76:79], v[116:119], v[212:215]
    ds_read_b128 v[64:67], v12 offset:2048
    v_mfma_f32_16x16x32_bf16 v[216:219], v[80:83], v[116:119], v[216:219]
    ds_read_b128 v[68:71], v12 offset:4096
    v_mfma_f32_16x16x32_bf16 v[188:191], v[80:83], v[112:115], v[188:191]
    ds_read_b128 v[72:75], v12 offset:6144
    v_mfma_f32_16x16x32_bf16 v[160:163], v[80:83], v[108:111], v[160:163]
    ds_read_b64_tr_b16 v[36:37], v14 offset:0
    v_mfma_f32_16x16x32_bf16 v[132:135], v[80:83], v[104:107], v[132:135]
    ds_read_b64_tr_b16 v[38:39], v14 offset:1024
    v_mfma_f32_16x16x32_bf16 v[136:139], v[84:87], v[104:107], v[136:139]
    ds_read_b64_tr_b16 v[40:41], v13 offset:4096
    v_mfma_f32_16x16x32_bf16 v[164:167], v[84:87], v[108:111], v[164:167]
    ds_read_b64_tr_b16 v[42:43], v13 offset:5120
    v_mfma_f32_16x16x32_bf16 v[192:195], v[84:87], v[112:115], v[192:195]
    ds_read_b64_tr_b16 v[44:45], v14 offset:4096
    v_mfma_f32_16x16x32_bf16 v[220:223], v[84:87], v[116:119], v[220:223]
    ds_read_b64_tr_b16 v[46:47], v14 offset:5120
    v_mfma_f32_16x16x32_bf16 v[224:227], v[88:91], v[116:119], v[224:227]
    ds_read_b64_tr_b16 v[48:49], v13 offset:8192
    v_mfma_f32_16x16x32_bf16 v[196:199], v[88:91], v[112:115], v[196:199]
    ds_read_b64_tr_b16 v[50:51], v13 offset:9216
    v_mfma_f32_16x16x32_bf16 v[168:171], v[88:91], v[108:111], v[168:171]
    ds_read_b64_tr_b16 v[52:53], v14 offset:8192
    v_mfma_f32_16x16x32_bf16 v[140:143], v[88:91], v[104:107], v[140:143]
    ds_read_b64_tr_b16 v[54:55], v14 offset:9216
    v_mfma_f32_16x16x32_bf16 v[144:147], v[92:95], v[104:107], v[144:147]
    ds_read_b64_tr_b16 v[56:57], v15 offset:0
    v_mfma_f32_16x16x32_bf16 v[172:175], v[92:95], v[108:111], v[172:175]
    ds_read_b64_tr_b16 v[58:59], v15 offset:1024
    v_mfma_f32_16x16x32_bf16 v[200:203], v[92:95], v[112:115], v[200:203]
    v_add_u32 v8, s46, v17
    v_mfma_f32_16x16x32_bf16 v[228:231], v[92:95], v[116:119], v[228:231]
    v_add_u32 v9, s49, v18
    v_mfma_f32_16x16x32_bf16 v[232:235], v[96:99], v[116:119], v[232:235]
    v_add_u32 v10, s49, v19
    v_mfma_f32_16x16x32_bf16 v[204:207], v[96:99], v[112:115], v[204:207]
    v_add_u32 v11, s49, v20
    v_mfma_f32_16x16x32_bf16 v[176:179], v[96:99], v[108:111], v[176:179]
    s_add_u32 s47, s47, 1
    v_mfma_f32_16x16x32_bf16 v[148:151], v[96:99], v[104:107], v[148:151]
    s_cmp_lt_u32 s47, 16
    v_mfma_f32_16x16x32_bf16 v[152:155], v[100:103], v[104:107], v[152:155]
    s_nop 0
    v_mfma_f32_16x16x32_bf16 v[180:183], v[100:103], v[108:111], v[180:183]
    s_nop 0
    v_mfma_f32_16x16x32_bf16 v[208:211], v[100:103], v[112:115], v[208:211]
    s_waitcnt lgkmcnt(0)
    v_mfma_f32_16x16x32_bf16 v[236:239], v[100:103], v[116:119], v[236:239]
    s_cbranch_scc1 adaLN_cond__spectral_gfnet__mixer_channel_mlp__prompt_kernel_loop62
late_code:
    s_waitcnt vmcnt(0) lgkmcnt(0)
    v_pk_fma_f32 v[32:33], v[152:153], v[152:153], s[44:45]
    v_pk_fma_f32 v[34:35], v[154:155], v[154:155], s[44:45]
    v_pk_fma_f32 v[36:37], v[180:181], v[180:181], s[44:45]
    v_pk_fma_f32 v[38:39], v[182:183], v[182:183], s[44:45]
    v_pk_mul_f32 v[32:33], v[32:33], v[152:153] neg_lo:[0,1] neg_hi:[0,1]
    v_pk_mul_f32 v[34:35], v[34:35], v[154:155] neg_lo:[0,1] neg_hi:[0,1]
    v_pk_mul_f32 v[36:37], v[36:37], v[180:181] neg_lo:[0,1] neg_hi:[0,1]
    v_pk_mul_f32 v[38:39], v[38:39], v[182:183] neg_lo:[0,1] neg_hi:[0,1]
    v_exp_f32 v32, v32
    v_exp_f32 v33, v33
    v_exp_f32 v34, v34
    v_exp_f32 v35, v35
    v_exp_f32 v36, v36
    v_exp_f32 v37, v37
    v_exp_f32 v38, v38
    v_exp_f32 v39, v39
    v_pk_add_f32 v[32:33], v[32:33], 1.0 op_sel_hi:[1,0]
    v_pk_add_f32 v[34:35], v[34:35], 1.0 op_sel_hi:[1,0]
    v_pk_add_f32 v[36:37], v[36:37], 1.0 op_sel_hi:[1,0]
    v_pk_add_f32 v[38:39], v[38:39], 1.0 op_sel_hi:[1,0]
    v_rcp_f32 v32, v32
    v_rcp_f32 v33, v33
    v_rcp_f32 v34, v34
    v_rcp_f32 v35, v35
    v_rcp_f32 v36, v36
    v_rcp_f32 v37, v37
    v_rcp_f32 v38, v38
    v_rcp_f32 v39, v39
    v_pk_mul_f32 v[152:153], v[152:153], v[32:33]
    v_pk_mul_f32 v[154:155], v[154:155], v[34:35]
    v_pk_mul_f32 v[180:181], v[180:181], v[36:37]
    v_pk_mul_f32 v[182:183], v[182:183], v[38:39]
    v_cvt_pk_bf16_f32 v64, v152, v153
    v_cvt_pk_bf16_f32 v65, v154, v155
    v_cvt_pk_bf16_f32 v66, v180, v181
    v_cvt_pk_bf16_f32 v67, v182, v183
    ds_write_b64 v5, v[64:65] offset:40960
    ds_write_b64 v5, v[66:67] offset:41984
    v_pk_fma_f32 v[40:41], v[208:209], v[208:209], s[44:45]
    v_pk_fma_f32 v[42:43], v[210:211], v[210:211], s[44:45]
    v_pk_fma_f32 v[44:45], v[236:237], v[236:237], s[44:45]
    v_pk_fma_f32 v[46:47], v[238:239], v[238:239], s[44:45]
    v_pk_mul_f32 v[40:41], v[40:41], v[208:209] neg_lo:[0,1] neg_hi:[0,1]
    v_pk_mul_f32 v[42:43], v[42:43], v[210:211] neg_lo:[0,1] neg_hi:[0,1]
    v_pk_mul_f32 v[44:45], v[44:45], v[236:237] neg_lo:[0,1] neg_hi:[0,1]
    v_pk_mul_f32 v[46:47], v[46:47], v[238:239] neg_lo:[0,1] neg_hi:[0,1]
    v_exp_f32 v40, v40
    v_exp_f32 v41, v41
    v_exp_f32 v42, v42
    v_exp_f32 v43, v43
    v_exp_f32 v44, v44
    v_exp_f32 v45, v45
    v_exp_f32 v46, v46
    v_exp_f32 v47, v47
    v_pk_add_f32 v[40:41], v[40:41], 1.0 op_sel_hi:[1,0]
    v_pk_add_f32 v[42:43], v[42:43], 1.0 op_sel_hi:[1,0]
    v_pk_add_f32 v[44:45], v[44:45], 1.0 op_sel_hi:[1,0]
    v_pk_add_f32 v[46:47], v[46:47], 1.0 op_sel_hi:[1,0]
    v_rcp_f32 v40, v40
    v_rcp_f32 v41, v41
    v_rcp_f32 v42, v42
    v_rcp_f32 v43, v43
    v_rcp_f32 v44, v44
    v_rcp_f32 v45, v45
    v_rcp_f32 v46, v46
    v_rcp_f32 v47, v47
    v_pk_mul_f32 v[208:209], v[208:209], v[40:41]
    v_pk_mul_f32 v[210:211], v[210:211], v[42:43]
    v_pk_mul_f32 v[236:237], v[236:237], v[44:45]
    v_pk_mul_f32 v[238:239], v[238:239], v[46:47]
    v_cvt_pk_bf16_f32 v68, v208, v209
    v_cvt_pk_bf16_f32 v69, v210, v211
    v_cvt_pk_bf16_f32 v70, v236, v237
    v_cvt_pk_bf16_f32 v71, v238, v239
    ds_write_b64 v5, v[68:69] offset:43008
    ds_write_b64 v5, v[70:71] offset:44032
    v_pk_fma_f32 v[32:33], v[128:129], v[128:129], s[44:45]
    v_pk_fma_f32 v[34:35], v[130:131], v[130:131], s[44:45]
    v_pk_fma_f32 v[36:37], v[132:133], v[132:133], s[44:45]
    v_pk_fma_f32 v[38:39], v[134:135], v[134:135], s[44:45]
    v_pk_mul_f32 v[32:33], v[32:33], v[128:129] neg_lo:[0,1] neg_hi:[0,1]
    v_pk_mul_f32 v[34:35], v[34:35], v[130:131] neg_lo:[0,1] neg_hi:[0,1]
    v_pk_mul_f32 v[36:37], v[36:37], v[132:133] neg_lo:[0,1] neg_hi:[0,1]
    v_pk_mul_f32 v[38:39], v[38:39], v[134:135] neg_lo:[0,1] neg_hi:[0,1]
    v_exp_f32 v32, v32
    v_exp_f32 v33, v33
    v_exp_f32 v34, v34
    v_exp_f32 v35, v35
    v_exp_f32 v36, v36
    v_exp_f32 v37, v37
    v_exp_f32 v38, v38
    v_exp_f32 v39, v39
    v_pk_add_f32 v[32:33], v[32:33], 1.0 op_sel_hi:[1,0]
    v_pk_add_f32 v[34:35], v[34:35], 1.0 op_sel_hi:[1,0]
    v_pk_add_f32 v[36:37], v[36:37], 1.0 op_sel_hi:[1,0]
    v_pk_add_f32 v[38:39], v[38:39], 1.0 op_sel_hi:[1,0]
    v_rcp_f32 v32, v32
    v_rcp_f32 v33, v33
    v_rcp_f32 v34, v34
    v_rcp_f32 v35, v35
    v_rcp_f32 v36, v36
    v_rcp_f32 v37, v37
    v_rcp_f32 v38, v38
    v_rcp_f32 v39, v39
    v_pk_mul_f32 v[128:129], v[128:129], v[32:33]
    v_pk_mul_f32 v[130:131], v[130:131], v[34:35]
    v_pk_mul_f32 v[132:133], v[132:133], v[36:37]
    v_pk_mul_f32 v[134:135], v[134:135], v[38:39]
    v_cvt_pk_bf16_f32 v72, v128, v129
    v_cvt_pk_bf16_f32 v73, v130, v131
    v_cvt_pk_bf16_f32 v74, v132, v133
    v_cvt_pk_bf16_f32 v75, v134, v135
    ds_write_b128 v4, v[72:75] offset:0
    v_pk_fma_f32 v[40:41], v[156:157], v[156:157], s[44:45]
    v_pk_fma_f32 v[42:43], v[158:159], v[158:159], s[44:45]
    v_pk_fma_f32 v[44:45], v[160:161], v[160:161], s[44:45]
    v_pk_fma_f32 v[46:47], v[162:163], v[162:163], s[44:45]
    v_pk_mul_f32 v[40:41], v[40:41], v[156:157] neg_lo:[0,1] neg_hi:[0,1]
    v_pk_mul_f32 v[42:43], v[42:43], v[158:159] neg_lo:[0,1] neg_hi:[0,1]
    v_pk_mul_f32 v[44:45], v[44:45], v[160:161] neg_lo:[0,1] neg_hi:[0,1]
    v_pk_mul_f32 v[46:47], v[46:47], v[162:163] neg_lo:[0,1] neg_hi:[0,1]
    v_exp_f32 v40, v40
    v_exp_f32 v41, v41
    v_exp_f32 v42, v42
    v_exp_f32 v43, v43
    v_exp_f32 v44, v44
    v_exp_f32 v45, v45
    v_exp_f32 v46, v46
    v_exp_f32 v47, v47
    v_pk_add_f32 v[40:41], v[40:41], 1.0 op_sel_hi:[1,0]
    v_pk_add_f32 v[42:43], v[42:43], 1.0 op_sel_hi:[1,0]
    v_pk_add_f32 v[44:45], v[44:45], 1.0 op_sel_hi:[1,0]
    v_pk_add_f32 v[46:47], v[46:47], 1.0 op_sel_hi:[1,0]
    v_rcp_f32 v40, v40
    v_rcp_f32 v41, v41
    v_rcp_f32 v42, v42
    v_rcp_f32 v43, v43
    v_rcp_f32 v44, v44
    v_rcp_f32 v45, v45
    v_rcp_f32 v46, v46
    v_rcp_f32 v47, v47
    v_pk_mul_f32 v[156:157], v[156:157], v[40:41]
    v_pk_mul_f32 v[158:159], v[158:159], v[42:43]
    v_pk_mul_f32 v[160:161], v[160:161], v[44:45]
    v_pk_mul_f32 v[162:163], v[162:163], v[46:47]
    v_cvt_pk_bf16_f32 v76, v156, v157
    v_cvt_pk_bf16_f32 v77, v158, v159
    v_cvt_pk_bf16_f32 v78, v160, v161
    v_cvt_pk_bf16_f32 v79, v162, v163
    ds_write_b128 v4, v[76:79] offset:1024
    v_pk_fma_f32 v[32:33], v[184:185], v[184:185], s[44:45]
    v_pk_fma_f32 v[34:35], v[186:187], v[186:187], s[44:45]
    v_pk_fma_f32 v[36:37], v[188:189], v[188:189], s[44:45]
    v_pk_fma_f32 v[38:39], v[190:191], v[190:191], s[44:45]
    v_pk_mul_f32 v[32:33], v[32:33], v[184:185] neg_lo:[0,1] neg_hi:[0,1]
    v_pk_mul_f32 v[34:35], v[34:35], v[186:187] neg_lo:[0,1] neg_hi:[0,1]
    v_pk_mul_f32 v[36:37], v[36:37], v[188:189] neg_lo:[0,1] neg_hi:[0,1]
    v_pk_mul_f32 v[38:39], v[38:39], v[190:191] neg_lo:[0,1] neg_hi:[0,1]
    v_exp_f32 v32, v32
    v_exp_f32 v33, v33
    v_exp_f32 v34, v34
    v_exp_f32 v35, v35
    v_exp_f32 v36, v36
    v_exp_f32 v37, v37
    v_exp_f32 v38, v38
    v_exp_f32 v39, v39
    v_pk_add_f32 v[32:33], v[32:33], 1.0 op_sel_hi:[1,0]
    v_pk_add_f32 v[34:35], v[34:35], 1.0 op_sel_hi:[1,0]
    v_pk_add_f32 v[36:37], v[36:37], 1.0 op_sel_hi:[1,0]
    v_pk_add_f32 v[38:39], v[38:39], 1.0 op_sel_hi:[1,0]
    v_rcp_f32 v32, v32
    v_rcp_f32 v33, v33
    v_rcp_f32 v34, v34
    v_rcp_f32 v35, v35
    v_rcp_f32 v36, v36
    v_rcp_f32 v37, v37
    v_rcp_f32 v38, v38
    v_rcp_f32 v39, v39
    v_pk_mul_f32 v[184:185], v[184:185], v[32:33]
    v_pk_mul_f32 v[186:187], v[186:187], v[34:35]
    v_pk_mul_f32 v[188:189], v[188:189], v[36:37]
    v_pk_mul_f32 v[190:191], v[190:191], v[38:39]
    v_cvt_pk_bf16_f32 v64, v184, v185
    v_cvt_pk_bf16_f32 v65, v186, v187
    v_cvt_pk_bf16_f32 v66, v188, v189
    v_cvt_pk_bf16_f32 v67, v190, v191
    ds_write_b128 v4, v[64:67] offset:2048
    v_pk_fma_f32 v[40:41], v[212:213], v[212:213], s[44:45]
    v_pk_fma_f32 v[42:43], v[214:215], v[214:215], s[44:45]
    v_pk_fma_f32 v[44:45], v[216:217], v[216:217], s[44:45]
    v_pk_fma_f32 v[46:47], v[218:219], v[218:219], s[44:45]
    v_pk_mul_f32 v[40:41], v[40:41], v[212:213] neg_lo:[0,1] neg_hi:[0,1]
    v_pk_mul_f32 v[42:43], v[42:43], v[214:215] neg_lo:[0,1] neg_hi:[0,1]
    v_pk_mul_f32 v[44:45], v[44:45], v[216:217] neg_lo:[0,1] neg_hi:[0,1]
    v_pk_mul_f32 v[46:47], v[46:47], v[218:219] neg_lo:[0,1] neg_hi:[0,1]
    v_exp_f32 v40, v40
    v_exp_f32 v41, v41
    v_exp_f32 v42, v42
    v_exp_f32 v43, v43
    v_exp_f32 v44, v44
    v_exp_f32 v45, v45
    v_exp_f32 v46, v46
    v_exp_f32 v47, v47
    v_pk_add_f32 v[40:41], v[40:41], 1.0 op_sel_hi:[1,0]
    v_pk_add_f32 v[42:43], v[42:43], 1.0 op_sel_hi:[1,0]
    v_pk_add_f32 v[44:45], v[44:45], 1.0 op_sel_hi:[1,0]
    v_pk_add_f32 v[46:47], v[46:47], 1.0 op_sel_hi:[1,0]
    v_rcp_f32 v40, v40
    v_rcp_f32 v41, v41
    v_rcp_f32 v42, v42
    v_rcp_f32 v43, v43
    v_rcp_f32 v44, v44
    v_rcp_f32 v45, v45
    v_rcp_f32 v46, v46
    v_rcp_f32 v47, v47
    v_pk_mul_f32 v[212:213], v[212:213], v[40:41]
    v_pk_mul_f32 v[214:215], v[214:215], v[42:43]
    v_pk_mul_f32 v[216:217], v[216:217], v[44:45]
    v_pk_mul_f32 v[218:219], v[218:219], v[46:47]
    v_cvt_pk_bf16_f32 v68, v212, v213
    v_cvt_pk_bf16_f32 v69, v214, v215
    v_cvt_pk_bf16_f32 v70, v216, v217
    v_cvt_pk_bf16_f32 v71, v218, v219
    ds_write_b128 v4, v[68:71] offset:3072
    s_add_u32 s41, s41, 8192
    v_pk_fma_f32 v[32:33], v[136:137], v[136:137], s[44:45]
    v_pk_fma_f32 v[34:35], v[138:139], v[138:139], s[44:45]
    v_pk_fma_f32 v[36:37], v[140:141], v[140:141], s[44:45]
    v_pk_fma_f32 v[38:39], v[142:143], v[142:143], s[44:45]
    v_pk_mul_f32 v[32:33], v[32:33], v[136:137] neg_lo:[0,1] neg_hi:[0,1]
    v_pk_mul_f32 v[34:35], v[34:35], v[138:139] neg_lo:[0,1] neg_hi:[0,1]
    v_pk_mul_f32 v[36:37], v[36:37], v[140:141] neg_lo:[0,1] neg_hi:[0,1]
    v_pk_mul_f32 v[38:39], v[38:39], v[142:143] neg_lo:[0,1] neg_hi:[0,1]
    v_exp_f32 v32, v32
    v_exp_f32 v33, v33
    v_exp_f32 v34, v34
    v_exp_f32 v35, v35
    v_exp_f32 v36, v36
    v_exp_f32 v37, v37
    v_exp_f32 v38, v38
    v_exp_f32 v39, v39
    v_pk_add_f32 v[32:33], v[32:33], 1.0 op_sel_hi:[1,0]
    v_pk_add_f32 v[34:35], v[34:35], 1.0 op_sel_hi:[1,0]
    v_pk_add_f32 v[36:37], v[36:37], 1.0 op_sel_hi:[1,0]
    v_pk_add_f32 v[38:39], v[38:39], 1.0 op_sel_hi:[1,0]
    v_rcp_f32 v32, v32
    v_rcp_f32 v33, v33
    v_rcp_f32 v34, v34
    v_rcp_f32 v35, v35
    v_rcp_f32 v36, v36
    v_rcp_f32 v37, v37
    v_rcp_f32 v38, v38
    v_rcp_f32 v39, v39
    v_pk_mul_f32 v[136:137], v[136:137], v[32:33]
    v_pk_mul_f32 v[138:139], v[138:139], v[34:35]
    v_pk_mul_f32 v[140:141], v[140:141], v[36:37]
    v_pk_mul_f32 v[142:143], v[142:143], v[38:39]
    s_waitcnt lgkmcnt(0)
    s_barrier
    v_cvt_pk_bf16_f32 v72, v136, v137
    v_cvt_pk_bf16_f32 v73, v138, v139
    v_cvt_pk_bf16_f32 v74, v140, v141
    v_cvt_pk_bf16_f32 v75, v142, v143
    ds_write_b128 v4, v[72:75] offset:8192
    v_pk_fma_f32 v[40:41], v[164:165], v[164:165], s[44:45]
    v_pk_fma_f32 v[42:43], v[166:167], v[166:167], s[44:45]
    v_pk_fma_f32 v[44:45], v[168:169], v[168:169], s[44:45]
    v_pk_fma_f32 v[46:47], v[170:171], v[170:171], s[44:45]
    v_pk_mul_f32 v[40:41], v[40:41], v[164:165] neg_lo:[0,1] neg_hi:[0,1]
    v_pk_mul_f32 v[42:43], v[42:43], v[166:167] neg_lo:[0,1] neg_hi:[0,1]
    v_pk_mul_f32 v[44:45], v[44:45], v[168:169] neg_lo:[0,1] neg_hi:[0,1]
    v_pk_mul_f32 v[46:47], v[46:47], v[170:171] neg_lo:[0,1] neg_hi:[0,1]
    v_exp_f32 v40, v40
    v_exp_f32 v41, v41
    v_exp_f32 v42, v42
    v_exp_f32 v43, v43
    v_exp_f32 v44, v44
    v_exp_f32 v45, v45
    v_exp_f32 v46, v46
    v_exp_f32 v47, v47
    v_pk_add_f32 v[40:41], v[40:41], 1.0 op_sel_hi:[1,0]
    v_pk_add_f32 v[42:43], v[42:43], 1.0 op_sel_hi:[1,0]
    v_pk_add_f32 v[44:45], v[44:45], 1.0 op_sel_hi:[1,0]
    v_pk_add_f32 v[46:47], v[46:47], 1.0 op_sel_hi:[1,0]
    v_rcp_f32 v40, v40
    v_rcp_f32 v41, v41
    v_rcp_f32 v42, v42
    v_rcp_f32 v43, v43
    v_rcp_f32 v44, v44
    v_rcp_f32 v45, v45
    v_rcp_f32 v46, v46
    v_rcp_f32 v47, v47
    v_pk_mul_f32 v[164:165], v[164:165], v[40:41]
    v_pk_mul_f32 v[166:167], v[166:167], v[42:43]
    v_pk_mul_f32 v[168:169], v[168:169], v[44:45]
    v_pk_mul_f32 v[170:171], v[170:171], v[46:47]
    v_cvt_pk_bf16_f32 v76, v164, v165
    v_cvt_pk_bf16_f32 v77, v166, v167
    v_cvt_pk_bf16_f32 v78, v168, v169
    v_cvt_pk_bf16_f32 v79, v170, v171
    ds_write_b128 v4, v[76:79] offset:9216
    v_pk_fma_f32 v[32:33], v[192:193], v[192:193], s[44:45]
    v_pk_fma_f32 v[34:35], v[194:195], v[194:195], s[44:45]
    v_pk_fma_f32 v[36:37], v[196:197], v[196:197], s[44:45]
    v_pk_fma_f32 v[38:39], v[198:199], v[198:199], s[44:45]
    v_pk_mul_f32 v[32:33], v[32:33], v[192:193] neg_lo:[0,1] neg_hi:[0,1]
    v_pk_mul_f32 v[34:35], v[34:35], v[194:195] neg_lo:[0,1] neg_hi:[0,1]
    v_pk_mul_f32 v[36:37], v[36:37], v[196:197] neg_lo:[0,1] neg_hi:[0,1]
    v_pk_mul_f32 v[38:39], v[38:39], v[198:199] neg_lo:[0,1] neg_hi:[0,1]
    v_exp_f32 v32, v32
    v_exp_f32 v33, v33
    v_exp_f32 v34, v34
    v_exp_f32 v35, v35
    v_exp_f32 v36, v36
    v_exp_f32 v37, v37
    v_exp_f32 v38, v38
    v_exp_f32 v39, v39
    v_pk_add_f32 v[32:33], v[32:33], 1.0 op_sel_hi:[1,0]
    v_pk_add_f32 v[34:35], v[34:35], 1.0 op_sel_hi:[1,0]
    v_pk_add_f32 v[36:37], v[36:37], 1.0 op_sel_hi:[1,0]
    v_pk_add_f32 v[38:39], v[38:39], 1.0 op_sel_hi:[1,0]
    v_rcp_f32 v32, v32
    v_rcp_f32 v33, v33
    v_rcp_f32 v34, v34
    v_rcp_f32 v35, v35
    v_rcp_f32 v36, v36
    v_rcp_f32 v37, v37
    v_rcp_f32 v38, v38
    v_rcp_f32 v39, v39
    v_pk_mul_f32 v[192:193], v[192:193], v[32:33]
    v_pk_mul_f32 v[194:195], v[194:195], v[34:35]
    v_pk_mul_f32 v[196:197], v[196:197], v[36:37]
    v_pk_mul_f32 v[198:199], v[198:199], v[38:39]
    v_cvt_pk_bf16_f32 v64, v192, v193
    v_cvt_pk_bf16_f32 v65, v194, v195
    v_cvt_pk_bf16_f32 v66, v196, v197
    v_cvt_pk_bf16_f32 v67, v198, v199
    ds_write_b128 v4, v[64:67] offset:10240
    v_pk_fma_f32 v[40:41], v[220:221], v[220:221], s[44:45]
    v_pk_fma_f32 v[42:43], v[222:223], v[222:223], s[44:45]
    v_pk_fma_f32 v[44:45], v[224:225], v[224:225], s[44:45]
    v_pk_fma_f32 v[46:47], v[226:227], v[226:227], s[44:45]
    v_pk_mul_f32 v[40:41], v[40:41], v[220:221] neg_lo:[0,1] neg_hi:[0,1]
    v_pk_mul_f32 v[42:43], v[42:43], v[222:223] neg_lo:[0,1] neg_hi:[0,1]
    v_pk_mul_f32 v[44:45], v[44:45], v[224:225] neg_lo:[0,1] neg_hi:[0,1]
    v_pk_mul_f32 v[46:47], v[46:47], v[226:227] neg_lo:[0,1] neg_hi:[0,1]
    v_exp_f32 v40, v40
    v_exp_f32 v41, v41
    v_exp_f32 v42, v42
    v_exp_f32 v43, v43
    v_exp_f32 v44, v44
    v_exp_f32 v45, v45
    v_exp_f32 v46, v46
    v_exp_f32 v47, v47
    v_pk_add_f32 v[40:41], v[40:41], 1.0 op_sel_hi:[1,0]
    v_pk_add_f32 v[42:43], v[42:43], 1.0 op_sel_hi:[1,0]
    v_pk_add_f32 v[44:45], v[44:45], 1.0 op_sel_hi:[1,0]
    v_pk_add_f32 v[46:47], v[46:47], 1.0 op_sel_hi:[1,0]
    v_rcp_f32 v40, v40
    v_rcp_f32 v41, v41
    v_rcp_f32 v42, v42
    v_rcp_f32 v43, v43
    v_rcp_f32 v44, v44
    v_rcp_f32 v45, v45
    v_rcp_f32 v46, v46
    v_rcp_f32 v47, v47
    v_pk_mul_f32 v[220:221], v[220:221], v[40:41]
    v_pk_mul_f32 v[222:223], v[222:223], v[42:43]
    v_pk_mul_f32 v[224:225], v[224:225], v[44:45]
    v_pk_mul_f32 v[226:227], v[226:227], v[46:47]
    v_cvt_pk_bf16_f32 v68, v220, v221
    v_cvt_pk_bf16_f32 v69, v222, v223
    v_cvt_pk_bf16_f32 v70, v224, v225
    v_cvt_pk_bf16_f32 v71, v226, v227
    ds_write_b128 v4, v[68:71] offset:11264
    s_add_u32 s41, s41, 8192
    v_pk_fma_f32 v[32:33], v[144:145], v[144:145], s[44:45]
    v_pk_fma_f32 v[34:35], v[146:147], v[146:147], s[44:45]
    v_pk_fma_f32 v[36:37], v[148:149], v[148:149], s[44:45]
    v_pk_fma_f32 v[38:39], v[150:151], v[150:151], s[44:45]
    v_pk_mul_f32 v[32:33], v[32:33], v[144:145] neg_lo:[0,1] neg_hi:[0,1]
    v_pk_mul_f32 v[34:35], v[34:35], v[146:147] neg_lo:[0,1] neg_hi:[0,1]
    v_pk_mul_f32 v[36:37], v[36:37], v[148:149] neg_lo:[0,1] neg_hi:[0,1]
    v_pk_mul_f32 v[38:39], v[38:39], v[150:151] neg_lo:[0,1] neg_hi:[0,1]
    v_exp_f32 v32, v32
    v_exp_f32 v33, v33
    v_exp_f32 v34, v34
    v_exp_f32 v35, v35
    v_exp_f32 v36, v36
    v_exp_f32 v37, v37
    v_exp_f32 v38, v38
    v_exp_f32 v39, v39
    v_pk_add_f32 v[32:33], v[32:33], 1.0 op_sel_hi:[1,0]
    v_pk_add_f32 v[34:35], v[34:35], 1.0 op_sel_hi:[1,0]
    v_pk_add_f32 v[36:37], v[36:37], 1.0 op_sel_hi:[1,0]
    v_pk_add_f32 v[38:39], v[38:39], 1.0 op_sel_hi:[1,0]
    v_rcp_f32 v32, v32
    v_rcp_f32 v33, v33
    v_rcp_f32 v34, v34
    v_rcp_f32 v35, v35
    v_rcp_f32 v36, v36
    v_rcp_f32 v37, v37
    v_rcp_f32 v38, v38
    v_rcp_f32 v39, v39
    v_pk_mul_f32 v[144:145], v[144:145], v[32:33]
    v_pk_mul_f32 v[146:147], v[146:147], v[34:35]
    v_pk_mul_f32 v[148:149], v[148:149], v[36:37]
    v_pk_mul_f32 v[150:151], v[150:151], v[38:39]
    s_waitcnt lgkmcnt(0)
    s_barrier
    v_cvt_pk_bf16_f32 v72, v144, v145
    v_cvt_pk_bf16_f32 v73, v146, v147
    v_cvt_pk_bf16_f32 v74, v148, v149
    v_cvt_pk_bf16_f32 v75, v150, v151
    ds_write_b128 v4, v[72:75] offset:32768
    v_pk_fma_f32 v[40:41], v[172:173], v[172:173], s[44:45]
    v_pk_fma_f32 v[42:43], v[174:175], v[174:175], s[44:45]
    v_pk_fma_f32 v[44:45], v[176:177], v[176:177], s[44:45]
    v_pk_fma_f32 v[46:47], v[178:179], v[178:179], s[44:45]
    v_pk_mul_f32 v[40:41], v[40:41], v[172:173] neg_lo:[0,1] neg_hi:[0,1]
    v_pk_mul_f32 v[42:43], v[42:43], v[174:175] neg_lo:[0,1] neg_hi:[0,1]
    v_pk_mul_f32 v[44:45], v[44:45], v[176:177] neg_lo:[0,1] neg_hi:[0,1]
    v_pk_mul_f32 v[46:47], v[46:47], v[178:179] neg_lo:[0,1] neg_hi:[0,1]
    v_exp_f32 v40, v40
    v_exp_f32 v41, v41
    v_exp_f32 v42, v42
    v_exp_f32 v43, v43
    v_exp_f32 v44, v44
    v_exp_f32 v45, v45
    v_exp_f32 v46, v46
    v_exp_f32 v47, v47
    v_pk_add_f32 v[40:41], v[40:41], 1.0 op_sel_hi:[1,0]
    v_pk_add_f32 v[42:43], v[42:43], 1.0 op_sel_hi:[1,0]
    v_pk_add_f32 v[44:45], v[44:45], 1.0 op_sel_hi:[1,0]
    v_pk_add_f32 v[46:47], v[46:47], 1.0 op_sel_hi:[1,0]
    v_rcp_f32 v40, v40
    v_rcp_f32 v41, v41
    v_rcp_f32 v42, v42
    v_rcp_f32 v43, v43
    v_rcp_f32 v44, v44
    v_rcp_f32 v45, v45
    v_rcp_f32 v46, v46
    v_rcp_f32 v47, v47
    v_pk_mul_f32 v[172:173], v[172:173], v[40:41]
    v_pk_mul_f32 v[174:175], v[174:175], v[42:43]
    v_pk_mul_f32 v[176:177], v[176:177], v[44:45]
    v_pk_mul_f32 v[178:179], v[178:179], v[46:47]
    v_cvt_pk_bf16_f32 v76, v172, v173
    v_cvt_pk_bf16_f32 v77, v174, v175
    v_cvt_pk_bf16_f32 v78, v176, v177
    v_cvt_pk_bf16_f32 v79, v178, v179
    ds_write_b128 v4, v[76:79] offset:33792
    v_pk_fma_f32 v[32:33], v[200:201], v[200:201], s[44:45]
    v_pk_fma_f32 v[34:35], v[202:203], v[202:203], s[44:45]
    v_pk_fma_f32 v[36:37], v[204:205], v[204:205], s[44:45]
    v_pk_fma_f32 v[38:39], v[206:207], v[206:207], s[44:45]
    v_pk_mul_f32 v[32:33], v[32:33], v[200:201] neg_lo:[0,1] neg_hi:[0,1]
    v_pk_mul_f32 v[34:35], v[34:35], v[202:203] neg_lo:[0,1] neg_hi:[0,1]
    v_pk_mul_f32 v[36:37], v[36:37], v[204:205] neg_lo:[0,1] neg_hi:[0,1]
    v_pk_mul_f32 v[38:39], v[38:39], v[206:207] neg_lo:[0,1] neg_hi:[0,1]
    v_exp_f32 v32, v32
    v_exp_f32 v33, v33
    v_exp_f32 v34, v34
    v_exp_f32 v35, v35
    v_exp_f32 v36, v36
    v_exp_f32 v37, v37
    v_exp_f32 v38, v38
    v_exp_f32 v39, v39
    v_pk_add_f32 v[32:33], v[32:33], 1.0 op_sel_hi:[1,0]
    v_pk_add_f32 v[34:35], v[34:35], 1.0 op_sel_hi:[1,0]
    v_pk_add_f32 v[36:37], v[36:37], 1.0 op_sel_hi:[1,0]
    v_pk_add_f32 v[38:39], v[38:39], 1.0 op_sel_hi:[1,0]
    v_rcp_f32 v32, v32
    v_rcp_f32 v33, v33
    v_rcp_f32 v34, v34
    v_rcp_f32 v35, v35
    v_rcp_f32 v36, v36
    v_rcp_f32 v37, v37
    v_rcp_f32 v38, v38
    v_rcp_f32 v39, v39
    v_pk_mul_f32 v[200:201], v[200:201], v[32:33]
    v_pk_mul_f32 v[202:203], v[202:203], v[34:35]
    v_pk_mul_f32 v[204:205], v[204:205], v[36:37]
    v_pk_mul_f32 v[206:207], v[206:207], v[38:39]
    v_cvt_pk_bf16_f32 v64, v200, v201
    v_cvt_pk_bf16_f32 v65, v202, v203
    v_cvt_pk_bf16_f32 v66, v204, v205
    v_cvt_pk_bf16_f32 v67, v206, v207
    ds_write_b128 v4, v[64:67] offset:34816
    v_pk_fma_f32 v[40:41], v[228:229], v[228:229], s[44:45]
    v_pk_fma_f32 v[42:43], v[230:231], v[230:231], s[44:45]
    v_pk_fma_f32 v[44:45], v[232:233], v[232:233], s[44:45]
    v_pk_fma_f32 v[46:47], v[234:235], v[234:235], s[44:45]
    v_pk_mul_f32 v[40:41], v[40:41], v[228:229] neg_lo:[0,1] neg_hi:[0,1]
    v_pk_mul_f32 v[42:43], v[42:43], v[230:231] neg_lo:[0,1] neg_hi:[0,1]
    v_pk_mul_f32 v[44:45], v[44:45], v[232:233] neg_lo:[0,1] neg_hi:[0,1]
    v_pk_mul_f32 v[46:47], v[46:47], v[234:235] neg_lo:[0,1] neg_hi:[0,1]
    v_exp_f32 v40, v40
    v_exp_f32 v41, v41
    v_exp_f32 v42, v42
    v_exp_f32 v43, v43
    v_exp_f32 v44, v44
    v_exp_f32 v45, v45
    v_exp_f32 v46, v46
    v_exp_f32 v47, v47
    v_pk_add_f32 v[40:41], v[40:41], 1.0 op_sel_hi:[1,0]
    v_pk_add_f32 v[42:43], v[42:43], 1.0 op_sel_hi:[1,0]
    v_pk_add_f32 v[44:45], v[44:45], 1.0 op_sel_hi:[1,0]
    v_pk_add_f32 v[46:47], v[46:47], 1.0 op_sel_hi:[1,0]
    v_rcp_f32 v40, v40
    v_rcp_f32 v41, v41
    v_rcp_f32 v42, v42
    v_rcp_f32 v43, v43
    v_rcp_f32 v44, v44
    v_rcp_f32 v45, v45
    v_rcp_f32 v46, v46
    v_rcp_f32 v47, v47
    v_pk_mul_f32 v[228:229], v[228:229], v[40:41]
    v_pk_mul_f32 v[230:231], v[230:231], v[42:43]
    v_pk_mul_f32 v[232:233], v[232:233], v[44:45]
    v_pk_mul_f32 v[234:235], v[234:235], v[46:47]
    v_cvt_pk_bf16_f32 v68, v228, v229
    v_cvt_pk_bf16_f32 v69, v230, v231
    v_cvt_pk_bf16_f32 v70, v232, v233
    v_cvt_pk_bf16_f32 v71, v234, v235
    ds_write_b128 v4, v[68:71] offset:35840
    s_add_u32 s41, s41, 8192
    v_mov_b32 v16, v21
    v_mov_b32 v17, v22
    v_xor_b32 v18, 32, v22
    v_xor_b32 v19, 64, v22
    v_xor_b32 v20, 0x60, v22
    s_mov_b32 s46, 0
    s_mov_b32 s47, 1
    s_waitcnt vmcnt(8) lgkmcnt(0)
    s_barrier
    ds_read_b64_tr_b16 v[32:33], v17 offset:0
    ds_read_b64_tr_b16 v[34:35], v17 offset:2048
    ds_read_b128 v[48:51], v16 offset:0
    ds_read_b128 v[52:55], v16 offset:1024
    ds_read_b128 v[56:59], v16 offset:2048
    ds_read_b128 v[60:63], v16 offset:3072
    ds_read_b64_tr_b16 v[36:37], v18 offset:0
    ds_read_b64_tr_b16 v[38:39], v18 offset:2048
    ds_read_b64_tr_b16 v[40:41], v19 offset:0
    ds_read_b64_tr_b16 v[42:43], v19 offset:2048
    ds_read_b64_tr_b16 v[44:45], v20 offset:0
    ds_read_b64_tr_b16 v[46:47], v20 offset:2048
    s_waitcnt lgkmcnt(6)
    v_mfma_f32_16x16x32_bf16 v[128:131], v[32:35], v[48:51], 0
    ds_read_b64_tr_b16 v[80:81], v17 offset:4096
    v_mfma_f32_16x16x32_bf16 v[144:147], v[32:35], v[52:55], 0
    ds_read_b64_tr_b16 v[82:83], v17 offset:6144
    v_mfma_f32_16x16x32_bf16 v[160:163], v[32:35], v[56:59], 0
    ds_read_b128 v[96:99], v16 offset:8192
    v_mfma_f32_16x16x32_bf16 v[176:179], v[32:35], v[60:63], 0
    ds_read_b128 v[100:103], v16 offset:9216
    s_waitcnt lgkmcnt(8)
    v_mfma_f32_16x16x32_bf16 v[180:183], v[36:39], v[60:63], 0
    ds_read_b128 v[104:107], v16 offset:10240
    v_mfma_f32_16x16x32_bf16 v[164:167], v[36:39], v[56:59], 0
    ds_read_b128 v[108:111], v16 offset:11264
    v_mfma_f32_16x16x32_bf16 v[148:151], v[36:39], v[52:55], 0
    ds_read_b64_tr_b16 v[84:85], v18 offset:4096
    v_mfma_f32_16x16x32_bf16 v[132:135], v[36:39], v[48:51], 0
    ds_read_b64_tr_b16 v[86:87], v18 offset:6144
    s_waitcnt lgkmcnt(10)
    v_mfma_f32_16x16x32_bf16 v[136:139], v[40:43], v[48:51], 0
    ds_read_b64_tr_b16 v[88:89], v19 offset:4096
    v_mfma_f32_16x16x32_bf16 v[152:155], v[40:43], v[52:55], 0
    ds_read_b64_tr_b16 v[90:91], v19 offset:6144
    v_mfma_f32_16x16x32_bf16 v[168:171], v[40:43], v[56:59], 0
    ds_read_b64_tr_b16 v[92:93], v20 offset:4096
    v_mfma_f32_16x16x32_bf16 v[184:187], v[40:43], v[60:63], 0
    ds_read_b64_tr_b16 v[94:95], v20 offset:6144
    s_waitcnt lgkmcnt(12)
    v_mfma_f32_16x16x32_bf16 v[188:191], v[44:47], v[60:63], 0
    s_add_u32 s46, s46, 32768
    s_cmp_ge_u32 s46, 163840
    s_cselect_b32 s46, 0, s46
    v_mfma_f32_16x16x32_bf16 v[172:175], v[44:47], v[56:59], 0
    v_add_u32 v8, s46, v16
    v_add_u32 v9, s46, v17
    v_mfma_f32_16x16x32_bf16 v[156:159], v[44:47], v[52:55], 0
    v_add_u32 v10, s46, v18
    v_add_u32 v11, s46, v19
    v_mfma_f32_16x16x32_bf16 v[140:143], v[44:47], v[48:51], 0
    v_add_u32 v12, s46, v20
    s_waitcnt lgkmcnt(6)
    v_mfma_f32_16x16x32_bf16 v[128:131], v[80:83], v[96:99], v[128:131]
    v_mfma_f32_16x16x32_bf16 v[144:147], v[80:83], v[100:103], v[144:147]
    v_mfma_f32_16x16x32_bf16 v[160:163], v[80:83], v[104:107], v[160:163]
    v_mfma_f32_16x16x32_bf16 v[176:179], v[80:83], v[108:111], v[176:179]
    s_waitcnt lgkmcnt(0)
    s_barrier
    v_mfma_f32_16x16x32_bf16 v[180:183], v[84:87], v[108:111], v[180:183]
    ds_read_b64_tr_b16 v[32:33], v9 offset:0
    v_mfma_f32_16x16x32_bf16 v[164:167], v[84:87], v[104:107], v[164:167]
    ds_read_b64_tr_b16 v[34:35], v9 offset:2048
    v_mfma_f32_16x16x32_bf16 v[148:151], v[84:87], v[100:103], v[148:151]
    ds_read_b128 v[48:51], v8 offset:0
    v_mfma_f32_16x16x32_bf16 v[132:135], v[84:87], v[96:99], v[132:135]
    ds_read_b128 v[52:55], v8 offset:1024
    v_mfma_f32_16x16x32_bf16 v[136:139], v[88:91], v[96:99], v[136:139]
    ds_read_b128 v[56:59], v8 offset:2048
    v_mfma_f32_16x16x32_bf16 v[152:155], v[88:91], v[100:103], v[152:155]
    ds_read_b128 v[60:63], v8 offset:3072
    v_mfma_f32_16x16x32_bf16 v[168:171], v[88:91], v[104:107], v[168:171]
    ds_read_b64_tr_b16 v[36:37], v10 offset:0
    v_mfma_f32_16x16x32_bf16 v[184:187], v[88:91], v[108:111], v[184:187]
    ds_read_b64_tr_b16 v[38:39], v10 offset:2048
    v_mfma_f32_16x16x32_bf16 v[188:191], v[92:95], v[108:111], v[188:191]
    ds_read_b64_tr_b16 v[40:41], v11 offset:0
    v_mfma_f32_16x16x32_bf16 v[172:175], v[92:95], v[104:107], v[172:175]
    ds_read_b64_tr_b16 v[42:43], v11 offset:2048
    v_mfma_f32_16x16x32_bf16 v[156:159], v[92:95], v[100:103], v[156:159]
    ds_read_b64_tr_b16 v[44:45], v12 offset:0
    v_mfma_f32_16x16x32_bf16 v[140:143], v[92:95], v[96:99], v[140:143]
    ds_read_b64_tr_b16 v[46:47], v12 offset:2048
    s_mov_b32 s48, 24
adaLN_cond__spectral_gfnet__mixer_channel_mlp__prompt_kernel_loop63:
    s_waitcnt lgkmcnt(6)
    v_mfma_f32_16x16x32_bf16 v[128:131], v[32:35], v[48:51], v[128:131]
    ds_read_b64_tr_b16 v[80:81], v9 offset:4096
    v_mfma_f32_16x16x32_bf16 v[144:147], v[32:35], v[52:55], v[144:147]
    ds_read_b64_tr_b16 v[82:83], v9 offset:6144
    v_mfma_f32_16x16x32_bf16 v[160:163], v[32:35], v[56:59], v[160:163]
    ds_read_b128 v[96:99], v8 offset:8192
    v_mfma_f32_16x16x32_bf16 v[176:179], v[32:35], v[60:63], v[176:179]
    ds_read_b128 v[100:103], v8 offset:9216
    s_waitcnt lgkmcnt(8)
    v_mfma_f32_16x16x32_bf16 v[180:183], v[36:39], v[60:63], v[180:183]
    ds_read_b128 v[104:107], v8 offset:10240
    v_mfma_f32_16x16x32_bf16 v[164:167], v[36:39], v[56:59], v[164:167]
    ds_read_b128 v[108:111], v8 offset:11264
    v_mfma_f32_16x16x32_bf16 v[148:151], v[36:39], v[52:55], v[148:151]
    ds_read_b64_tr_b16 v[84:85], v10 offset:4096
    v_mfma_f32_16x16x32_bf16 v[132:135], v[36:39], v[48:51], v[132:135]
    ds_read_b64_tr_b16 v[86:87], v10 offset:6144
    s_waitcnt lgkmcnt(10)
    v_mfma_f32_16x16x32_bf16 v[136:139], v[40:43], v[48:51], v[136:139]
    ds_read_b64_tr_b16 v[88:89], v11 offset:4096
    v_mfma_f32_16x16x32_bf16 v[152:155], v[40:43], v[52:55], v[152:155]
    ds_read_b64_tr_b16 v[90:91], v11 offset:6144
    v_mfma_f32_16x16x32_bf16 v[168:171], v[40:43], v[56:59], v[168:171]
    ds_read_b64_tr_b16 v[92:93], v12 offset:4096
    v_mfma_f32_16x16x32_bf16 v[184:187], v[40:43], v[60:63], v[184:187]
    ds_read_b64_tr_b16 v[94:95], v12 offset:6144
    s_waitcnt lgkmcnt(12)
    v_mfma_f32_16x16x32_bf16 v[188:191], v[44:47], v[60:63], v[188:191]
    s_add_u32 s46, s46, 32768
    s_cmp_ge_u32 s46, 163840
    s_cselect_b32 s46, 0, s46
    v_mfma_f32_16x16x32_bf16 v[172:175], v[44:47], v[56:59], v[172:175]
    v_add_u32 v8, s46, v16
    v_add_u32 v9, s46, v17
    v_mfma_f32_16x16x32_bf16 v[156:159], v[44:47], v[52:55], v[156:159]
    v_add_u32 v10, s46, v18
    v_add_u32 v11, s46, v19
    v_mfma_f32_16x16x32_bf16 v[140:143], v[44:47], v[48:51], v[140:143]
    v_add_u32 v12, s46, v20
    s_waitcnt lgkmcnt(6)
    v_mfma_f32_16x16x32_bf16 v[128:131], v[80:83], v[96:99], v[128:131]
    s_add_u32 s47, s47, 1
    v_mfma_f32_16x16x32_bf16 v[144:147], v[80:83], v[100:103], v[144:147]
    s_cmp_lt_u32 s47, s48
    v_mfma_f32_16x16x32_bf16 v[160:163], v[80:83], v[104:107], v[160:163]
    v_mfma_f32_16x16x32_bf16 v[176:179], v[80:83], v[108:111], v[176:179]
    s_waitcnt lgkmcnt(0)
    s_barrier
    v_mfma_f32_16x16x32_bf16 v[180:183], v[84:87], v[108:111], v[180:183]
    ds_read_b64_tr_b16 v[32:33], v9 offset:0
    v_mfma_f32_16x16x32_bf16 v[164:167], v[84:87], v[104:107], v[164:167]
    ds_read_b64_tr_b16 v[34:35], v9 offset:2048
    v_mfma_f32_16x16x32_bf16 v[148:151], v[84:87], v[100:103], v[148:151]
    ds_read_b128 v[48:51], v8 offset:0
    v_mfma_f32_16x16x32_bf16 v[132:135], v[84:87], v[96:99], v[132:135]
    ds_read_b128 v[52:55], v8 offset:1024
    v_mfma_f32_16x16x32_bf16 v[136:139], v[88:91], v[96:99], v[136:139]
    ds_read_b128 v[56:59], v8 offset:2048
    v_mfma_f32_16x16x32_bf16 v[152:155], v[88:91], v[100:103], v[152:155]
    ds_read_b128 v[60:63], v8 offset:3072
    v_mfma_f32_16x16x32_bf16 v[168:171], v[88:91], v[104:107], v[168:171]
    ds_read_b64_tr_b16 v[36:37], v10 offset:0
    v_mfma_f32_16x16x32_bf16 v[184:187], v[88:91], v[108:111], v[184:187]
    ds_read_b64_tr_b16 v[38:39], v10 offset:2048
    v_mfma_f32_16x16x32_bf16 v[188:191], v[92:95], v[108:111], v[188:191]
    ds_read_b64_tr_b16 v[40:41], v11 offset:0
    v_mfma_f32_16x16x32_bf16 v[172:175], v[92:95], v[104:107], v[172:175]
    ds_read_b64_tr_b16 v[42:43], v11 offset:2048
    v_mfma_f32_16x16x32_bf16 v[156:159], v[92:95], v[100:103], v[156:159]
    ds_read_b64_tr_b16 v[44:45], v12 offset:0
    v_mfma_f32_16x16x32_bf16 v[140:143], v[92:95], v[96:99], v[140:143]
    ds_read_b64_tr_b16 v[46:47], v12 offset:2048
    s_cbranch_scc1 adaLN_cond__spectral_gfnet__mixer_channel_mlp__prompt_kernel_loop63
    s_cmp_ge_u32 s47, 27
    s_cbranch_scc1 adaLN_cond__spectral_gfnet__mixer_channel_mlp__prompt_kernel_ld64
    s_mov_b32 s48, 27
    v_lshlrev_b32 v28, 3, v7
    v_lshlrev_b32 v29, 4, v7
    buffer_load_dwordx2 v[24:25], v28, s[16:19], s37 offen offset:0
    buffer_load_dwordx2 v[26:27], v28, s[16:19], s37 offen offset:32
    buffer_load_dwordx4 v[120:123], v29, s[20:23], s38 offen offset:0 sc1
    buffer_load_dwordx4 v[124:127], v29, s[20:23], s38 offen offset:64 sc1
    v_lshl_add_u32 v29, v6, 11, v29
    buffer_load_dwordx4 v[240:243], v29, s[20:23], s39 offen sc1
    s_add_u32 s39, s39, 32768
    buffer_load_dwordx4 v[244:247], v29, s[20:23], s39 offen sc1
    s_add_u32 s39, s39, 32768
    buffer_load_dwordx4 v[248:251], v29, s[20:23], s39 offen sc1
    s_add_u32 s39, s39, 32768
    buffer_load_dwordx4 v[252:255], v29, s[20:23], s39 offen sc1
    s_lshl_b32 s44, s58, 2
    s_add_u32 s44, s44, s3
    s_lshl_b32 s44, s44, 12
    s_add_u32 s44, s44, 29360128
    s_xor_b32 s45, s44, 131072
    s_branch adaLN_cond__spectral_gfnet__mixer_channel_mlp__prompt_kernel_loop63
adaLN_cond__spectral_gfnet__mixer_channel_mlp__prompt_kernel_ld64:
    s_waitcnt lgkmcnt(0)
    v_mfma_f32_16x16x32_bf16 v[136:139], v[40:43], v[48:51], v[136:139]
    ds_read_b64_tr_b16 v[88:89], v11 offset:4096
    ds_read_b64_tr_b16 v[90:91], v11 offset:6144
    v_mfma_f32_16x16x32_bf16 v[152:155], v[40:43], v[52:55], v[152:155]
    ds_read_b64_tr_b16 v[92:93], v12 offset:4096
    ds_read_b64_tr_b16 v[94:95], v12 offset:6144
    v_mfma_f32_16x16x32_bf16 v[168:171], v[40:43], v[56:59], v[168:171]
    ds_read_b128 v[96:99], v8 offset:8192
    ds_read_b128 v[100:103], v8 offset:9216
    v_mfma_f32_16x16x32_bf16 v[184:187], v[40:43], v[60:63], v[184:187]
    ds_read_b128 v[104:107], v8 offset:10240
    ds_read_b128 v[108:111], v8 offset:11264
    v_mfma_f32_16x16x32_bf16 v[140:143], v[44:47], v[48:51], v[140:143]
    ds_read_b64_tr_b16 v[80:81], v9 offset:4096
    v_mfma_f32_16x16x32_bf16 v[156:159], v[44:47], v[52:55], v[156:159]
    ds_read_b64_tr_b16 v[82:83], v9 offset:6144
    v_mfma_f32_16x16x32_bf16 v[172:175], v[44:47], v[56:59], v[172:175]
    ds_read_b64_tr_b16 v[84:85], v10 offset:4096
    v_mfma_f32_16x16x32_bf16 v[188:191], v[44:47], v[60:63], v[188:191]
    ds_read_b64_tr_b16 v[86:87], v10 offset:6144
    v_mfma_f32_16x16x32_bf16 v[128:131], v[32:35], v[48:51], v[128:131]
    v_mfma_f32_16x16x32_bf16 v[144:147], v[32:35], v[52:55], v[144:147]
    v_mfma_f32_16x16x32_bf16 v[160:163], v[32:35], v[56:59], v[160:163]
    v_mfma_f32_16x16x32_bf16 v[176:179], v[32:35], v[60:63], v[176:179]
    s_waitcnt lgkmcnt(0)
    s_barrier
    v_mfma_f32_16x16x32_bf16 v[136:139], v[88:91], v[96:99], v[136:139]
    v_mfma_f32_16x16x32_bf16 v[140:143], v[92:95], v[96:99], v[140:143]
    v_mfma_f32_16x16x32_bf16 v[152:155], v[88:91], v[100:103], v[152:155]
    v_mfma_f32_16x16x32_bf16 v[156:159], v[92:95], v[100:103], v[156:159]
    v_mfma_f32_16x16x32_bf16 v[168:171], v[88:91], v[104:107], v[168:171]
    v_mfma_f32_16x16x32_bf16 v[172:175], v[92:95], v[104:107], v[172:175]
    v_mfma_f32_16x16x32_bf16 v[184:187], v[88:91], v[108:111], v[184:187]
    v_mfma_f32_16x16x32_bf16 v[188:191], v[92:95], v[108:111], v[188:191]
    v_mfma_f32_16x16x32_bf16 v[132:135], v[36:39], v[48:51], v[132:135]
    v_cvt_pk_bf16_f32 v208, v136, v137
    v_cvt_pk_bf16_f32 v209, v138, v139
    v_cvt_pk_bf16_f32 v210, v140, v141
    v_mfma_f32_16x16x32_bf16 v[148:151], v[36:39], v[52:55], v[148:151]
    v_cvt_pk_bf16_f32 v211, v142, v143
    v_min_u32 v208, -2, v208
    v_min_u32 v209, -2, v209
    v_mfma_f32_16x16x32_bf16 v[164:167], v[36:39], v[56:59], v[164:167]
    v_min_u32 v210, -2, v210
    v_min_u32 v211, -2, v211
    buffer_store_dwordx4 v[208:211], v3, s[20:23], s45 offen offset:0 sc1
    v_mfma_f32_16x16x32_bf16 v[180:183], v[36:39], v[60:63], v[180:183]
    v_cvt_pk_bf16_f32 v212, v152, v153
    v_cvt_pk_bf16_f32 v213, v154, v155
    v_cvt_pk_bf16_f32 v214, v156, v157
    v_mfma_f32_16x16x32_bf16 v[128:131], v[80:83], v[96:99], v[128:131]
    v_cvt_pk_bf16_f32 v215, v158, v159
    v_min_u32 v212, -2, v212
    v_min_u32 v213, -2, v213
    v_mfma_f32_16x16x32_bf16 v[144:147], v[80:83], v[100:103], v[144:147]
    v_min_u32 v214, -2, v214
    v_min_u32 v215, -2, v215
    buffer_store_dwordx4 v[212:215], v3, s[20:23], s45 offen offset:1024 sc1
    v_mfma_f32_16x16x32_bf16 v[160:163], v[80:83], v[104:107], v[160:163]
    v_cvt_pk_bf16_f32 v216, v168, v169
    v_cvt_pk_bf16_f32 v217, v170, v171
    v_cvt_pk_bf16_f32 v218, v172, v173
    v_mfma_f32_16x16x32_bf16 v[176:179], v[80:83], v[108:111], v[176:179]
    v_cvt_pk_bf16_f32 v219, v174, v175
    v_min_u32 v216, -2, v216
    v_min_u32 v217, -2, v217
    v_mfma_f32_16x16x32_bf16 v[132:135], v[84:87], v[96:99], v[132:135]
    v_min_u32 v218, -2, v218
    v_min_u32 v219, -2, v219
    buffer_store_dwordx4 v[216:219], v3, s[20:23], s45 offen offset:2048 sc1
    v_mfma_f32_16x16x32_bf16 v[148:151], v[84:87], v[100:103], v[148:151]
    v_cvt_pk_bf16_f32 v220, v184, v185
    v_cvt_pk_bf16_f32 v221, v186, v187
    v_cvt_pk_bf16_f32 v222, v188, v189
    v_mfma_f32_16x16x32_bf16 v[164:167], v[84:87], v[104:107], v[164:167]
    v_cvt_pk_bf16_f32 v223, v190, v191
    v_min_u32 v220, -2, v220
    v_min_u32 v221, -2, v221
    v_mfma_f32_16x16x32_bf16 v[180:183], v[84:87], v[108:111], v[180:183]
    v_min_u32 v222, -2, v222
    v_min_u32 v223, -2, v223
    buffer_store_dwordx4 v[220:223], v3, s[20:23], s45 offen offset:3072 sc1
    buffer_load_dwordx4 v[192:195], v3, s[20:23], s44 offen offset:0 sc1
    buffer_load_dwordx4 v[196:199], v3, s[20:23], s44 offen offset:1024 sc1
    buffer_load_dwordx4 v[200:203], v3, s[20:23], s44 offen offset:2048 sc1
    buffer_load_dwordx4 v[204:207], v3, s[20:23], s44 offen offset:3072 sc1
    s_waitcnt vmcnt(8)
    v_lshlrev_b32 v112, 16, v24
    v_and_b32 v113, 0xffff0000, v24
    v_lshlrev_b32 v114, 16, v25
    v_and_b32 v115, 0xffff0000, v25
    v_lshlrev_b32 v116, 16, v26
    v_and_b32 v117, 0xffff0000, v26
    v_lshlrev_b32 v118, 16, v27
    v_and_b32 v119, 0xffff0000, v27
    v_pk_mul_f32 v[112:113], v[112:113], v[120:121]
    v_pk_mul_f32 v[114:115], v[114:115], v[122:123]
    v_pk_mul_f32 v[116:117], v[116:117], v[124:125]
    v_pk_mul_f32 v[118:119], v[118:119], v[126:127]
    v_mul_f32 v120, 0x40088e99, v120
    v_mul_f32 v121, 0x40088e99, v121
    v_mul_f32 v122, 0x40088e99, v122
    v_mul_f32 v123, 0x40088e99, v123
    v_mul_f32 v124, 0x40088e99, v124
    v_mul_f32 v125, 0x40088e99, v125
    v_mul_f32 v126, 0x40088e99, v126
    v_mul_f32 v127, 0x40088e99, v127
    v_lshlrev_b32 v32, 16, v240
    v_and_b32 v33, 0xffff0000, v240
    v_lshlrev_b32 v34, 16, v241
    v_and_b32 v35, 0xffff0000, v241
    v_lshlrev_b32 v36, 16, v242
    v_and_b32 v37, 0xffff0000, v242
    v_lshlrev_b32 v38, 16, v243
    v_and_b32 v39, 0xffff0000, v243
    v_pk_fma_f32 v[128:129], v[128:129], v[120:121], v[112:113]
    v_pk_fma_f32 v[130:131], v[130:131], v[122:123], v[114:115]
    v_pk_fma_f32 v[132:133], v[132:133], v[124:125], v[116:117]
    v_pk_fma_f32 v[134:135], v[134:135], v[126:127], v[118:119]
    v_pk_add_f32 v[32:33], v[32:33], v[128:129]
    v_pk_add_f32 v[34:35], v[34:35], v[130:131]
    v_pk_add_f32 v[36:37], v[36:37], v[132:133]
    v_pk_add_f32 v[38:39], v[38:39], v[134:135]
    v_lshlrev_b32 v40, 16, v244
    v_and_b32 v41, 0xffff0000, v244
    v_lshlrev_b32 v42, 16, v245
    v_and_b32 v43, 0xffff0000, v245
    v_lshlrev_b32 v44, 16, v246
    v_and_b32 v45, 0xffff0000, v246
    v_lshlrev_b32 v46, 16, v247
    v_and_b32 v47, 0xffff0000, v247
    v_pk_fma_f32 v[144:145], v[144:145], v[120:121], v[112:113]
    v_pk_fma_f32 v[146:147], v[146:147], v[122:123], v[114:115]
    v_pk_fma_f32 v[148:149], v[148:149], v[124:125], v[116:117]
    v_pk_fma_f32 v[150:151], v[150:151], v[126:127], v[118:119]
    v_pk_add_f32 v[40:41], v[40:41], v[144:145]
    v_pk_add_f32 v[42:43], v[42:43], v[146:147]
    v_pk_add_f32 v[44:45], v[44:45], v[148:149]
    v_pk_add_f32 v[46:47], v[46:47], v[150:151]
    v_lshlrev_b32 v48, 16, v248
    v_and_b32 v49, 0xffff0000, v248
    v_lshlrev_b32 v50, 16, v249
    v_and_b32 v51, 0xffff0000, v249
    v_lshlrev_b32 v52, 16, v250
    v_and_b32 v53, 0xffff0000, v250
    v_lshlrev_b32 v54, 16, v251
    v_and_b32 v55, 0xffff0000, v251
    v_pk_fma_f32 v[160:161], v[160:161], v[120:121], v[112:113]
    v_pk_fma_f32 v[162:163], v[162:163], v[122:123], v[114:115]
    v_pk_fma_f32 v[164:165], v[164:165], v[124:125], v[116:117]
    v_pk_fma_f32 v[166:167], v[166:167], v[126:127], v[118:119]
    v_pk_add_f32 v[48:49], v[48:49], v[160:161]
    v_pk_add_f32 v[50:51], v[50:51], v[162:163]
    v_pk_add_f32 v[52:53], v[52:53], v[164:165]
    v_pk_add_f32 v[54:55], v[54:55], v[166:167]
    v_lshlrev_b32 v56, 16, v252
    v_and_b32 v57, 0xffff0000, v252
    v_lshlrev_b32 v58, 16, v253
    v_and_b32 v59, 0xffff0000, v253
    v_lshlrev_b32 v60, 16, v254
    v_and_b32 v61, 0xffff0000, v254
    v_lshlrev_b32 v62, 16, v255
    v_and_b32 v63, 0xffff0000, v255
    v_pk_fma_f32 v[176:177], v[176:177], v[120:121], v[112:113]
    v_pk_fma_f32 v[178:179], v[178:179], v[122:123], v[114:115]
    v_pk_fma_f32 v[180:181], v[180:181], v[124:125], v[116:117]
    v_pk_fma_f32 v[182:183], v[182:183], v[126:127], v[118:119]
    v_pk_add_f32 v[56:57], v[56:57], v[176:177]
    v_pk_add_f32 v[58:59], v[58:59], v[178:179]
    v_pk_add_f32 v[60:61], v[60:61], v[180:181]
    v_pk_add_f32 v[62:63], v[62:63], v[182:183]
    s_mov_b32 s64, 0
    s_branch adaLN_cond__spectral_gfnet__mixer_channel_mlp__prompt_kernel_xc66
adaLN_cond__spectral_gfnet__mixer_channel_mlp__prompt_kernel_xp65:
    buffer_load_dwordx4 v[192:195], v3, s[20:23], s44 offen offset:0 sc1
    buffer_load_dwordx4 v[196:199], v3, s[20:23], s44 offen offset:1024 sc1
    buffer_load_dwordx4 v[200:203], v3, s[20:23], s44 offen offset:2048 sc1
    buffer_load_dwordx4 v[204:207], v3, s[20:23], s44 offen offset:3072 sc1
adaLN_cond__spectral_gfnet__mixer_channel_mlp__prompt_kernel_xc66:
    s_add_u32 s64, s64, 1
    s_waitcnt vmcnt(0)
    v_max3_u32 v4, v192, v193, v194
    v_max3_u32 v5, v195, v196, v197
    v_max3_u32 v4, v4, v198, v199
    v_max3_u32 v5, v5, v200, v201
    v_max3_u32 v4, v4, v202, v203
    v_max3_u32 v5, v5, v204, v205
    v_max3_u32 v4, v4, v206, v207
    v_max_u32 v4, v4, v5
    v_cmp_eq_u32 vcc, -1, v4
    s_cmp_ge_u32 s64, 100000
    s_cbranch_scc1 adaLN_cond__spectral_gfnet__mixer_channel_mlp__prompt_kernel_xe67
    s_nop 2
    s_cbranch_vccnz adaLN_cond__spectral_gfnet__mixer_channel_mlp__prompt_kernel_xp65
adaLN_cond__spectral_gfnet__mixer_channel_mlp__prompt_kernel_xe67:
    v_lshlrev_b32 v112, 16, v192
    v_and_b32 v113, 0xffff0000, v192
    v_lshlrev_b32 v114, 16, v193
    v_and_b32 v115, 0xffff0000, v193
    v_lshlrev_b32 v116, 16, v194
    v_and_b32 v117, 0xffff0000, v194
    v_lshlrev_b32 v118, 16, v195
    v_and_b32 v119, 0xffff0000, v195
    v_pk_fma_f32 v[32:33], v[112:113], v[120:121], v[32:33]
    v_pk_fma_f32 v[34:35], v[114:115], v[122:123], v[34:35]
    v_pk_fma_f32 v[36:37], v[116:117], v[124:125], v[36:37]
    v_pk_fma_f32 v[38:39], v[118:119], v[126:127], v[38:39]
    v_cvt_pk_bf16_f32 v72, v32, v33
    v_cvt_pk_bf16_f32 v73, v34, v35
    v_cvt_pk_bf16_f32 v74, v36, v37
    v_cvt_pk_bf16_f32 v75, v38, v39
    s_nop 0
    v_permlane16_swap_b32 v72, v74
    v_permlane16_swap_b32 v73, v75
    buffer_store_dwordx4 v[72:75], v23, s[12:15], s50 offen sc1
    s_add_u32 s50, s50, 4096
    v_lshlrev_b32 v112, 16, v196
    v_and_b32 v113, 0xffff0000, v196
    v_lshlrev_b32 v114, 16, v197
    v_and_b32 v115, 0xffff0000, v197
    v_lshlrev_b32 v116, 16, v198
    v_and_b32 v117, 0xffff0000, v198
    v_lshlrev_b32 v118, 16, v199
    v_and_b32 v119, 0xffff0000, v199
    v_pk_fma_f32 v[40:41], v[112:113], v[120:121], v[40:41]
    v_pk_fma_f32 v[42:43], v[114:115], v[122:123], v[42:43]
    v_pk_fma_f32 v[44:45], v[116:117], v[124:125], v[44:45]
    v_pk_fma_f32 v[46:47], v[118:119], v[126:127], v[46:47]
    v_cvt_pk_bf16_f32 v76, v40, v41
    v_cvt_pk_bf16_f32 v77, v42, v43
    v_cvt_pk_bf16_f32 v78, v44, v45
    v_cvt_pk_bf16_f32 v79, v46, v47
    s_nop 0
    v_permlane16_swap_b32 v76, v78
    v_permlane16_swap_b32 v77, v79
    buffer_store_dwordx4 v[76:79], v23, s[12:15], s50 offen sc1
    s_add_u32 s50, s50, 4096
    v_lshlrev_b32 v112, 16, v200
    v_and_b32 v113, 0xffff0000, v200
    v_lshlrev_b32 v114, 16, v201
    v_and_b32 v115, 0xffff0000, v201
    v_lshlrev_b32 v116, 16, v202
    v_and_b32 v117, 0xffff0000, v202
    v_lshlrev_b32 v118, 16, v203
    v_and_b32 v119, 0xffff0000, v203
    v_pk_fma_f32 v[48:49], v[112:113], v[120:121], v[48:49]
    v_pk_fma_f32 v[50:51], v[114:115], v[122:123], v[50:51]
    v_pk_fma_f32 v[52:53], v[116:117], v[124:125], v[52:53]
    v_pk_fma_f32 v[54:55], v[118:119], v[126:127], v[54:55]
    v_cvt_pk_bf16_f32 v80, v48, v49
    v_cvt_pk_bf16_f32 v81, v50, v51
    v_cvt_pk_bf16_f32 v82, v52, v53
    v_cvt_pk_bf16_f32 v83, v54, v55
    s_nop 0
    v_permlane16_swap_b32 v80, v82
    v_permlane16_swap_b32 v81, v83
    buffer_store_dwordx4 v[80:83], v23, s[12:15], s50 offen sc1
    s_add_u32 s50, s50, 4096
    v_lshlrev_b32 v112, 16, v204
    v_and_b32 v113, 0xffff0000, v204
    v_lshlrev_b32 v114, 16, v205
    v_and_b32 v115, 0xffff0000, v205
    v_lshlrev_b32 v116, 16, v206
    v_and_b32 v117, 0xffff0000, v206
    v_lshlrev_b32 v118, 16, v207
    v_and_b32 v119, 0xffff0000, v207
    v_pk_fma_f32 v[56:57], v[112:113], v[120:121], v[56:57]
    v_pk_fma_f32 v[58:59], v[114:115], v[122:123], v[58:59]
    v_pk_fma_f32 v[60:61], v[116:117], v[124:125], v[60:61]
    v_pk_fma_f32 v[62:63], v[118:119], v[126:127], v[62:63]
    v_cvt_pk_bf16_f32 v84, v56, v57
    v_cvt_pk_bf16_f32 v85, v58, v59
    v_cvt_pk_bf16_f32 v86, v60, v61
    v_cvt_pk_bf16_f32 v87, v62, v63
    s_nop 0
    v_permlane16_swap_b32 v84, v86
    v_permlane16_swap_b32 v85, v87
    buffer_store_dwordx4 v[84:87], v23, s[12:15], s50 offen sc1
adaLN_cond__spectral_gfnet__mixer_channel_mlp__prompt_kernel_end1:
    s_endpgm
.text
.p2align 8
.type k1_tab,@object
k1_tab:
.long 0x3f803f80,0x3f803f80,0x3f803f80,0x3f803f80,0x3f353f80,0xbf350000,0xbf35bf80,0x3f350000
.long 0x3f80,0xbf80,0x3f80,0xbf80,0xbf353f80,0x3f350000,0x3f35bf80,0xbf350000
.long 0xbf803f80,0xbf803f80,0xbf803f80,0xbf803f80,0xbf353f80,0x3f350000,0x3f35bf80,0xbf350000
.long 0x3f80,0xbf80,0x3f80,0xbf80,0x3f353f80,0xbf350000,0xbf35bf80,0x3f350000
.long 0x3f803f80,0x3f803f80,0x3f803f80,0x3f803f80,0x3f353f80,0xbf350000,0xbf35bf80,0x3f350000
.long 0x3f80,0xbf80,0x3f80,0xbf80,0xbf353f80,0x3f350000,0x3f35bf80,0xbf350000
.long 0xbf803f80,0xbf803f80,0xbf803f80,0xbf803f80,0xbf353f80,0x3f350000,0x3f35bf80,0xbf350000
.long 0x3f80,0xbf80,0x3f80,0xbf80,0x3f353f80,0xbf350000,0xbf35bf80,0x3f350000
.long 0x3f803f80,0x3f803f80,0x3f803f80,0x3f803f80,0x3f0e3f7b,0xbf55be48,0xbf0ebf7b,0x3f553e48
.long 0xbec43f6d,0x3ec4bf6d,0xbec43f6d,0x3ec4bf6d,0xbf7b3f55,0x3e483f0e,0x3f7bbf55,0xbe48bf0e
.long 0xbf353f35,0xbf353f35,0xbf353f35,0xbf353f35,0x3e483f0e,0x3f7bbf55,0xbe48bf0e,0xbf7b3f55
.long 0x3f6d3ec4,0xbf6dbec4,0x3f6d3ec4,0xbf6dbec4,0x3f553e48,0x3f0e3f7b,0xbf55be48,0xbf0ebf7b
.long 0x0,0x0,0x0,0x0,0xbf55be48,0xbf0ebf7b,0x3f553e48,0x3f0e3f7b
.long 0xbf6dbec4,0x3f6d3ec4,0xbf6dbec4,0x3f6d3ec4,0xbe48bf0e,0xbf7b3f55,0x3e483f0e,0x3f7bbf55
.long 0x3f35bf35,0x3f35bf35,0x3f35bf35,0x3f35bf35,0x3f7bbf55,0xbe48bf0e,0xbf7b3f55,0x3e483f0e
.long 0x3ec4bf6d,0xbec43f6d,0x3ec4bf6d,0xbec43f6d,0xbf0ebf7b,0x3f553e48,0x3f0e3f7b,0xbf55be48
.long 0x3f803f80,0x3f803f80,0x3f803f80,0x3f803f80,0x3ec43f6d,0xbf6dbec4,0xbec4bf6d,0x3f6d3ec4
.long 0xbf353f35,0x3f35bf35,0xbf353f35,0x3f35bf35,0xbf6d3ec4,0xbec43f6d,0x3f6dbec4,0x3ec4bf6d
.long 0x0,0x0,0x0,0x0,0x3f6dbec4,0x3ec4bf6d,0xbf6d3ec4,0xbec43f6d
.long 0x3f35bf35,0xbf353f35,0x3f35bf35,0xbf353f35,0xbec4bf6d,0x3f6d3ec4,0x3ec43f6d,0xbf6dbec4
.long 0xbf80bf80,0xbf80bf80,0xbf80bf80,0xbf80bf80,0xbec4bf6d,0x3f6d3ec4,0x3ec43f6d,0xbf6dbec4
.long 0x3f35bf35,0xbf353f35,0x3f35bf35,0xbf353f35,0x3f6dbec4,0x3ec4bf6d,0xbf6d3ec4,0xbec43f6d
.long 0x0,0x0,0x0,0x0,0xbf6d3ec4,0xbec43f6d,0x3f6dbec4,0x3ec4bf6d
.long 0xbf353f35,0x3f35bf35,0xbf353f35,0x3f35bf35,0x3ec43f6d,0xbf6dbec4,0xbec4bf6d,0x3f6d3ec4
.long 0x3f803f80,0x3f803f80,0x3f803f80,0x3f803f80,0x3e483f55,0xbf7bbf0e,0xbe48bf55,0x3f7b3f0e
.long 0xbf6d3ec4,0x3f6dbec4,0xbf6d3ec4,0x3f6dbec4,0xbf0ebe48,0xbf553f7b,0x3f0e3e48,0x3f55bf7b
.long 0x3f35bf35,0x3f35bf35,0x3f35bf35,0x3f35bf35,0x3f55bf7b,0xbf0ebe48,0xbf553f7b,0x3f0e3e48
.long 0xbec4bf6d,0x3ec43f6d,0xbec4bf6d,0x3ec43f6d,0xbf7bbf0e,0xbe48bf55,0x3f7b3f0e,0x3e483f55
.long 0x0,0x0,0x0,0x0,0x3f7b3f0e,0x3e483f55,0xbf7bbf0e,0xbe48bf55
.long 0x3ec43f6d,0xbec4bf6d,0x3ec43f6d,0xbec4bf6d,0xbf553f7b,0x3f0e3e48,0x3f55bf7b,0xbf0ebe48
.long 0xbf353f35,0xbf353f35,0xbf353f35,0xbf353f35,0x3f0e3e48,0x3f55bf7b,0xbf0ebe48,0xbf553f7b
.long 0x3f6dbec4,0xbf6d3ec4,0x3f6dbec4,0xbf6d3ec4,0xbe48bf55,0x3f7b3f0e,0x3e483f55,0xbf7bbf0e
.long 0x3f803f80,0x3f803f80,0x3f803f80,0x3f803f80,0xbf350000,0xbf35bf80,0x3f350000,0x3f353f80
.long 0xbf800000,0x3f800000,0xbf800000,0x3f800000,0xbf350000,0xbf353f80,0x3f350000,0x3f35bf80
.long 0x0,0x0,0x0,0x0,0x3f350000,0x3f35bf80,0xbf350000,0xbf353f80
.long 0x3f800000,0xbf800000,0x3f800000,0xbf800000,0x3f350000,0x3f353f80,0xbf350000,0xbf35bf80
.long 0x0,0x0,0x0,0x0,0xbf350000,0xbf35bf80,0x3f350000,0x3f353f80
.long 0xbf800000,0x3f800000,0xbf800000,0x3f800000,0xbf350000,0xbf353f80,0x3f350000,0x3f35bf80
.long 0x0,0x0,0x0,0x0,0x3f350000,0x3f35bf80,0xbf350000,0xbf353f80
.long 0x3f800000,0xbf800000,0x3f800000,0xbf800000,0x3f350000,0x3f353f80,0xbf350000,0xbf35bf80
.long 0xbf80bf80,0xbf80bf80,0xbf80bf80,0xbf80bf80,0xbf55be48,0xbf0ebf7b,0x3f553e48,0x3f0e3f7b
.long 0xbf6dbec4,0x3f6d3ec4,0xbf6dbec4,0x3f6d3ec4,0xbe48bf0e,0xbf7b3f55,0x3e483f0e,0x3f7bbf55
.long 0x3f35bf35,0x3f35bf35,0x3f35bf35,0x3f35bf35,0x3f7bbf55,0xbe48bf0e,0xbf7b3f55,0x3e483f0e
.long 0x3ec4bf6d,0xbec43f6d,0x3ec4bf6d,0xbec43f6d,0xbf0ebf7b,0x3f553e48,0x3f0e3f7b,0xbf55be48
.long 0xbf80bf80,0xbf80bf80,0xbf80bf80,0xbf80bf80,0xbf0ebf7b,0x3f553e48,0x3f0e3f7b,0xbf55be48
.long 0x3ec4bf6d,0xbec43f6d,0x3ec4bf6d,0xbec43f6d,0x3f7bbf55,0xbe48bf0e,0xbf7b3f55,0x3e483f0e
.long 0x3f35bf35,0x3f35bf35,0x3f35bf35,0x3f35bf35,0xbe48bf0e,0xbf7b3f55,0x3e483f0e,0x3f7bbf55
.long 0xbf6dbec4,0x3f6d3ec4,0xbf6dbec4,0x3f6d3ec4,0xbf55be48,0xbf0ebf7b,0x3f553e48,0x3f0e3f7b
.long 0x3f803f80,0x3f803f80,0x3f803f80,0x3f803f80,0xbf6dbec4,0xbec4bf6d,0x3f6d3ec4,0x3ec43f6d
.long 0xbf35bf35,0x3f353f35,0xbf35bf35,0x3f353f35,0x3ec4bf6d,0xbf6d3ec4,0xbec43f6d,0x3f6dbec4
.long 0x3f80bf80,0x3f80bf80,0x3f80bf80,0x3f80bf80,0x3ec4bf6d,0xbf6d3ec4,0xbec43f6d,0x3f6dbec4
.long 0xbf35bf35,0x3f353f35,0xbf35bf35,0x3f353f35,0xbf6dbec4,0xbec4bf6d,0x3f6d3ec4,0x3ec43f6d
.long 0x0,0x0,0x0,0x0,0x3f6d3ec4,0x3ec43f6d,0xbf6dbec4,0xbec4bf6d
.long 0x3f353f35,0xbf35bf35,0x3f353f35,0xbf35bf35,0xbec43f6d,0x3f6dbec4,0x3ec4bf6d,0xbf6d3ec4
.long 0xbf803f80,0xbf803f80,0xbf803f80,0xbf803f80,0xbec43f6d,0x3f6dbec4,0x3ec4bf6d,0xbf6d3ec4
.long 0x3f353f35,0xbf35bf35,0x3f353f35,0xbf35bf35,0x3f6d3ec4,0x3ec43f6d,0xbf6dbec4,0xbec4bf6d
.long 0xbf80bf80,0xbf80bf80,0xbf80bf80,0xbf80bf80,0xbf7bbf0e,0xbe48bf55,0x3f7b3f0e,0x3e483f55
.long 0xbec4bf6d,0x3ec43f6d,0xbec4bf6d,0x3ec43f6d,0x3f55bf7b,0xbf0ebe48,0xbf553f7b,0x3f0e3e48
.long 0x3f35bf35,0x3f35bf35,0x3f35bf35,0x3f35bf35,0xbf0ebe48,0xbf553f7b,0x3f0e3e48,0x3f55bf7b
.long 0xbf6d3ec4,0x3f6dbec4,0xbf6d3ec4,0x3f6dbec4,0x3e483f55,0xbf7bbf0e,0xbe48bf55,0x3f7b3f0e
.long 0x3f803f80,0x3f803f80,0x3f803f80,0x3f803f80,0x3e483f55,0xbf7bbf0e,0xbe48bf55,0x3f7b3f0e
.long 0xbf6d3ec4,0x3f6dbec4,0xbf6d3ec4,0x3f6dbec4,0xbf0ebe48,0xbf553f7b,0x3f0e3e48,0x3f55bf7b
.long 0x3f35bf35,0x3f35bf35,0x3f35bf35,0x3f35bf35,0x3f55bf7b,0xbf0ebe48,0xbf553f7b,0x3f0e3e48
.long 0xbec4bf6d,0x3ec43f6d,0xbec4bf6d,0x3ec43f6d,0xbf7bbf0e,0xbe48bf55,0x3f7b3f0e,0x3e483f55
.long 0x3f803f80,0x3f803f80,0x3f803f80,0x3f803f80,0x3f7b3f80,0x3f553f6d,0x3f0e3f35,0x3e483ec4
.long 0x3f6d3f80,0x3ec43f35,0xbec40000,0xbf6dbf35,0x3f553f80,0xbe483ec4,0xbf7bbf35,0xbf0ebf6d
.long 0x3f353f80,0xbf350000,0xbf35bf80,0x3f350000,0x3f0e3f80,0xbf7bbec4,0x3e48bf35,0x3f553f6d
.long 0x3ec43f80,0xbf6dbf35,0x3f6d0000,0xbec43f35,0x3e483f80,0xbf0ebf6d,0x3f553f35,0xbf7bbec4
.long 0x3f80,0xbf80,0x3f80,0xbf80,0xbe483f80,0x3f0ebf6d,0xbf553f35,0x3f7bbec4
.long 0xbec43f80,0x3f6dbf35,0xbf6d0000,0x3ec43f35,0xbf0e3f80,0x3f7bbec4,0xbe48bf35,0xbf553f6d
.long 0xbf353f80,0x3f350000,0x3f35bf80,0xbf350000,0xbf553f80,0x3e483ec4,0x3f7bbf35,0x3f0ebf6d
.long 0xbf6d3f80,0xbec43f35,0x3ec40000,0x3f6dbf35,0xbf7b3f80,0xbf553f6d,0xbf0e3f35,0xbe483ec4
.long 0x3f803f80,0x3f803f80,0x3f803f80,0x3f803f80,0xbe480000,0xbf0ebec4,0xbf55bf35,0xbf7bbf6d
.long 0xbf6dbf80,0xbec4bf35,0x3ec40000,0x3f6d3f35,0x3f0e0000,0x3f7b3f6d,0x3e483f35,0xbf55bec4
.long 0x3f353f80,0xbf350000,0xbf35bf80,0x3f350000,0xbf550000,0xbe48bf6d,0x3f7b3f35,0xbf0e3ec4
.long 0xbec4bf80,0x3f6d3f35,0xbf6d0000,0x3ec4bf35,0x3f7b0000,0xbf553ec4,0x3f0ebf35,0xbe483f6d
.long 0x3f80,0xbf80,0x3f80,0xbf80,0xbf7b0000,0x3f553ec4,0xbf0ebf35,0x3e483f6d
.long 0x3ec4bf80,0xbf6d3f35,0x3f6d0000,0xbec4bf35,0x3f550000,0x3e48bf6d,0xbf7b3f35,0x3f0e3ec4
.long 0xbf353f80,0x3f350000,0x3f35bf80,0xbf350000,0xbf0e0000,0xbf7b3f6d,0xbe483f35,0x3f55bec4
.long 0x3f6dbf80,0x3ec4bf35,0xbec40000,0xbf6d3f35,0x3e480000,0x3f0ebec4,0x3f55bf35,0x3f7bbf6d
.long 0x3f803f80,0x3f803f80,0x3f803f80,0x3f803f80,0xbf7bbf80,0xbf55bf6d,0xbf0ebf35,0xbe48bec4
.long 0x3f6d3f80,0x3ec43f35,0xbec40000,0xbf6dbf35,0xbf55bf80,0x3e48bec4,0x3f7b3f35,0x3f0e3f6d
.long 0x3f353f80,0xbf350000,0xbf35bf80,0x3f350000,0xbf0ebf80,0x3f7b3ec4,0xbe483f35,0xbf55bf6d
.long 0x3ec43f80,0xbf6dbf35,0x3f6d0000,0xbec43f35,0xbe48bf80,0x3f0e3f6d,0xbf55bf35,0x3f7b3ec4
.long 0x3f80,0xbf80,0x3f80,0xbf80,0x3e48bf80,0xbf0e3f6d,0x3f55bf35,0xbf7b3ec4
.long 0xbec43f80,0x3f6dbf35,0xbf6d0000,0x3ec43f35,0x3f0ebf80,0xbf7b3ec4,0x3e483f35,0x3f55bf6d
.long 0xbf353f80,0x3f350000,0x3f35bf80,0xbf350000,0x3f55bf80,0xbe48bec4,0xbf7b3f35,0xbf0e3f6d
.long 0xbf6d3f80,0xbec43f35,0x3ec40000,0x3f6dbf35,0x3f7bbf80,0x3f55bf6d,0x3f0ebf35,0x3e48bec4
.long 0x3f803f80,0x3f803f80,0x3f803f80,0x3f803f80,0x3e480000,0x3f0e3ec4,0x3f553f35,0x3f7b3f6d
.long 0xbf6dbf80,0xbec4bf35,0x3ec40000,0x3f6d3f35,0xbf0e0000,0xbf7bbf6d,0xbe48bf35,0x3f553ec4
.long 0x3f353f80,0xbf350000,0xbf35bf80,0x3f350000,0x3f550000,0x3e483f6d,0xbf7bbf35,0x3f0ebec4
.long 0xbec4bf80,0x3f6d3f35,0xbf6d0000,0x3ec4bf35,0xbf7b0000,0x3f55bec4,0xbf0e3f35,0x3e48bf6d
.long 0x3f80,0xbf80,0x3f80,0xbf80,0x3f7b0000,0xbf55bec4,0x3f0e3f35,0xbe48bf6d
.long 0x3ec4bf80,0xbf6d3f35,0x3f6d0000,0xbec4bf35,0xbf550000,0xbe483f6d,0x3f7bbf35,0xbf0ebec4
.long 0xbf353f80,0x3f350000,0x3f35bf80,0xbf350000,0x3f0e0000,0x3f7bbf6d,0x3e48bf35,0xbf553ec4
.long 0x3f6dbf80,0x3ec4bf35,0xbec40000,0xbf6d3f35,0xbe480000,0xbf0e3ec4,0xbf553f35,0xbf7b3f6d
.long 0x0,0x0,0x0,0x0,0x3e480000,0x3f0e3ec4,0x3f553f35,0x3f7b3f6d
.long 0x3ec40000,0x3f6d3f35,0x3f6d3f80,0x3ec43f35,0x3f0e0000,0x3f7b3f6d,0x3e483f35,0xbf55bec4
.long 0x3f350000,0x3f353f80,0xbf350000,0xbf35bf80,0x3f550000,0x3e483f6d,0xbf7bbf35,0x3f0ebec4
.long 0x3f6d0000,0xbec43f35,0xbec4bf80,0x3f6d3f35,0x3f7b0000,0xbf553ec4,0x3f0ebf35,0xbe483f6d
.long 0x3f800000,0xbf800000,0x3f800000,0xbf800000,0x3f7b0000,0xbf55bec4,0x3f0e3f35,0xbe48bf6d
.long 0x3f6d0000,0xbec4bf35,0xbec43f80,0x3f6dbf35,0x3f550000,0x3e48bf6d,0xbf7b3f35,0x3f0e3ec4
.long 0x3f350000,0x3f35bf80,0xbf350000,0xbf353f80,0x3f0e0000,0x3f7bbf6d,0x3e48bf35,0xbf553ec4
.long 0x3ec40000,0x3f6dbf35,0x3f6dbf80,0x3ec4bf35,0x3e480000,0x3f0ebec4,0x3f55bf35,0x3f7bbf6d
.long 0x0,0x0,0x0,0x0,0x3f7b3f80,0x3f553f6d,0x3f0e3f35,0x3e483ec4
.long 0xbec40000,0xbf6dbf35,0xbf6dbf80,0xbec4bf35,0xbf55bf80,0x3e48bec4,0x3f7b3f35,0x3f0e3f6d
.long 0x3f350000,0x3f353f80,0xbf350000,0xbf35bf80,0x3f0e3f80,0xbf7bbec4,0x3e48bf35,0x3f553f6d
.long 0xbf6d0000,0x3ec4bf35,0x3ec43f80,0xbf6dbf35,0xbe48bf80,0x3f0e3f6d,0xbf55bf35,0x3f7b3ec4
.long 0x3f800000,0xbf800000,0x3f800000,0xbf800000,0xbe483f80,0x3f0ebf6d,0xbf553f35,0x3f7bbec4
.long 0xbf6d0000,0x3ec43f35,0x3ec4bf80,0xbf6d3f35,0x3f0ebf80,0xbf7b3ec4,0x3e483f35,0x3f55bf6d
.long 0x3f350000,0x3f35bf80,0xbf350000,0xbf353f80,0xbf553f80,0x3e483ec4,0x3f7bbf35,0x3f0ebf6d
.long 0xbec40000,0xbf6d3f35,0xbf6d3f80,0xbec43f35,0x3f7bbf80,0x3f55bf6d,0x3f0ebf35,0x3e48bec4
.long 0x0,0x0,0x0,0x0,0xbe480000,0xbf0ebec4,0xbf55bf35,0xbf7bbf6d
.long 0x3ec40000,0x3f6d3f35,0x3f6d3f80,0x3ec43f35,0xbf0e0000,0xbf7bbf6d,0xbe48bf35,0x3f553ec4
.long 0x3f350000,0x3f353f80,0xbf350000,0xbf35bf80,0xbf550000,0xbe48bf6d,0x3f7b3f35,0xbf0e3ec4
.long 0x3f6d0000,0xbec43f35,0xbec4bf80,0x3f6d3f35,0xbf7b0000,0x3f55bec4,0xbf0e3f35,0x3e48bf6d
.long 0x3f800000,0xbf800000,0x3f800000,0xbf800000,0xbf7b0000,0x3f553ec4,0xbf0ebf35,0x3e483f6d
.long 0x3f6d0000,0xbec4bf35,0xbec43f80,0x3f6dbf35,0xbf550000,0xbe483f6d,0x3f7bbf35,0xbf0ebec4
.long 0x3f350000,0x3f35bf80,0xbf350000,0xbf353f80,0xbf0e0000,0xbf7b3f6d,0xbe483f35,0x3f55bec4
.long 0x3ec40000,0x3f6dbf35,0x3f6dbf80,0x3ec4bf35,0xbe480000,0xbf0e3ec4,0xbf553f35,0xbf7b3f6d
.long 0x0,0x0,0x0,0x0,0xbf7bbf80,0xbf55bf6d,0xbf0ebf35,0xbe48bec4
.long 0xbec40000,0xbf6dbf35,0xbf6dbf80,0xbec4bf35,0x3f553f80,0xbe483ec4,0xbf7bbf35,0xbf0ebf6d
.long 0x3f350000,0x3f353f80,0xbf350000,0xbf35bf80,0xbf0ebf80,0x3f7b3ec4,0xbe483f35,0xbf55bf6d
.long 0xbf6d0000,0x3ec4bf35,0x3ec43f80,0xbf6dbf35,0x3e483f80,0xbf0ebf6d,0x3f553f35,0xbf7bbec4
.long 0x3f800000,0xbf800000,0x3f800000,0xbf800000,0x3e48bf80,0xbf0e3f6d,0x3f55bf35,0xbf7b3ec4
.long 0xbf6d0000,0x3ec43f35,0x3ec4bf80,0xbf6d3f35,0xbf0e3f80,0x3f7bbec4,0xbe48bf35,0xbf553f6d
.long 0x3f350000,0x3f35bf80,0xbf350000,0xbf353f80,0x3f55bf80,0xbe48bec4,0xbf7b3f35,0xbf0e3f6d
.long 0xbec40000,0xbf6d3f35,0xbf6d3f80,0xbec43f35,0xbf7b3f80,0xbf553f6d,0xbf0e3f35,0xbe483ec4
.long 0x0,0x0,0x0,0x0,0xbe480000,0xbf0ebec4,0xbf55bf35,0xbf7bbf6d
.long 0xbec40000,0xbf6dbf35,0xbf6dbf80,0xbec4bf35,0xbf0e0000,0xbf7bbf6d,0xbe48bf35,0x3f553ec4
.long 0xbf350000,0xbf35bf80,0x3f350000,0x3f353f80,0xbf550000,0xbe48bf6d,0x3f7b3f35,0xbf0e3ec4
.long 0xbf6d0000,0x3ec4bf35,0x3ec43f80,0xbf6dbf35,0xbf7b0000,0x3f55bec4,0xbf0e3f35,0x3e48bf6d
.long 0xbf800000,0x3f800000,0xbf800000,0x3f800000,0xbf7b0000,0x3f553ec4,0xbf0ebf35,0x3e483f6d
.long 0xbf6d0000,0x3ec43f35,0x3ec4bf80,0xbf6d3f35,0xbf550000,0xbe483f6d,0x3f7bbf35,0xbf0ebec4
.long 0xbf350000,0xbf353f80,0x3f350000,0x3f35bf80,0xbf0e0000,0xbf7b3f6d,0xbe483f35,0x3f55bec4
.long 0xbec40000,0xbf6d3f35,0xbf6d3f80,0xbec43f35,0xbe480000,0xbf0e3ec4,0xbf553f35,0xbf7b3f6d
.long 0x0,0x0,0x0,0x0,0xbf7bbf80,0xbf55bf6d,0xbf0ebf35,0xbe48bec4
.long 0x3ec40000,0x3f6d3f35,0x3f6d3f80,0x3ec43f35,0x3f553f80,0xbe483ec4,0xbf7bbf35,0xbf0ebf6d
.long 0xbf350000,0xbf35bf80,0x3f350000,0x3f353f80,0xbf0ebf80,0x3f7b3ec4,0xbe483f35,0xbf55bf6d
.long 0x3f6d0000,0xbec43f35,0xbec4bf80,0x3f6d3f35,0x3e483f80,0xbf0ebf6d,0x3f553f35,0xbf7bbec4
.long 0xbf800000,0x3f800000,0xbf800000,0x3f800000,0x3e48bf80,0xbf0e3f6d,0x3f55bf35,0xbf7b3ec4
.long 0x3f6d0000,0xbec4bf35,0xbec43f80,0x3f6dbf35,0xbf0e3f80,0x3f7bbec4,0xbe48bf35,0xbf553f6d
.long 0xbf350000,0xbf353f80,0x3f350000,0x3f35bf80,0x3f55bf80,0xbe48bec4,0xbf7b3f35,0xbf0e3f6d
.long 0x3ec40000,0x3f6dbf35,0x3f6dbf80,0x3ec4bf35,0xbf7b3f80,0xbf553f6d,0xbf0e3f35,0xbe483ec4
.long 0x0,0x0,0x0,0x0,0x3e480000,0x3f0e3ec4,0x3f553f35,0x3f7b3f6d
.long 0xbec40000,0xbf6dbf35,0xbf6dbf80,0xbec4bf35,0x3f0e0000,0x3f7b3f6d,0x3e483f35,0xbf55bec4
.long 0xbf350000,0xbf35bf80,0x3f350000,0x3f353f80,0x3f550000,0x3e483f6d,0xbf7bbf35,0x3f0ebec4
.long 0xbf6d0000,0x3ec4bf35,0x3ec43f80,0xbf6dbf35,0x3f7b0000,0xbf553ec4,0x3f0ebf35,0xbe483f6d
.long 0xbf800000,0x3f800000,0xbf800000,0x3f800000,0x3f7b0000,0xbf55bec4,0x3f0e3f35,0xbe48bf6d
.long 0xbf6d0000,0x3ec43f35,0x3ec4bf80,0xbf6d3f35,0x3f550000,0x3e48bf6d,0xbf7b3f35,0x3f0e3ec4
.long 0xbf350000,0xbf353f80,0x3f350000,0x3f35bf80,0x3f0e0000,0x3f7bbf6d,0x3e48bf35,0xbf553ec4
.long 0xbec40000,0xbf6d3f35,0xbf6d3f80,0xbec43f35,0x3e480000,0x3f0ebec4,0x3f55bf35,0x3f7bbf6d
.long 0x0,0x0,0x0,0x0,0x3f7b3f80,0x3f553f6d,0x3f0e3f35,0x3e483ec4
.long 0x3ec40000,0x3f6d3f35,0x3f6d3f80,0x3ec43f35,0xbf55bf80,0x3e48bec4,0x3f7b3f35,0x3f0e3f6d
.long 0xbf350000,0xbf35bf80,0x3f350000,0x3f353f80,0x3f0e3f80,0xbf7bbec4,0x3e48bf35,0x3f553f6d
.long 0x3f6d0000,0xbec43f35,0xbec4bf80,0x3f6d3f35,0xbe48bf80,0x3f0e3f6d,0xbf55bf35,0x3f7b3ec4
.long 0xbf800000,0x3f800000,0xbf800000,0x3f800000,0xbe483f80,0x3f0ebf6d,0xbf553f35,0x3f7bbec4
.long 0x3f6d0000,0xbec4bf35,0xbec43f80,0x3f6dbf35,0x3f0ebf80,0xbf7b3ec4,0x3e483f35,0x3f55bf6d
.long 0xbf350000,0xbf353f80,0x3f350000,0x3f35bf80,0xbf553f80,0x3e483ec4,0x3f7bbf35,0x3f0ebf6d
.long 0x3ec40000,0x3f6dbf35,0x3f6dbf80,0x3ec4bf35,0x3f7bbf80,0x3f55bf6d,0x3f0ebf35,0x3e48bec4
.long 0x3f7b3f80,0x3f553f6d,0x3f0e3f35,0x3e483ec4,0x3f6d3f80,0x3ec43f35,0xbec40000,0xbf6dbf35
.long 0x3f553f80,0xbe483ec4,0xbf7bbf35,0xbf0ebf6d,0x3f353f80,0xbf350000,0xbf35bf80,0x3f350000
.long 0x3f0e3f80,0xbf7bbec4,0x3e48bf35,0x3f553f6d,0x3ec43f80,0xbf6dbf35,0x3f6d0000,0xbec43f35
.long 0x3e483f80,0xbf0ebf6d,0x3f553f35,0xbf7bbec4,0x3f80,0xbf80,0x3f80,0xbf80
.long 0xbe483f80,0x3f0ebf6d,0xbf553f35,0x3f7bbec4,0xbec43f80,0x3f6dbf35,0xbf6d0000,0x3ec43f35
.long 0xbf0e3f80,0x3f7bbec4,0xbe48bf35,0xbf553f6d,0xbf353f80,0x3f350000,0x3f35bf80,0xbf350000
.long 0xbf553f80,0x3e483ec4,0x3f7bbf35,0x3f0ebf6d,0xbf6d3f80,0xbec43f35,0x3ec40000,0x3f6dbf35
.long 0xbf7b3f80,0xbf553f6d,0xbf0e3f35,0xbe483ec4,0xbf803f80,0xbf803f80,0xbf803f80,0xbf803f80
.long 0xbe480000,0xbf0ebec4,0xbf55bf35,0xbf7bbf6d,0xbf6dbf80,0xbec4bf35,0x3ec40000,0x3f6d3f35
.long 0x3f0e0000,0x3f7b3f6d,0x3e483f35,0xbf55bec4,0x3f353f80,0xbf350000,0xbf35bf80,0x3f350000
.long 0xbf550000,0xbe48bf6d,0x3f7b3f35,0xbf0e3ec4,0xbec4bf80,0x3f6d3f35,0xbf6d0000,0x3ec4bf35
.long 0x3f7b0000,0xbf553ec4,0x3f0ebf35,0xbe483f6d,0x3f80,0xbf80,0x3f80,0xbf80
.long 0xbf7b0000,0x3f553ec4,0xbf0ebf35,0x3e483f6d,0x3ec4bf80,0xbf6d3f35,0x3f6d0000,0xbec4bf35
.long 0x3f550000,0x3e48bf6d,0xbf7b3f35,0x3f0e3ec4,0xbf353f80,0x3f350000,0x3f35bf80,0xbf350000
.long 0xbf0e0000,0xbf7b3f6d,0xbe483f35,0x3f55bec4,0x3f6dbf80,0x3ec4bf35,0xbec40000,0xbf6d3f35
.long 0x3e480000,0x3f0ebec4,0x3f55bf35,0x3f7bbf6d,0xbf803f80,0xbf803f80,0xbf803f80,0xbf803f80
.long 0xbf7bbf80,0xbf55bf6d,0xbf0ebf35,0xbe48bec4,0x3f6d3f80,0x3ec43f35,0xbec40000,0xbf6dbf35
.long 0xbf55bf80,0x3e48bec4,0x3f7b3f35,0x3f0e3f6d,0x3f353f80,0xbf350000,0xbf35bf80,0x3f350000
.long 0xbf0ebf80,0x3f7b3ec4,0xbe483f35,0xbf55bf6d,0x3ec43f80,0xbf6dbf35,0x3f6d0000,0xbec43f35
.long 0xbe48bf80,0x3f0e3f6d,0xbf55bf35,0x3f7b3ec4,0x3f80,0xbf80,0x3f80,0xbf80
.long 0x3e48bf80,0xbf0e3f6d,0x3f55bf35,0xbf7b3ec4,0xbec43f80,0x3f6dbf35,0xbf6d0000,0x3ec43f35
.long 0x3f0ebf80,0xbf7b3ec4,0x3e483f35,0x3f55bf6d,0xbf353f80,0x3f350000,0x3f35bf80,0xbf350000
.long 0x3f55bf80,0xbe48bec4,0xbf7b3f35,0xbf0e3f6d,0xbf6d3f80,0xbec43f35,0x3ec40000,0x3f6dbf35
.long 0x3f7bbf80,0x3f55bf6d,0x3f0ebf35,0x3e48bec4,0xbf803f80,0xbf803f80,0xbf803f80,0xbf803f80
.long 0x3e480000,0x3f0e3ec4,0x3f553f35,0x3f7b3f6d,0xbf6dbf80,0xbec4bf35,0x3ec40000,0x3f6d3f35
.long 0xbf0e0000,0xbf7bbf6d,0xbe48bf35,0x3f553ec4,0x3f353f80,0xbf350000,0xbf35bf80,0x3f350000
.long 0x3f550000,0x3e483f6d,0xbf7bbf35,0x3f0ebec4,0xbec4bf80,0x3f6d3f35,0xbf6d0000,0x3ec4bf35
.long 0xbf7b0000,0x3f55bec4,0xbf0e3f35,0x3e48bf6d,0x3f80,0xbf80,0x3f80,0xbf80
.long 0x3f7b0000,0xbf55bec4,0x3f0e3f35,0xbe48bf6d,0x3ec4bf80,0xbf6d3f35,0x3f6d0000,0xbec4bf35
.long 0xbf550000,0xbe483f6d,0x3f7bbf35,0xbf0ebec4,0xbf353f80,0x3f350000,0x3f35bf80,0xbf350000
.long 0x3f0e0000,0x3f7bbf6d,0x3e48bf35,0xbf553ec4,0x3f6dbf80,0x3ec4bf35,0xbec40000,0xbf6d3f35
.long 0xbe480000,0xbf0e3ec4,0xbf553f35,0xbf7b3f6d,0xbf803f80,0xbf803f80,0xbf803f80,0xbf803f80
.long 0xbe480000,0xbf0ebec4,0xbf55bf35,0xbf7bbf6d,0xbec40000,0xbf6dbf35,0xbf6dbf80,0xbec4bf35
.long 0xbf0e0000,0xbf7bbf6d,0xbe48bf35,0x3f553ec4,0xbf350000,0xbf35bf80,0x3f350000,0x3f353f80
.long 0xbf550000,0xbe48bf6d,0x3f7b3f35,0xbf0e3ec4,0xbf6d0000,0x3ec4bf35,0x3ec43f80,0xbf6dbf35
.long 0xbf7b0000,0x3f55bec4,0xbf0e3f35,0x3e48bf6d,0xbf800000,0x3f800000,0xbf800000,0x3f800000
.long 0xbf7b0000,0x3f553ec4,0xbf0ebf35,0x3e483f6d,0xbf6d0000,0x3ec43f35,0x3ec4bf80,0xbf6d3f35
.long 0xbf550000,0xbe483f6d,0x3f7bbf35,0xbf0ebec4,0xbf350000,0xbf353f80,0x3f350000,0x3f35bf80
.long 0xbf0e0000,0xbf7b3f6d,0xbe483f35,0x3f55bec4,0xbec40000,0xbf6d3f35,0xbf6d3f80,0xbec43f35
.long 0xbe480000,0xbf0e3ec4,0xbf553f35,0xbf7b3f6d,0x0,0x0,0x0,0x0
.long 0xbf7bbf80,0xbf55bf6d,0xbf0ebf35,0xbe48bec4,0x3ec40000,0x3f6d3f35,0x3f6d3f80,0x3ec43f35
.long 0x3f553f80,0xbe483ec4,0xbf7bbf35,0xbf0ebf6d,0xbf350000,0xbf35bf80,0x3f350000,0x3f353f80
.long 0xbf0ebf80,0x3f7b3ec4,0xbe483f35,0xbf55bf6d,0x3f6d0000,0xbec43f35,0xbec4bf80,0x3f6d3f35
.long 0x3e483f80,0xbf0ebf6d,0x3f553f35,0xbf7bbec4,0xbf800000,0x3f800000,0xbf800000,0x3f800000
.long 0x3e48bf80,0xbf0e3f6d,0x3f55bf35,0xbf7b3ec4,0x3f6d0000,0xbec4bf35,0xbec43f80,0x3f6dbf35
.long 0xbf0e3f80,0x3f7bbec4,0xbe48bf35,0xbf553f6d,0xbf350000,0xbf353f80,0x3f350000,0x3f35bf80
.long 0x3f55bf80,0xbe48bec4,0xbf7b3f35,0xbf0e3f6d,0x3ec40000,0x3f6dbf35,0x3f6dbf80,0x3ec4bf35
.long 0xbf7b3f80,0xbf553f6d,0xbf0e3f35,0xbe483ec4,0x0,0x0,0x0,0x0
.long 0x3e480000,0x3f0e3ec4,0x3f553f35,0x3f7b3f6d,0xbec40000,0xbf6dbf35,0xbf6dbf80,0xbec4bf35
.long 0x3f0e0000,0x3f7b3f6d,0x3e483f35,0xbf55bec4,0xbf350000,0xbf35bf80,0x3f350000,0x3f353f80
.long 0x3f550000,0x3e483f6d,0xbf7bbf35,0x3f0ebec4,0xbf6d0000,0x3ec4bf35,0x3ec43f80,0xbf6dbf35
.long 0x3f7b0000,0xbf553ec4,0x3f0ebf35,0xbe483f6d,0xbf800000,0x3f800000,0xbf800000,0x3f800000
.long 0x3f7b0000,0xbf55bec4,0x3f0e3f35,0xbe48bf6d,0xbf6d0000,0x3ec43f35,0x3ec4bf80,0xbf6d3f35
.long 0x3f550000,0x3e48bf6d,0xbf7b3f35,0x3f0e3ec4,0xbf350000,0xbf353f80,0x3f350000,0x3f35bf80
.long 0x3f0e0000,0x3f7bbf6d,0x3e48bf35,0xbf553ec4,0xbec40000,0xbf6d3f35,0xbf6d3f80,0xbec43f35
.long 0x3e480000,0x3f0ebec4,0x3f55bf35,0x3f7bbf6d,0x0,0x0,0x0,0x0
.long 0x3f7b3f80,0x3f553f6d,0x3f0e3f35,0x3e483ec4,0x3ec40000,0x3f6d3f35,0x3f6d3f80,0x3ec43f35
.long 0xbf55bf80,0x3e48bec4,0x3f7b3f35,0x3f0e3f6d,0xbf350000,0xbf35bf80,0x3f350000,0x3f353f80
.long 0x3f0e3f80,0xbf7bbec4,0x3e48bf35,0x3f553f6d,0x3f6d0000,0xbec43f35,0xbec4bf80,0x3f6d3f35
.long 0xbe48bf80,0x3f0e3f6d,0xbf55bf35,0x3f7b3ec4,0xbf800000,0x3f800000,0xbf800000,0x3f800000
.long 0xbe483f80,0x3f0ebf6d,0xbf553f35,0x3f7bbec4,0x3f6d0000,0xbec4bf35,0xbec43f80,0x3f6dbf35
.long 0x3f0ebf80,0xbf7b3ec4,0x3e483f35,0x3f55bf6d,0xbf350000,0xbf353f80,0x3f350000,0x3f35bf80
.long 0xbf553f80,0x3e483ec4,0x3f7bbf35,0x3f0ebf6d,0x3ec40000,0x3f6dbf35,0x3f6dbf80,0x3ec4bf35
.long 0x3f7bbf80,0x3f55bf6d,0x3f0ebf35,0x3e48bec4,0x0,0x0,0x0,0x0
.long 0xbf7bbf80,0xbf55bf6d,0xbf0ebf35,0xbe48bec4,0xbf6dbf80,0xbec4bf35,0x3ec40000,0x3f6d3f35
.long 0xbf55bf80,0x3e48bec4,0x3f7b3f35,0x3f0e3f6d,0xbf35bf80,0x3f350000,0x3f353f80,0xbf350000
.long 0xbf0ebf80,0x3f7b3ec4,0xbe483f35,0xbf55bf6d,0xbec4bf80,0x3f6d3f35,0xbf6d0000,0x3ec4bf35
.long 0xbe48bf80,0x3f0e3f6d,0xbf55bf35,0x3f7b3ec4,0xbf80,0x3f80,0xbf80,0x3f80
.long 0x3e48bf80,0xbf0e3f6d,0x3f55bf35,0xbf7b3ec4,0x3ec4bf80,0xbf6d3f35,0x3f6d0000,0xbec4bf35
.long 0x3f0ebf80,0xbf7b3ec4,0x3e483f35,0x3f55bf6d,0x3f35bf80,0xbf350000,0xbf353f80,0x3f350000
.long 0x3f55bf80,0xbe48bec4,0xbf7b3f35,0xbf0e3f6d,0x3f6dbf80,0x3ec4bf35,0xbec40000,0xbf6d3f35
.long 0x3f7bbf80,0x3f55bf6d,0x3f0ebf35,0x3e48bec4,0x3f80bf80,0x3f80bf80,0x3f80bf80,0x3f80bf80
.long 0x3e480000,0x3f0e3ec4,0x3f553f35,0x3f7b3f6d,0x3f6d3f80,0x3ec43f35,0xbec40000,0xbf6dbf35
.long 0xbf0e0000,0xbf7bbf6d,0xbe48bf35,0x3f553ec4,0xbf35bf80,0x3f350000,0x3f353f80,0xbf350000
.long 0x3f550000,0x3e483f6d,0xbf7bbf35,0x3f0ebec4,0x3ec43f80,0xbf6dbf35,0x3f6d0000,0xbec43f35
.long 0xbf7b0000,0x3f55bec4,0xbf0e3f35,0x3e48bf6d,0xbf80,0x3f80,0xbf80,0x3f80
.long 0x3f7b0000,0xbf55bec4,0x3f0e3f35,0xbe48bf6d,0xbec43f80,0x3f6dbf35,0xbf6d0000,0x3ec43f35
.long 0xbf550000,0xbe483f6d,0x3f7bbf35,0xbf0ebec4,0x3f35bf80,0xbf350000,0xbf353f80,0x3f350000
.long 0x3f0e0000,0x3f7bbf6d,0x3e48bf35,0xbf553ec4,0xbf6d3f80,0xbec43f35,0x3ec40000,0x3f6dbf35
.long 0xbe480000,0xbf0e3ec4,0xbf553f35,0xbf7b3f6d,0x3f80bf80,0x3f80bf80,0x3f80bf80,0x3f80bf80
.long 0x3f7b3f80,0x3f553f6d,0x3f0e3f35,0x3e483ec4,0xbf6dbf80,0xbec4bf35,0x3ec40000,0x3f6d3f35
.long 0x3f553f80,0xbe483ec4,0xbf7bbf35,0xbf0ebf6d,0xbf35bf80,0x3f350000,0x3f353f80,0xbf350000
.long 0x3f0e3f80,0xbf7bbec4,0x3e48bf35,0x3f553f6d,0xbec4bf80,0x3f6d3f35,0xbf6d0000,0x3ec4bf35
.long 0x3e483f80,0xbf0ebf6d,0x3f553f35,0xbf7bbec4,0xbf80,0x3f80,0xbf80,0x3f80
.long 0xbe483f80,0x3f0ebf6d,0xbf553f35,0x3f7bbec4,0x3ec4bf80,0xbf6d3f35,0x3f6d0000,0xbec4bf35
.long 0xbf0e3f80,0x3f7bbec4,0xbe48bf35,0xbf553f6d,0x3f35bf80,0xbf350000,0xbf353f80,0x3f350000
.long 0xbf553f80,0x3e483ec4,0x3f7bbf35,0x3f0ebf6d,0x3f6dbf80,0x3ec4bf35,0xbec40000,0xbf6d3f35
.long 0xbf7b3f80,0xbf553f6d,0xbf0e3f35,0xbe483ec4,0x3f80bf80,0x3f80bf80,0x3f80bf80,0x3f80bf80
.long 0xbe480000,0xbf0ebec4,0xbf55bf35,0xbf7bbf6d,0x3f6d3f80,0x3ec43f35,0xbec40000,0xbf6dbf35
.long 0x3f0e0000,0x3f7b3f6d,0x3e483f35,0xbf55bec4,0xbf35bf80,0x3f350000,0x3f353f80,0xbf350000
.long 0xbf550000,0xbe48bf6d,0x3f7b3f35,0xbf0e3ec4,0x3ec43f80,0xbf6dbf35,0x3f6d0000,0xbec43f35
.long 0x3f7b0000,0xbf553ec4,0x3f0ebf35,0xbe483f6d,0xbf80,0x3f80,0xbf80,0x3f80
.long 0xbf7b0000,0x3f553ec4,0xbf0ebf35,0x3e483f6d,0xbec43f80,0x3f6dbf35,0xbf6d0000,0x3ec43f35
.long 0x3f550000,0x3e48bf6d,0xbf7b3f35,0x3f0e3ec4,0x3f35bf80,0xbf350000,0xbf353f80,0x3f350000
.long 0xbf0e0000,0xbf7b3f6d,0xbe483f35,0x3f55bec4,0xbf6d3f80,0xbec43f35,0x3ec40000,0x3f6dbf35
.long 0x3e480000,0x3f0ebec4,0x3f55bf35,0x3f7bbf6d,0x3f80bf80,0x3f80bf80,0x3f80bf80,0x3f80bf80
.long 0xbf803f80,0xbf803f80,0xbf803f80,0xbf803f80,0xbe480000,0xbf0ebec4,0xbf55bf35,0xbf7bbf6d
.long 0xbec40000,0xbf6dbf35,0xbf6dbf80,0xbec4bf35,0xbf0e0000,0xbf7bbf6d,0xbe48bf35,0x3f553ec4
.long 0xbf350000,0xbf35bf80,0x3f350000,0x3f353f80,0xbf550000,0xbe48bf6d,0x3f7b3f35,0xbf0e3ec4
.long 0xbf6d0000,0x3ec4bf35,0x3ec43f80,0xbf6dbf35,0xbf7b0000,0x3f55bec4,0xbf0e3f35,0x3e48bf6d
.long 0xbf800000,0x3f800000,0xbf800000,0x3f800000,0xbf7b0000,0x3f553ec4,0xbf0ebf35,0x3e483f6d
.long 0xbf6d0000,0x3ec43f35,0x3ec4bf80,0xbf6d3f35,0xbf550000,0xbe483f6d,0x3f7bbf35,0xbf0ebec4
.long 0xbf350000,0xbf353f80,0x3f350000,0x3f35bf80,0xbf0e0000,0xbf7b3f6d,0xbe483f35,0x3f55bec4
.long 0xbec40000,0xbf6d3f35,0xbf6d3f80,0xbec43f35,0xbe480000,0xbf0e3ec4,0xbf553f35,0xbf7b3f6d
.long 0xbf803f80,0xbf803f80,0xbf803f80,0xbf803f80,0xbf7bbf80,0xbf55bf6d,0xbf0ebf35,0xbe48bec4
.long 0x3ec40000,0x3f6d3f35,0x3f6d3f80,0x3ec43f35,0x3f553f80,0xbe483ec4,0xbf7bbf35,0xbf0ebf6d
.long 0xbf350000,0xbf35bf80,0x3f350000,0x3f353f80,0xbf0ebf80,0x3f7b3ec4,0xbe483f35,0xbf55bf6d
.long 0x3f6d0000,0xbec43f35,0xbec4bf80,0x3f6d3f35,0x3e483f80,0xbf0ebf6d,0x3f553f35,0xbf7bbec4
.long 0xbf800000,0x3f800000,0xbf800000,0x3f800000,0x3e48bf80,0xbf0e3f6d,0x3f55bf35,0xbf7b3ec4
.long 0x3f6d0000,0xbec4bf35,0xbec43f80,0x3f6dbf35,0xbf0e3f80,0x3f7bbec4,0xbe48bf35,0xbf553f6d
.long 0xbf350000,0xbf353f80,0x3f350000,0x3f35bf80,0x3f55bf80,0xbe48bec4,0xbf7b3f35,0xbf0e3f6d
.long 0x3ec40000,0x3f6dbf35,0x3f6dbf80,0x3ec4bf35,0xbf7b3f80,0xbf553f6d,0xbf0e3f35,0xbe483ec4
.long 0xbf803f80,0xbf803f80,0xbf803f80,0xbf803f80,0x3e480000,0x3f0e3ec4,0x3f553f35,0x3f7b3f6d
.long 0xbec40000,0xbf6dbf35,0xbf6dbf80,0xbec4bf35,0x3f0e0000,0x3f7b3f6d,0x3e483f35,0xbf55bec4
.long 0xbf350000,0xbf35bf80,0x3f350000,0x3f353f80,0x3f550000,0x3e483f6d,0xbf7bbf35,0x3f0ebec4
.long 0xbf6d0000,0x3ec4bf35,0x3ec43f80,0xbf6dbf35,0x3f7b0000,0xbf553ec4,0x3f0ebf35,0xbe483f6d
.long 0xbf800000,0x3f800000,0xbf800000,0x3f800000,0x3f7b0000,0xbf55bec4,0x3f0e3f35,0xbe48bf6d
.long 0xbf6d0000,0x3ec43f35,0x3ec4bf80,0xbf6d3f35,0x3f550000,0x3e48bf6d,0xbf7b3f35,0x3f0e3ec4
.long 0xbf350000,0xbf353f80,0x3f350000,0x3f35bf80,0x3f0e0000,0x3f7bbf6d,0x3e48bf35,0xbf553ec4
.long 0xbec40000,0xbf6d3f35,0xbf6d3f80,0xbec43f35,0x3e480000,0x3f0ebec4,0x3f55bf35,0x3f7bbf6d
.long 0xbf803f80,0xbf803f80,0xbf803f80,0xbf803f80,0x3f7b3f80,0x3f553f6d,0x3f0e3f35,0x3e483ec4
.long 0x3ec40000,0x3f6d3f35,0x3f6d3f80,0x3ec43f35,0xbf55bf80,0x3e48bec4,0x3f7b3f35,0x3f0e3f6d
.long 0xbf350000,0xbf35bf80,0x3f350000,0x3f353f80,0x3f0e3f80,0xbf7bbec4,0x3e48bf35,0x3f553f6d
.long 0x3f6d0000,0xbec43f35,0xbec4bf80,0x3f6d3f35,0xbe48bf80,0x3f0e3f6d,0xbf55bf35,0x3f7b3ec4
.long 0xbf800000,0x3f800000,0xbf800000,0x3f800000,0xbe483f80,0x3f0ebf6d,0xbf553f35,0x3f7bbec4
.long 0x3f6d0000,0xbec4bf35,0xbec43f80,0x3f6dbf35,0x3f0ebf80,0xbf7b3ec4,0x3e483f35,0x3f55bf6d
.long 0xbf350000,0xbf353f80,0x3f350000,0x3f35bf80,0xbf553f80,0x3e483ec4,0x3f7bbf35,0x3f0ebf6d
.long 0x3ec40000,0x3f6dbf35,0x3f6dbf80,0x3ec4bf35,0x3f7bbf80,0x3f55bf6d,0x3f0ebf35,0x3e48bec4
.long 0x3f7f3f80,0x3f753f7b,0x3f623f6d,0x3f463f55,0x3f753f80,0x3f223f55,0x3dc93ec4,0xbef1be48
.long 0x3f623f80,0x3dc93f0e,0xbf46bec4,0xbf75bf7b,0x3f463f80,0xbef13e48,0xbf75bf6d,0x3dc9bf0e
.long 0x3f223f80,0xbf62be48,0xbe95bf6d,0x3f7f3f0e,0x3ef13f80,0xbf7fbf0e,0x3f22bec4,0x3e953f7b
.long 0x3e953f80,0xbf46bf55,0x3f7f3ec4,0xbf623e48,0x3dc93f80,0xbe95bf7b,0x3ef13f6d,0xbf22bf55
.long 0xbdc93f80,0x3e95bf7b,0xbef13f6d,0x3f22bf55,0xbe953f80,0x3f46bf55,0xbf7f3ec4,0x3f623e48
.long 0xbef13f80,0x3f7fbf0e,0xbf22bec4,0xbe953f7b,0xbf223f80,0x3f62be48,0x3e95bf6d,0xbf7f3f0e
.long 0xbf463f80,0x3ef13e48,0x3f75bf6d,0xbdc9bf0e,0xbf623f80,0xbdc93f0e,0x3f46bec4,0x3f75bf7b
.long 0xbf753f80,0xbf223f55,0xbdc93ec4,0x3ef1be48,0xbf7f3f80,0xbf753f7b,0xbf623f6d,0xbf463f55
.long 0x3f223f35,0x3ef13f0e,0x3e953ec4,0x3dc93e48,0xbf62bf35,0xbf7fbf7b,0xbf46bf6d,0xbe95bf0e
.long 0xbe95bf35,0x3f223e48,0x3f7f3f6d,0x3ef13f55,0x3f7f3f35,0x3e953f55,0xbf62bec4,0xbf22bf7b
.long 0xbdc93f35,0xbf75bf55,0x3ef1bec4,0x3f463f7b,0xbf75bf35,0x3f46be48,0x3dc93f6d,0xbf62bf55
.long 0x3ef1bf35,0x3dc93f7b,0xbf22bf6d,0x3f753f0e,0x3f463f35,0xbf62bf0e,0x3f753ec4,0xbf7fbe48
.long 0xbf463f35,0x3f62bf0e,0xbf753ec4,0x3f7fbe48,0xbef1bf35,0xbdc93f7b,0x3f22bf6d,0xbf753f0e
.long 0x3f75bf35,0xbf46be48,0xbdc93f6d,0x3f62bf55,0x3dc93f35,0x3f75bf55,0xbef1bec4,0xbf463f7b
.long 0xbf7f3f35,0xbe953f55,0x3f62bec4,0x3f22bf7b,0x3e95bf35,0xbf223e48,0xbf7f3f6d,0xbef13f55
.long 0x3f62bf35,0x3f7fbf7b,0x3f46bf6d,0x3e95bf0e,0xbf223f35,0xbef13f0e,0xbe953ec4,0xbdc93e48
.long 0xbdc90000,0xbe95be48,0xbef1bec4,0xbf22bf0e,0x3e950000,0x3f463f0e,0x3f7f3f6d,0x3f623f7b
.long 0xbef10000,0xbf7fbf55,0xbf22bf6d,0x3e95be48,0x3f220000,0x3f623f7b,0xbe953ec4,0xbf7fbf55
.long 0xbf460000,0xbef1bf7b,0x3f753ec4,0x3dc93f55,0x3f620000,0xbdc93f55,0xbf46bf6d,0x3f753e48
.long 0xbf750000,0x3f22bf0e,0xbdc93f6d,0xbef1bf7b,0x3f7f0000,0xbf753e48,0x3f62bec4,0xbf463f0e
.long 0xbf7f0000,0x3f753e48,0xbf62bec4,0x3f463f0e,0x3f750000,0xbf22bf0e,0x3dc93f6d,0x3ef1bf7b
.long 0xbf620000,0x3dc93f55,0x3f46bf6d,0xbf753e48,0x3f460000,0x3ef1bf7b,0xbf753ec4,0xbdc93f55
.long 0xbf220000,0xbf623f7b,0x3e953ec4,0x3f7fbf55,0x3ef10000,0x3f7fbf55,0x3f22bf6d,0xbe95be48
.long 0xbe950000,0xbf463f0e,0xbf7f3f6d,0xbf623f7b,0x3dc90000,0x3e95be48,0x3ef1bec4,0x3f22bf0e
.long 0xbf46bf35,0xbf62bf55,0xbf75bf6d,0xbf7fbf7b,0x3ef13f35,0xbdc93e48,0xbf22bec4,0xbf75bf55
.long 0x3f753f35,0x3f463f7b,0xbdc93ec4,0xbf62bf0e,0xbdc9bf35,0x3f753f0e,0x3ef13f6d,0xbf46be48
.long 0xbf7fbf35,0x3e95bf0e,0x3f623f6d,0xbf223e48,0xbe953f35,0xbf22bf7b,0x3f7f3ec4,0xbef13f0e
.long 0x3f623f35,0xbf7fbe48,0x3f46bec4,0xbe953f55,0x3f22bf35,0xbef13f55,0x3e95bf6d,0xbdc93f7b
.long 0xbf22bf35,0x3ef13f55,0xbe95bf6d,0x3dc93f7b,0xbf623f35,0x3f7fbe48,0xbf46bec4,0x3e953f55
.long 0x3e953f35,0x3f22bf7b,0xbf7f3ec4,0x3ef13f0e,0x3f7fbf35,0xbe95bf0e,0xbf623f6d,0x3f223e48
.long 0x3dc9bf35,0xbf753f0e,0xbef13f6d,0x3f46be48,0xbf753f35,0xbf463f7b,0x3dc93ec4,0x3f62bf0e
.long 0xbef13f35,0x3dc93e48,0x3f22bec4,0x3f75bf55,0x3f46bf35,0x3f62bf55,0x3f75bf6d,0x3f7fbf7b
.long 0xbdc90000,0xbe95be48,0xbef1bec4,0xbf22bf0e,0xbe950000,0xbf46bf0e,0xbf7fbf6d,0xbf62bf7b
.long 0xbef10000,0xbf7fbf55,0xbf22bf6d,0x3e95be48,0xbf220000,0xbf62bf7b,0x3e95bec4,0x3f7f3f55
.long 0xbf460000,0xbef1bf7b,0x3f753ec4,0x3dc93f55,0xbf620000,0x3dc9bf55,0x3f463f6d,0xbf75be48
.long 0xbf750000,0x3f22bf0e,0xbdc93f6d,0xbef1bf7b,0xbf7f0000,0x3f75be48,0xbf623ec4,0x3f46bf0e
.long 0xbf7f0000,0x3f753e48,0xbf62bec4,0x3f463f0e,0xbf750000,0x3f223f0e,0xbdc9bf6d,0xbef13f7b
.long 0xbf620000,0x3dc93f55,0x3f46bf6d,0xbf753e48,0xbf460000,0xbef13f7b,0x3f75bec4,0x3dc9bf55
.long 0xbf220000,0xbf623f7b,0x3e953ec4,0x3f7fbf55,0xbef10000,0xbf7f3f55,0xbf223f6d,0x3e953e48
.long 0xbe950000,0xbf463f0e,0xbf7f3f6d,0xbf623f7b,0xbdc90000,0xbe953e48,0xbef13ec4,0xbf223f0e
.long 0xbf46bf35,0xbf62bf55,0xbf75bf6d,0xbf7fbf7b,0xbef1bf35,0x3dc9be48,0x3f223ec4,0x3f753f55
.long 0x3f753f35,0x3f463f7b,0xbdc93ec4,0xbf62bf0e,0x3dc93f35,0xbf75bf0e,0xbef1bf6d,0x3f463e48
.long 0xbf7fbf35,0x3e95bf0e,0x3f623f6d,0xbf223e48,0x3e95bf35,0x3f223f7b,0xbf7fbec4,0x3ef1bf0e
.long 0x3f623f35,0xbf7fbe48,0x3f46bec4,0xbe953f55,0xbf223f35,0x3ef1bf55,0xbe953f6d,0x3dc9bf7b
.long 0xbf22bf35,0x3ef13f55,0xbe95bf6d,0x3dc93f7b,0x3f62bf35,0xbf7f3e48,0x3f463ec4,0xbe95bf55
.long 0x3e953f35,0x3f22bf7b,0xbf7f3ec4,0x3ef13f0e,0xbf7f3f35,0x3e953f0e,0x3f62bf6d,0xbf22be48
.long 0x3dc9bf35,0xbf753f0e,0xbef13f6d,0x3f46be48,0x3f75bf35,0x3f46bf7b,0xbdc9bec4,0xbf623f0e
.long 0xbef13f35,0x3dc93e48,0x3f22bec4,0x3f75bf55,0xbf463f35,0xbf623f55,0xbf753f6d,0xbf7f3f7b
.long 0xbf7fbf80,0xbf75bf7b,0xbf62bf6d,0xbf46bf55,0x3f753f80,0x3f223f55,0x3dc93ec4,0xbef1be48
.long 0xbf62bf80,0xbdc9bf0e,0x3f463ec4,0x3f753f7b,0x3f463f80,0xbef13e48,0xbf75bf6d,0x3dc9bf0e
.long 0xbf22bf80,0x3f623e48,0x3e953f6d,0xbf7fbf0e,0x3ef13f80,0xbf7fbf0e,0x3f22bec4,0x3e953f7b
.long 0xbe95bf80,0x3f463f55,0xbf7fbec4,0x3f62be48,0x3dc93f80,0xbe95bf7b,0x3ef13f6d,0xbf22bf55
.long 0x3dc9bf80,0xbe953f7b,0x3ef1bf6d,0xbf223f55,0xbe953f80,0x3f46bf55,0xbf7f3ec4,0x3f623e48
.long 0x3ef1bf80,0xbf7f3f0e,0x3f223ec4,0x3e95bf7b,0xbf223f80,0x3f62be48,0x3e95bf6d,0xbf7f3f0e
.long 0x3f46bf80,0xbef1be48,0xbf753f6d,0x3dc93f0e,0xbf623f80,0xbdc93f0e,0x3f46bec4,0x3f75bf7b
.long 0x3f75bf80,0x3f22bf55,0x3dc9bec4,0xbef13e48,0xbf7f3f80,0xbf753f7b,0xbf623f6d,0xbf463f55
.long 0xbf22bf35,0xbef1bf0e,0xbe95bec4,0xbdc9be48,0xbf62bf35,0xbf7fbf7b,0xbf46bf6d,0xbe95bf0e
.long 0x3e953f35,0xbf22be48,0xbf7fbf6d,0xbef1bf55,0x3f7f3f35,0x3e953f55,0xbf62bec4,0xbf22bf7b
.long 0x3dc9bf35,0x3f753f55,0xbef13ec4,0xbf46bf7b,0xbf75bf35,0x3f46be48,0x3dc93f6d,0xbf62bf55
.long 0xbef13f35,0xbdc9bf7b,0x3f223f6d,0xbf75bf0e,0x3f463f35,0xbf62bf0e,0x3f753ec4,0xbf7fbe48
.long 0x3f46bf35,0xbf623f0e,0x3f75bec4,0xbf7f3e48,0xbef1bf35,0xbdc93f7b,0x3f22bf6d,0xbf753f0e
.long 0xbf753f35,0x3f463e48,0x3dc9bf6d,0xbf623f55,0x3dc93f35,0x3f75bf55,0xbef1bec4,0xbf463f7b
.long 0x3f7fbf35,0x3e95bf55,0xbf623ec4,0xbf223f7b,0x3e95bf35,0xbf223e48,0xbf7f3f6d,0xbef13f55
.long 0xbf623f35,0xbf7f3f7b,0xbf463f6d,0xbe953f0e,0xbf223f35,0xbef13f0e,0xbe953ec4,0xbdc93e48
.size k1_tab, 11264
.text
.p2align 8
.type k2_tab,@object
k2_tab:
.long 0x3f803f80,0x3f803f80,0x3f803f80,0x3f803f80,0x3f7b3f80,0x3f553f6d,0xbf7bbf80,0xbf55bf6d
.long 0x3f6d3f80,0x3ec43f35,0x3f6d3f80,0x3ec43f35,0x3f553f80,0xbe483ec4,0xbf55bf80,0x3e48bec4
.long 0x3f353f80,0xbf350000,0x3f353f80,0xbf350000,0x3f0e3f80,0xbf7bbec4,0xbf0ebf80,0x3f7b3ec4
.long 0x3ec43f80,0xbf6dbf35,0x3ec43f80,0xbf6dbf35,0x3e483f80,0xbf0ebf6d,0xbe48bf80,0x3f0e3f6d
.long 0x3f80,0xbf80,0x3f80,0xbf80,0xbe483f80,0x3f0ebf6d,0x3e48bf80,0xbf0e3f6d
.long 0xbec43f80,0x3f6dbf35,0xbec43f80,0x3f6dbf35,0xbf0e3f80,0x3f7bbec4,0x3f0ebf80,0xbf7b3ec4
.long 0xbf353f80,0x3f350000,0xbf353f80,0x3f350000,0xbf553f80,0x3e483ec4,0x3f55bf80,0xbe48bec4
.long 0xbf6d3f80,0xbec43f35,0xbf6d3f80,0xbec43f35,0xbf7b3f80,0xbf553f6d,0x3f7bbf80,0x3f55bf6d
.long 0x3f803f80,0x3f803f80,0x3f803f80,0x3f803f80,0x3f0e3f35,0x3e483ec4,0xbf0ebf35,0xbe48bec4
.long 0xbec40000,0xbf6dbf35,0xbec40000,0xbf6dbf35,0xbf7bbf35,0xbf0ebf6d,0x3f7b3f35,0x3f0e3f6d
.long 0xbf35bf80,0x3f350000,0xbf35bf80,0x3f350000,0x3e48bf35,0x3f553f6d,0xbe483f35,0xbf55bf6d
.long 0x3f6d0000,0xbec43f35,0x3f6d0000,0xbec43f35,0x3f553f35,0xbf7bbec4,0xbf55bf35,0x3f7b3ec4
.long 0x3f80,0xbf80,0x3f80,0xbf80,0xbf553f35,0x3f7bbec4,0x3f55bf35,0xbf7b3ec4
.long 0xbf6d0000,0x3ec43f35,0xbf6d0000,0x3ec43f35,0xbe48bf35,0xbf553f6d,0x3e483f35,0x3f55bf6d
.long 0x3f35bf80,0xbf350000,0x3f35bf80,0xbf350000,0x3f7bbf35,0x3f0ebf6d,0xbf7b3f35,0xbf0e3f6d
.long 0x3ec40000,0x3f6dbf35,0x3ec40000,0x3f6dbf35,0xbf0e3f35,0xbe483ec4,0x3f0ebf35,0x3e48bec4
.long 0x3f803f80,0x3f803f80,0x3f803f80,0x3f803f80,0xbe480000,0xbf0ebec4,0x3e480000,0x3f0e3ec4
.long 0xbf6dbf80,0xbec4bf35,0xbf6dbf80,0xbec4bf35,0x3f0e0000,0x3f7b3f6d,0xbf0e0000,0xbf7bbf6d
.long 0x3f353f80,0xbf350000,0x3f353f80,0xbf350000,0xbf550000,0xbe48bf6d,0x3f550000,0x3e483f6d
.long 0xbec4bf80,0x3f6d3f35,0xbec4bf80,0x3f6d3f35,0x3f7b0000,0xbf553ec4,0xbf7b0000,0x3f55bec4
.long 0x3f80,0xbf80,0x3f80,0xbf80,0xbf7b0000,0x3f553ec4,0x3f7b0000,0xbf55bec4
.long 0x3ec4bf80,0xbf6d3f35,0x3ec4bf80,0xbf6d3f35,0x3f550000,0x3e48bf6d,0xbf550000,0xbe483f6d
.long 0xbf353f80,0x3f350000,0xbf353f80,0x3f350000,0xbf0e0000,0xbf7b3f6d,0x3f0e0000,0x3f7bbf6d
.long 0x3f6dbf80,0x3ec4bf35,0x3f6dbf80,0x3ec4bf35,0x3e480000,0x3f0ebec4,0xbe480000,0xbf0e3ec4
.long 0x3f803f80,0x3f803f80,0x3f803f80,0x3f803f80,0xbf55bf35,0xbf7bbf6d,0x3f553f35,0x3f7b3f6d
.long 0x3ec40000,0x3f6d3f35,0x3ec40000,0x3f6d3f35,0x3e483f35,0xbf55bec4,0xbe48bf35,0x3f553ec4
.long 0xbf35bf80,0x3f350000,0xbf35bf80,0x3f350000,0x3f7b3f35,0xbf0e3ec4,0xbf7bbf35,0x3f0ebec4
.long 0xbf6d0000,0x3ec4bf35,0xbf6d0000,0x3ec4bf35,0x3f0ebf35,0xbe483f6d,0xbf0e3f35,0x3e48bf6d
.long 0x3f80,0xbf80,0x3f80,0xbf80,0xbf0ebf35,0x3e483f6d,0x3f0e3f35,0xbe48bf6d
.long 0x3f6d0000,0xbec4bf35,0x3f6d0000,0xbec4bf35,0xbf7b3f35,0x3f0e3ec4,0x3f7bbf35,0xbf0ebec4
.long 0x3f35bf80,0xbf350000,0x3f35bf80,0xbf350000,0xbe483f35,0x3f55bec4,0x3e48bf35,0xbf553ec4
.long 0xbec40000,0xbf6d3f35,0xbec40000,0xbf6d3f35,0x3f55bf35,0x3f7bbf6d,0xbf553f35,0xbf7b3f6d
.long 0x0,0x0,0x0,0x0,0x3e480000,0x3f0e3ec4,0xbe480000,0xbf0ebec4
.long 0x3ec40000,0x3f6d3f35,0x3ec40000,0x3f6d3f35,0x3f0e0000,0x3f7b3f6d,0xbf0e0000,0xbf7bbf6d
.long 0x3f350000,0x3f353f80,0x3f350000,0x3f353f80,0x3f550000,0x3e483f6d,0xbf550000,0xbe48bf6d
.long 0x3f6d0000,0xbec43f35,0x3f6d0000,0xbec43f35,0x3f7b0000,0xbf553ec4,0xbf7b0000,0x3f55bec4
.long 0x3f800000,0xbf800000,0x3f800000,0xbf800000,0x3f7b0000,0xbf55bec4,0xbf7b0000,0x3f553ec4
.long 0x3f6d0000,0xbec4bf35,0x3f6d0000,0xbec4bf35,0x3f550000,0x3e48bf6d,0xbf550000,0xbe483f6d
.long 0x3f350000,0x3f35bf80,0x3f350000,0x3f35bf80,0x3f0e0000,0x3f7bbf6d,0xbf0e0000,0xbf7b3f6d
.long 0x3ec40000,0x3f6dbf35,0x3ec40000,0x3f6dbf35,0x3e480000,0x3f0ebec4,0xbe480000,0xbf0e3ec4
.long 0x0,0x0,0x0,0x0,0x3f553f35,0x3f7b3f6d,0xbf55bf35,0xbf7bbf6d
.long 0x3f6d3f80,0x3ec43f35,0x3f6d3f80,0x3ec43f35,0x3e483f35,0xbf55bec4,0xbe48bf35,0x3f553ec4
.long 0xbf350000,0xbf35bf80,0xbf350000,0xbf35bf80,0xbf7bbf35,0x3f0ebec4,0x3f7b3f35,0xbf0e3ec4
.long 0xbec4bf80,0x3f6d3f35,0xbec4bf80,0x3f6d3f35,0x3f0ebf35,0xbe483f6d,0xbf0e3f35,0x3e48bf6d
.long 0x3f800000,0xbf800000,0x3f800000,0xbf800000,0x3f0e3f35,0xbe48bf6d,0xbf0ebf35,0x3e483f6d
.long 0xbec43f80,0x3f6dbf35,0xbec43f80,0x3f6dbf35,0xbf7b3f35,0x3f0e3ec4,0x3f7bbf35,0xbf0ebec4
.long 0xbf350000,0xbf353f80,0xbf350000,0xbf353f80,0x3e48bf35,0xbf553ec4,0xbe483f35,0x3f55bec4
.long 0x3f6dbf80,0x3ec4bf35,0x3f6dbf80,0x3ec4bf35,0x3f55bf35,0x3f7bbf6d,0xbf553f35,0xbf7b3f6d
.long 0x0,0x0,0x0,0x0,0x3f7b3f80,0x3f553f6d,0xbf7bbf80,0xbf55bf6d
.long 0xbec40000,0xbf6dbf35,0xbec40000,0xbf6dbf35,0xbf55bf80,0x3e48bec4,0x3f553f80,0xbe483ec4
.long 0x3f350000,0x3f353f80,0x3f350000,0x3f353f80,0x3f0e3f80,0xbf7bbec4,0xbf0ebf80,0x3f7b3ec4
.long 0xbf6d0000,0x3ec4bf35,0xbf6d0000,0x3ec4bf35,0xbe48bf80,0x3f0e3f6d,0x3e483f80,0xbf0ebf6d
.long 0x3f800000,0xbf800000,0x3f800000,0xbf800000,0xbe483f80,0x3f0ebf6d,0x3e48bf80,0xbf0e3f6d
.long 0xbf6d0000,0x3ec43f35,0xbf6d0000,0x3ec43f35,0x3f0ebf80,0xbf7b3ec4,0xbf0e3f80,0x3f7bbec4
.long 0x3f350000,0x3f35bf80,0x3f350000,0x3f35bf80,0xbf553f80,0x3e483ec4,0x3f55bf80,0xbe48bec4
.long 0xbec40000,0xbf6d3f35,0xbec40000,0xbf6d3f35,0x3f7bbf80,0x3f55bf6d,0xbf7b3f80,0xbf553f6d
.long 0x0,0x0,0x0,0x0,0x3f0e3f35,0x3e483ec4,0xbf0ebf35,0xbe48bec4
.long 0xbf6dbf80,0xbec4bf35,0xbf6dbf80,0xbec4bf35,0x3f7b3f35,0x3f0e3f6d,0xbf7bbf35,0xbf0ebf6d
.long 0xbf350000,0xbf35bf80,0xbf350000,0xbf35bf80,0x3e48bf35,0x3f553f6d,0xbe483f35,0xbf55bf6d
.long 0x3ec43f80,0xbf6dbf35,0x3ec43f80,0xbf6dbf35,0xbf55bf35,0x3f7b3ec4,0x3f553f35,0xbf7bbec4
.long 0x3f800000,0xbf800000,0x3f800000,0xbf800000,0xbf553f35,0x3f7bbec4,0x3f55bf35,0xbf7b3ec4
.long 0x3ec4bf80,0xbf6d3f35,0x3ec4bf80,0xbf6d3f35,0x3e483f35,0x3f55bf6d,0xbe48bf35,0xbf553f6d
.long 0xbf350000,0xbf353f80,0xbf350000,0xbf353f80,0x3f7bbf35,0x3f0ebf6d,0xbf7b3f35,0xbf0e3f6d
.long 0xbf6d3f80,0xbec43f35,0xbf6d3f80,0xbec43f35,0x3f0ebf35,0x3e48bec4,0xbf0e3f35,0xbe483ec4
.long 0x0,0x0,0x0,0x0,0xbe480000,0xbf0ebec4,0x3e480000,0x3f0e3ec4
.long 0xbec40000,0xbf6dbf35,0xbec40000,0xbf6dbf35,0xbf0e0000,0xbf7bbf6d,0x3f0e0000,0x3f7b3f6d
.long 0xbf350000,0xbf35bf80,0xbf350000,0xbf35bf80,0xbf550000,0xbe48bf6d,0x3f550000,0x3e483f6d
.long 0xbf6d0000,0x3ec4bf35,0xbf6d0000,0x3ec4bf35,0xbf7b0000,0x3f55bec4,0x3f7b0000,0xbf553ec4
.long 0xbf800000,0x3f800000,0xbf800000,0x3f800000,0xbf7b0000,0x3f553ec4,0x3f7b0000,0xbf55bec4
.long 0xbf6d0000,0x3ec43f35,0xbf6d0000,0x3ec43f35,0xbf550000,0xbe483f6d,0x3f550000,0x3e48bf6d
.long 0xbf350000,0xbf353f80,0xbf350000,0xbf353f80,0xbf0e0000,0xbf7b3f6d,0x3f0e0000,0x3f7bbf6d
.long 0xbec40000,0xbf6d3f35,0xbec40000,0xbf6d3f35,0xbe480000,0xbf0e3ec4,0x3e480000,0x3f0ebec4
.long 0x0,0x0,0x0,0x0,0xbf55bf35,0xbf7bbf6d,0x3f553f35,0x3f7b3f6d
.long 0xbf6dbf80,0xbec4bf35,0xbf6dbf80,0xbec4bf35,0xbe48bf35,0x3f553ec4,0x3e483f35,0xbf55bec4
.long 0x3f350000,0x3f353f80,0x3f350000,0x3f353f80,0x3f7b3f35,0xbf0e3ec4,0xbf7bbf35,0x3f0ebec4
.long 0x3ec43f80,0xbf6dbf35,0x3ec43f80,0xbf6dbf35,0xbf0e3f35,0x3e48bf6d,0x3f0ebf35,0xbe483f6d
.long 0xbf800000,0x3f800000,0xbf800000,0x3f800000,0xbf0ebf35,0x3e483f6d,0x3f0e3f35,0xbe48bf6d
.long 0x3ec4bf80,0xbf6d3f35,0x3ec4bf80,0xbf6d3f35,0x3f7bbf35,0xbf0ebec4,0xbf7b3f35,0x3f0e3ec4
.long 0x3f350000,0x3f35bf80,0x3f350000,0x3f35bf80,0xbe483f35,0x3f55bec4,0x3e48bf35,0xbf553ec4
.long 0xbf6d3f80,0xbec43f35,0xbf6d3f80,0xbec43f35,0xbf553f35,0xbf7b3f6d,0x3f55bf35,0x3f7bbf6d
.long 0x0,0x0,0x0,0x0,0xbf7bbf80,0xbf55bf6d,0x3f7b3f80,0x3f553f6d
.long 0x3ec40000,0x3f6d3f35,0x3ec40000,0x3f6d3f35,0x3f553f80,0xbe483ec4,0xbf55bf80,0x3e48bec4
.long 0xbf350000,0xbf35bf80,0xbf350000,0xbf35bf80,0xbf0ebf80,0x3f7b3ec4,0x3f0e3f80,0xbf7bbec4
.long 0x3f6d0000,0xbec43f35,0x3f6d0000,0xbec43f35,0x3e483f80,0xbf0ebf6d,0xbe48bf80,0x3f0e3f6d
.long 0xbf800000,0x3f800000,0xbf800000,0x3f800000,0x3e48bf80,0xbf0e3f6d,0xbe483f80,0x3f0ebf6d
.long 0x3f6d0000,0xbec4bf35,0x3f6d0000,0xbec4bf35,0xbf0e3f80,0x3f7bbec4,0x3f0ebf80,0xbf7b3ec4
.long 0xbf350000,0xbf353f80,0xbf350000,0xbf353f80,0x3f55bf80,0xbe48bec4,0xbf553f80,0x3e483ec4
.long 0x3ec40000,0x3f6dbf35,0x3ec40000,0x3f6dbf35,0xbf7b3f80,0xbf553f6d,0x3f7bbf80,0x3f55bf6d
.long 0x0,0x0,0x0,0x0,0xbf0ebf35,0xbe48bec4,0x3f0e3f35,0x3e483ec4
.long 0x3f6d3f80,0x3ec43f35,0x3f6d3f80,0x3ec43f35,0xbf7bbf35,0xbf0ebf6d,0x3f7b3f35,0x3f0e3f6d
.long 0x3f350000,0x3f353f80,0x3f350000,0x3f353f80,0xbe483f35,0xbf55bf6d,0x3e48bf35,0x3f553f6d
.long 0xbec4bf80,0x3f6d3f35,0xbec4bf80,0x3f6d3f35,0x3f553f35,0xbf7bbec4,0xbf55bf35,0x3f7b3ec4
.long 0xbf800000,0x3f800000,0xbf800000,0x3f800000,0x3f55bf35,0xbf7b3ec4,0xbf553f35,0x3f7bbec4
.long 0xbec43f80,0x3f6dbf35,0xbec43f80,0x3f6dbf35,0xbe48bf35,0xbf553f6d,0x3e483f35,0x3f55bf6d
.long 0x3f350000,0x3f35bf80,0x3f350000,0x3f35bf80,0xbf7b3f35,0xbf0e3f6d,0x3f7bbf35,0x3f0ebf6d
.long 0x3f6dbf80,0x3ec4bf35,0x3f6dbf80,0x3ec4bf35,0xbf0e3f35,0xbe483ec4,0x3f0ebf35,0x3e48bec4
.long 0xbf803f80,0xbf803f80,0xbf803f80,0xbf803f80,0xbf7b3f80,0xbf553f6d,0x3f7bbf80,0x3f55bf6d
.long 0xbf6d3f80,0xbec43f35,0xbf6d3f80,0xbec43f35,0xbf553f80,0x3e483ec4,0x3f55bf80,0xbe48bec4
.long 0xbf353f80,0x3f350000,0xbf353f80,0x3f350000,0xbf0e3f80,0x3f7bbec4,0x3f0ebf80,0xbf7b3ec4
.long 0xbec43f80,0x3f6dbf35,0xbec43f80,0x3f6dbf35,0xbe483f80,0x3f0ebf6d,0x3e48bf80,0xbf0e3f6d
.long 0x3f80,0xbf80,0x3f80,0xbf80,0x3e483f80,0xbf0ebf6d,0xbe48bf80,0x3f0e3f6d
.long 0x3ec43f80,0xbf6dbf35,0x3ec43f80,0xbf6dbf35,0x3f0e3f80,0xbf7bbec4,0xbf0ebf80,0x3f7b3ec4
.long 0x3f353f80,0xbf350000,0x3f353f80,0xbf350000,0x3f553f80,0xbe483ec4,0xbf55bf80,0x3e48bec4
.long 0x3f6d3f80,0x3ec43f35,0x3f6d3f80,0x3ec43f35,0x3f7b3f80,0x3f553f6d,0xbf7bbf80,0xbf55bf6d
.long 0xbf803f80,0xbf803f80,0xbf803f80,0xbf803f80,0xbf0e3f35,0xbe483ec4,0x3f0ebf35,0x3e48bec4
.long 0x3ec40000,0x3f6dbf35,0x3ec40000,0x3f6dbf35,0x3f7bbf35,0x3f0ebf6d,0xbf7b3f35,0xbf0e3f6d
.long 0x3f35bf80,0xbf350000,0x3f35bf80,0xbf350000,0xbe48bf35,0xbf553f6d,0x3e483f35,0x3f55bf6d
.long 0xbf6d0000,0x3ec43f35,0xbf6d0000,0x3ec43f35,0xbf553f35,0x3f7bbec4,0x3f55bf35,0xbf7b3ec4
.long 0x3f80,0xbf80,0x3f80,0xbf80,0x3f553f35,0xbf7bbec4,0xbf55bf35,0x3f7b3ec4
.long 0x3f6d0000,0xbec43f35,0x3f6d0000,0xbec43f35,0x3e48bf35,0x3f553f6d,0xbe483f35,0xbf55bf6d
.long 0xbf35bf80,0x3f350000,0xbf35bf80,0x3f350000,0xbf7bbf35,0xbf0ebf6d,0x3f7b3f35,0x3f0e3f6d
.long 0xbec40000,0xbf6dbf35,0xbec40000,0xbf6dbf35,0x3f0e3f35,0x3e483ec4,0xbf0ebf35,0xbe48bec4
.long 0xbf803f80,0xbf803f80,0xbf803f80,0xbf803f80,0x3e480000,0x3f0ebec4,0xbe480000,0xbf0e3ec4
.long 0x3f6dbf80,0x3ec4bf35,0x3f6dbf80,0x3ec4bf35,0xbf0e0000,0xbf7b3f6d,0x3f0e0000,0x3f7bbf6d
.long 0xbf353f80,0x3f350000,0xbf353f80,0x3f350000,0x3f550000,0x3e48bf6d,0xbf550000,0xbe483f6d
.long 0x3ec4bf80,0xbf6d3f35,0x3ec4bf80,0xbf6d3f35,0xbf7b0000,0x3f553ec4,0x3f7b0000,0xbf55bec4
.long 0x3f80,0xbf80,0x3f80,0xbf80,0x3f7b0000,0xbf553ec4,0xbf7b0000,0x3f55bec4
.long 0xbec4bf80,0x3f6d3f35,0xbec4bf80,0x3f6d3f35,0xbf550000,0xbe48bf6d,0x3f550000,0x3e483f6d
.long 0x3f353f80,0xbf350000,0x3f353f80,0xbf350000,0x3f0e0000,0x3f7b3f6d,0xbf0e0000,0xbf7bbf6d
.long 0xbf6dbf80,0xbec4bf35,0xbf6dbf80,0xbec4bf35,0xbe480000,0xbf0ebec4,0x3e480000,0x3f0e3ec4
.long 0xbf803f80,0xbf803f80,0xbf803f80,0xbf803f80,0x3f55bf35,0x3f7bbf6d,0xbf553f35,0xbf7b3f6d
.long 0xbec40000,0xbf6d3f35,0xbec40000,0xbf6d3f35,0xbe483f35,0x3f55bec4,0x3e48bf35,0xbf553ec4
.long 0x3f35bf80,0xbf350000,0x3f35bf80,0xbf350000,0xbf7b3f35,0x3f0e3ec4,0x3f7bbf35,0xbf0ebec4
.long 0x3f6d0000,0xbec4bf35,0x3f6d0000,0xbec4bf35,0xbf0ebf35,0x3e483f6d,0x3f0e3f35,0xbe48bf6d
.long 0x3f80,0xbf80,0x3f80,0xbf80,0x3f0ebf35,0xbe483f6d,0xbf0e3f35,0x3e48bf6d
.long 0xbf6d0000,0x3ec4bf35,0xbf6d0000,0x3ec4bf35,0x3f7b3f35,0xbf0e3ec4,0xbf7bbf35,0x3f0ebec4
.long 0xbf35bf80,0x3f350000,0xbf35bf80,0x3f350000,0x3e483f35,0xbf55bec4,0xbe48bf35,0x3f553ec4
.long 0x3ec40000,0x3f6d3f35,0x3ec40000,0x3f6d3f35,0xbf55bf35,0xbf7bbf6d,0x3f553f35,0x3f7b3f6d
.long 0x0,0x0,0x0,0x0,0xbe480000,0xbf0e3ec4,0x3e480000,0x3f0ebec4
.long 0xbec40000,0xbf6d3f35,0xbec40000,0xbf6d3f35,0xbf0e0000,0xbf7b3f6d,0x3f0e0000,0x3f7bbf6d
.long 0xbf350000,0xbf353f80,0xbf350000,0xbf353f80,0xbf550000,0xbe483f6d,0x3f550000,0x3e48bf6d
.long 0xbf6d0000,0x3ec43f35,0xbf6d0000,0x3ec43f35,0xbf7b0000,0x3f553ec4,0x3f7b0000,0xbf55bec4
.long 0xbf800000,0x3f800000,0xbf800000,0x3f800000,0xbf7b0000,0x3f55bec4,0x3f7b0000,0xbf553ec4
.long 0xbf6d0000,0x3ec4bf35,0xbf6d0000,0x3ec4bf35,0xbf550000,0xbe48bf6d,0x3f550000,0x3e483f6d
.long 0xbf350000,0xbf35bf80,0xbf350000,0xbf35bf80,0xbf0e0000,0xbf7bbf6d,0x3f0e0000,0x3f7b3f6d
.long 0xbec40000,0xbf6dbf35,0xbec40000,0xbf6dbf35,0xbe480000,0xbf0ebec4,0x3e480000,0x3f0e3ec4
.long 0x0,0x0,0x0,0x0,0xbf553f35,0xbf7b3f6d,0x3f55bf35,0x3f7bbf6d
.long 0xbf6d3f80,0xbec43f35,0xbf6d3f80,0xbec43f35,0xbe483f35,0x3f55bec4,0x3e48bf35,0xbf553ec4
.long 0x3f350000,0x3f35bf80,0x3f350000,0x3f35bf80,0x3f7bbf35,0xbf0ebec4,0xbf7b3f35,0x3f0e3ec4
.long 0x3ec4bf80,0xbf6d3f35,0x3ec4bf80,0xbf6d3f35,0xbf0ebf35,0x3e483f6d,0x3f0e3f35,0xbe48bf6d
.long 0xbf800000,0x3f800000,0xbf800000,0x3f800000,0xbf0e3f35,0x3e48bf6d,0x3f0ebf35,0xbe483f6d
.long 0x3ec43f80,0xbf6dbf35,0x3ec43f80,0xbf6dbf35,0x3f7b3f35,0xbf0e3ec4,0xbf7bbf35,0x3f0ebec4
.long 0x3f350000,0x3f353f80,0x3f350000,0x3f353f80,0xbe48bf35,0x3f553ec4,0x3e483f35,0xbf55bec4
.long 0xbf6dbf80,0xbec4bf35,0xbf6dbf80,0xbec4bf35,0xbf55bf35,0xbf7bbf6d,0x3f553f35,0x3f7b3f6d
.long 0x0,0x0,0x0,0x0,0xbf7b3f80,0xbf553f6d,0x3f7bbf80,0x3f55bf6d
.long 0x3ec40000,0x3f6dbf35,0x3ec40000,0x3f6dbf35,0x3f55bf80,0xbe48bec4,0xbf553f80,0x3e483ec4
.long 0xbf350000,0xbf353f80,0xbf350000,0xbf353f80,0xbf0e3f80,0x3f7bbec4,0x3f0ebf80,0xbf7b3ec4
.long 0x3f6d0000,0xbec4bf35,0x3f6d0000,0xbec4bf35,0x3e48bf80,0xbf0e3f6d,0xbe483f80,0x3f0ebf6d
.long 0xbf800000,0x3f800000,0xbf800000,0x3f800000,0x3e483f80,0xbf0ebf6d,0xbe48bf80,0x3f0e3f6d
.long 0x3f6d0000,0xbec43f35,0x3f6d0000,0xbec43f35,0xbf0ebf80,0x3f7b3ec4,0x3f0e3f80,0xbf7bbec4
.long 0xbf350000,0xbf35bf80,0xbf350000,0xbf35bf80,0x3f553f80,0xbe483ec4,0xbf55bf80,0x3e48bec4
.long 0x3ec40000,0x3f6d3f35,0x3ec40000,0x3f6d3f35,0xbf7bbf80,0xbf55bf6d,0x3f7b3f80,0x3f553f6d
.long 0x0,0x0,0x0,0x0,0xbf0e3f35,0xbe483ec4,0x3f0ebf35,0x3e48bec4
.long 0x3f6dbf80,0x3ec4bf35,0x3f6dbf80,0x3ec4bf35,0xbf7b3f35,0xbf0e3f6d,0x3f7bbf35,0x3f0ebf6d
.long 0x3f350000,0x3f35bf80,0x3f350000,0x3f35bf80,0xbe48bf35,0xbf553f6d,0x3e483f35,0x3f55bf6d
.long 0xbec43f80,0x3f6dbf35,0xbec43f80,0x3f6dbf35,0x3f55bf35,0xbf7b3ec4,0xbf553f35,0x3f7bbec4
.long 0xbf800000,0x3f800000,0xbf800000,0x3f800000,0x3f553f35,0xbf7bbec4,0xbf55bf35,0x3f7b3ec4
.long 0xbec4bf80,0x3f6d3f35,0xbec4bf80,0x3f6d3f35,0xbe483f35,0xbf55bf6d,0x3e48bf35,0x3f553f6d
.long 0x3f350000,0x3f353f80,0x3f350000,0x3f353f80,0xbf7bbf35,0xbf0ebf6d,0x3f7b3f35,0x3f0e3f6d
.long 0x3f6d3f80,0x3ec43f35,0x3f6d3f80,0x3ec43f35,0xbf0ebf35,0xbe48bec4,0x3f0e3f35,0x3e483ec4
.long 0x0,0x0,0x0,0x0,0x3e480000,0x3f0ebec4,0xbe480000,0xbf0e3ec4
.long 0x3ec40000,0x3f6dbf35,0x3ec40000,0x3f6dbf35,0x3f0e0000,0x3f7bbf6d,0xbf0e0000,0xbf7b3f6d
.long 0x3f350000,0x3f35bf80,0x3f350000,0x3f35bf80,0x3f550000,0x3e48bf6d,0xbf550000,0xbe483f6d
.long 0x3f6d0000,0xbec4bf35,0x3f6d0000,0xbec4bf35,0x3f7b0000,0xbf55bec4,0xbf7b0000,0x3f553ec4
.long 0x3f800000,0xbf800000,0x3f800000,0xbf800000,0x3f7b0000,0xbf553ec4,0xbf7b0000,0x3f55bec4
.long 0x3f6d0000,0xbec43f35,0x3f6d0000,0xbec43f35,0x3f550000,0x3e483f6d,0xbf550000,0xbe48bf6d
.long 0x3f350000,0x3f353f80,0x3f350000,0x3f353f80,0x3f0e0000,0x3f7b3f6d,0xbf0e0000,0xbf7bbf6d
.long 0x3ec40000,0x3f6d3f35,0x3ec40000,0x3f6d3f35,0x3e480000,0x3f0e3ec4,0xbe480000,0xbf0ebec4
.long 0x0,0x0,0x0,0x0,0x3f55bf35,0x3f7bbf6d,0xbf553f35,0xbf7b3f6d
.long 0x3f6dbf80,0x3ec4bf35,0x3f6dbf80,0x3ec4bf35,0x3e48bf35,0xbf553ec4,0xbe483f35,0x3f55bec4
.long 0xbf350000,0xbf353f80,0xbf350000,0xbf353f80,0xbf7b3f35,0x3f0e3ec4,0x3f7bbf35,0xbf0ebec4
.long 0xbec43f80,0x3f6dbf35,0xbec43f80,0x3f6dbf35,0x3f0e3f35,0xbe48bf6d,0xbf0ebf35,0x3e483f6d
.long 0x3f800000,0xbf800000,0x3f800000,0xbf800000,0x3f0ebf35,0xbe483f6d,0xbf0e3f35,0x3e48bf6d
.long 0xbec4bf80,0x3f6d3f35,0xbec4bf80,0x3f6d3f35,0xbf7bbf35,0x3f0ebec4,0x3f7b3f35,0xbf0e3ec4
.long 0xbf350000,0xbf35bf80,0xbf350000,0xbf35bf80,0x3e483f35,0xbf55bec4,0xbe48bf35,0x3f553ec4
.long 0x3f6d3f80,0x3ec43f35,0x3f6d3f80,0x3ec43f35,0x3f553f35,0x3f7b3f6d,0xbf55bf35,0xbf7bbf6d
.long 0x0,0x0,0x0,0x0,0x3f7bbf80,0x3f55bf6d,0xbf7b3f80,0xbf553f6d
.long 0xbec40000,0xbf6d3f35,0xbec40000,0xbf6d3f35,0xbf553f80,0x3e483ec4,0x3f55bf80,0xbe48bec4
.long 0x3f350000,0x3f35bf80,0x3f350000,0x3f35bf80,0x3f0ebf80,0xbf7b3ec4,0xbf0e3f80,0x3f7bbec4
.long 0xbf6d0000,0x3ec43f35,0xbf6d0000,0x3ec43f35,0xbe483f80,0x3f0ebf6d,0x3e48bf80,0xbf0e3f6d
.long 0x3f800000,0xbf800000,0x3f800000,0xbf800000,0xbe48bf80,0x3f0e3f6d,0x3e483f80,0xbf0ebf6d
.long 0xbf6d0000,0x3ec4bf35,0xbf6d0000,0x3ec4bf35,0x3f0e3f80,0xbf7bbec4,0xbf0ebf80,0x3f7b3ec4
.long 0x3f350000,0x3f353f80,0x3f350000,0x3f353f80,0xbf55bf80,0x3e48bec4,0x3f553f80,0xbe483ec4
.long 0xbec40000,0xbf6dbf35,0xbec40000,0xbf6dbf35,0x3f7b3f80,0x3f553f6d,0xbf7bbf80,0xbf55bf6d
.long 0x0,0x0,0x0,0x0,0x3f0ebf35,0x3e48bec4,0xbf0e3f35,0xbe483ec4
.long 0xbf6d3f80,0xbec43f35,0xbf6d3f80,0xbec43f35,0x3f7bbf35,0x3f0ebf6d,0xbf7b3f35,0xbf0e3f6d
.long 0xbf350000,0xbf353f80,0xbf350000,0xbf353f80,0x3e483f35,0x3f55bf6d,0xbe48bf35,0xbf553f6d
.long 0x3ec4bf80,0xbf6d3f35,0x3ec4bf80,0xbf6d3f35,0xbf553f35,0x3f7bbec4,0x3f55bf35,0xbf7b3ec4
.long 0x3f800000,0xbf800000,0x3f800000,0xbf800000,0xbf55bf35,0x3f7b3ec4,0x3f553f35,0xbf7bbec4
.long 0x3ec43f80,0xbf6dbf35,0x3ec43f80,0xbf6dbf35,0x3e48bf35,0x3f553f6d,0xbe483f35,0xbf55bf6d
.long 0xbf350000,0xbf35bf80,0xbf350000,0xbf35bf80,0x3f7b3f35,0x3f0e3f6d,0xbf7bbf35,0xbf0ebf6d
.long 0xbf6dbf80,0xbec4bf35,0xbf6dbf80,0xbec4bf35,0x3f0e3f35,0x3e483ec4,0xbf0ebf35,0xbe48bec4
.long 0x3f803f80,0x3f803f80,0x3f803f80,0x3f803f80,0x3f753f7f,0x3f463f62,0xbf75bf7f,0xbf46bf62
.long 0x3f553f7b,0x3e483f0e,0x3f553f7b,0x3e483f0e,0x3f223f75,0xbef13dc9,0xbf22bf75,0x3ef1bdc9
.long 0x3ec43f6d,0xbf6dbec4,0x3ec43f6d,0xbf6dbec4,0x3dc93f62,0xbf75bf46,0xbdc9bf62,0x3f753f46
.long 0xbe483f55,0xbf0ebf7b,0xbe483f55,0xbf0ebf7b,0xbef13f46,0x3dc9bf75,0x3ef1bf46,0xbdc93f75
.long 0xbf353f35,0x3f35bf35,0xbf353f35,0x3f35bf35,0xbf623f22,0x3f7fbe95,0x3f62bf22,0xbf7f3e95
.long 0xbf7b3f0e,0x3f553e48,0xbf7b3f0e,0x3f553e48,0xbf7f3ef1,0x3e953f22,0x3f7fbef1,0xbe95bf22
.long 0xbf6d3ec4,0xbec43f6d,0xbf6d3ec4,0xbec43f6d,0xbf463e95,0xbf623f7f,0x3f46be95,0x3f62bf7f
.long 0xbf0e3e48,0xbf7b3f55,0xbf0e3e48,0xbf7b3f55,0xbe953dc9,0xbf223ef1,0x3e95bdc9,0x3f22bef1
.long 0x3f803f80,0x3f803f80,0x3f803f80,0x3f803f80,0x3ef13f22,0x3dc93e95,0xbef1bf22,0xbdc9be95
.long 0xbf0ebe48,0xbf7bbf55,0xbf0ebe48,0xbf7bbf55,0xbf7fbf62,0xbe95bf46,0x3f7f3f62,0x3e953f46
.long 0xbec4bf6d,0x3f6d3ec4,0xbec4bf6d,0x3f6d3ec4,0x3f22be95,0x3ef13f7f,0xbf223e95,0xbef1bf7f
.long 0x3f7b3f0e,0xbf553e48,0x3f7b3f0e,0xbf553e48,0x3e953f7f,0xbf22bf62,0xbe95bf7f,0x3f223f62
.long 0xbf353f35,0x3f35bf35,0xbf353f35,0x3f35bf35,0xbf75bdc9,0x3f463ef1,0x3f753dc9,0xbf46bef1
.long 0xbe48bf55,0xbf0e3f7b,0xbe48bf55,0xbf0e3f7b,0x3f46bf75,0xbf623dc9,0xbf463f75,0x3f62bdc9
.long 0x3f6dbec4,0x3ec4bf6d,0x3f6dbec4,0x3ec4bf6d,0x3dc93ef1,0x3f75bf22,0xbdc9bef1,0xbf753f22
.long 0xbf553f7b,0xbe483f0e,0xbf553f7b,0xbe483f0e,0xbf623f46,0xbf7f3f75,0x3f62bf46,0x3f7fbf75
.long 0x3f803f80,0x3f803f80,0x3f803f80,0x3f803f80,0xbe95bdc9,0xbf22bef1,0x3e953dc9,0x3f223ef1
.long 0xbf55bf7b,0xbe48bf0e,0xbf55bf7b,0xbe48bf0e,0x3f463e95,0x3f623f7f,0xbf46be95,0xbf62bf7f
.long 0x3ec43f6d,0xbf6dbec4,0x3ec43f6d,0xbf6dbec4,0xbf7fbef1,0x3e95bf22,0x3f7f3ef1,0xbe953f22
.long 0x3e48bf55,0x3f0e3f7b,0x3e48bf55,0x3f0e3f7b,0x3f623f22,0xbf7fbe95,0xbf62bf22,0x3f7f3e95
.long 0xbf353f35,0x3f35bf35,0xbf353f35,0x3f35bf35,0xbef1bf46,0x3dc93f75,0x3ef13f46,0xbdc9bf75
.long 0x3f7bbf0e,0xbf55be48,0x3f7bbf0e,0xbf55be48,0xbdc93f62,0x3f75bf46,0x3dc9bf62,0xbf753f46
.long 0xbf6d3ec4,0xbec43f6d,0xbf6d3ec4,0xbec43f6d,0x3f22bf75,0xbef1bdc9,0xbf223f75,0x3ef13dc9
.long 0x3f0ebe48,0x3f7bbf55,0x3f0ebe48,0x3f7bbf55,0xbf753f7f,0xbf463f62,0x3f75bf7f,0x3f46bf62
.long 0x3f803f80,0x3f803f80,0x3f803f80,0x3f803f80,0xbf62bf46,0xbf7fbf75,0x3f623f46,0x3f7f3f75
.long 0x3f0e3e48,0x3f7b3f55,0x3f0e3e48,0x3f7b3f55,0xbdc93ef1,0xbf75bf22,0x3dc9bef1,0x3f753f22
.long 0xbec4bf6d,0x3f6d3ec4,0xbec4bf6d,0x3f6d3ec4,0x3f463f75,0xbf62bdc9,0xbf46bf75,0x3f623dc9
.long 0xbf7bbf0e,0x3f55be48,0xbf7bbf0e,0x3f55be48,0x3f75bdc9,0xbf463ef1,0xbf753dc9,0x3f46bef1
.long 0xbf353f35,0x3f35bf35,0xbf353f35,0x3f35bf35,0x3e95bf7f,0xbf223f62,0xbe953f7f,0x3f22bf62
.long 0x3e483f55,0x3f0ebf7b,0x3e483f55,0x3f0ebf7b,0xbf22be95,0xbef13f7f,0x3f223e95,0x3ef1bf7f
.long 0x3f6dbec4,0x3ec4bf6d,0x3f6dbec4,0x3ec4bf6d,0xbf7f3f62,0xbe953f46,0x3f7fbf62,0x3e95bf46
.long 0x3f55bf7b,0x3e48bf0e,0x3f55bf7b,0x3e48bf0e,0xbef13f22,0xbdc93e95,0x3ef1bf22,0x3dc9be95
.long 0x0,0x0,0x0,0x0,0x3e953dc9,0x3f223ef1,0xbe95bdc9,0xbf22bef1
.long 0x3f0e3e48,0x3f7b3f55,0x3f0e3e48,0x3f7b3f55,0x3f463e95,0x3f623f7f,0xbf46be95,0xbf62bf7f
.long 0x3f6d3ec4,0x3ec43f6d,0x3f6d3ec4,0x3ec43f6d,0x3f7f3ef1,0xbe953f22,0xbf7fbef1,0x3e95bf22
.long 0x3f7b3f0e,0xbf553e48,0x3f7b3f0e,0xbf553e48,0x3f623f22,0xbf7fbe95,0xbf62bf22,0x3f7f3e95
.long 0x3f353f35,0xbf35bf35,0x3f353f35,0xbf35bf35,0x3ef13f46,0xbdc9bf75,0xbef1bf46,0x3dc93f75
.long 0x3e483f55,0x3f0ebf7b,0x3e483f55,0x3f0ebf7b,0xbdc93f62,0x3f75bf46,0x3dc9bf62,0xbf753f46
.long 0xbec43f6d,0x3f6dbec4,0xbec43f6d,0x3f6dbec4,0xbf223f75,0x3ef13dc9,0x3f22bf75,0xbef1bdc9
.long 0xbf553f7b,0xbe483f0e,0xbf553f7b,0xbe483f0e,0xbf753f7f,0xbf463f62,0x3f75bf7f,0x3f46bf62
.long 0x0,0x0,0x0,0x0,0x3f623f46,0x3f7f3f75,0xbf62bf46,0xbf7fbf75
.long 0x3f553f7b,0x3e483f0e,0x3f553f7b,0x3e483f0e,0xbdc93ef1,0xbf75bf22,0x3dc9bef1,0x3f753f22
.long 0xbf6dbec4,0xbec4bf6d,0xbf6dbec4,0xbec4bf6d,0xbf46bf75,0x3f623dc9,0x3f463f75,0xbf62bdc9
.long 0x3e48bf55,0x3f0e3f7b,0x3e48bf55,0x3f0e3f7b,0x3f75bdc9,0xbf463ef1,0xbf753dc9,0x3f46bef1
.long 0x3f353f35,0xbf35bf35,0x3f353f35,0xbf35bf35,0xbe953f7f,0x3f22bf62,0x3e95bf7f,0xbf223f62
.long 0xbf7b3f0e,0x3f553e48,0xbf7b3f0e,0x3f553e48,0xbf22be95,0xbef13f7f,0x3f223e95,0x3ef1bf7f
.long 0x3ec4bf6d,0xbf6d3ec4,0x3ec4bf6d,0xbf6d3ec4,0x3f7fbf62,0x3e95bf46,0xbf7f3f62,0xbe953f46
.long 0x3f0ebe48,0x3f7bbf55,0x3f0ebe48,0x3f7bbf55,0xbef13f22,0xbdc93e95,0x3ef1bf22,0x3dc9be95
.long 0x0,0x0,0x0,0x0,0x3f753f7f,0x3f463f62,0xbf75bf7f,0xbf46bf62
.long 0xbf0ebe48,0xbf7bbf55,0xbf0ebe48,0xbf7bbf55,0xbf22bf75,0x3ef1bdc9,0x3f223f75,0xbef13dc9
.long 0x3f6d3ec4,0x3ec43f6d,0x3f6d3ec4,0x3ec43f6d,0x3dc93f62,0xbf75bf46,0xbdc9bf62,0x3f753f46
.long 0xbf7bbf0e,0x3f55be48,0xbf7bbf0e,0x3f55be48,0x3ef1bf46,0xbdc93f75,0xbef13f46,0x3dc9bf75
.long 0x3f353f35,0xbf35bf35,0x3f353f35,0xbf35bf35,0xbf623f22,0x3f7fbe95,0x3f62bf22,0xbf7f3e95
.long 0xbe48bf55,0xbf0e3f7b,0xbe48bf55,0xbf0e3f7b,0x3f7fbef1,0xbe95bf22,0xbf7f3ef1,0x3e953f22
.long 0xbec43f6d,0x3f6dbec4,0xbec43f6d,0x3f6dbec4,0xbf463e95,0xbf623f7f,0x3f46be95,0x3f62bf7f
.long 0x3f55bf7b,0x3e48bf0e,0x3f55bf7b,0x3e48bf0e,0x3e95bdc9,0x3f22bef1,0xbe953dc9,0xbf223ef1
.long 0x0,0x0,0x0,0x0,0x3ef13f22,0x3dc93e95,0xbef1bf22,0xbdc9be95
.long 0xbf55bf7b,0xbe48bf0e,0xbf55bf7b,0xbe48bf0e,0x3f7f3f62,0x3e953f46,0xbf7fbf62,0xbe95bf46
.long 0xbf6dbec4,0xbec4bf6d,0xbf6dbec4,0xbec4bf6d,0x3f22be95,0x3ef13f7f,0xbf223e95,0xbef1bf7f
.long 0xbe483f55,0xbf0ebf7b,0xbe483f55,0xbf0ebf7b,0xbe95bf7f,0x3f223f62,0x3e953f7f,0xbf22bf62
.long 0x3f353f35,0xbf35bf35,0x3f353f35,0xbf35bf35,0xbf75bdc9,0x3f463ef1,0x3f753dc9,0xbf46bef1
.long 0x3f7bbf0e,0xbf55be48,0x3f7bbf0e,0xbf55be48,0xbf463f75,0x3f62bdc9,0x3f46bf75,0xbf623dc9
.long 0x3ec4bf6d,0xbf6d3ec4,0x3ec4bf6d,0xbf6d3ec4,0x3dc93ef1,0x3f75bf22,0xbdc9bef1,0xbf753f22
.long 0xbf0e3e48,0xbf7b3f55,0xbf0e3e48,0xbf7b3f55,0x3f62bf46,0x3f7fbf75,0xbf623f46,0xbf7f3f75
.long 0x0,0x0,0x0,0x0,0xbe95bdc9,0xbf22bef1,0x3e953dc9,0x3f223ef1
.long 0xbf0ebe48,0xbf7bbf55,0xbf0ebe48,0xbf7bbf55,0xbf46be95,0xbf62bf7f,0x3f463e95,0x3f623f7f
.long 0xbf6dbec4,0xbec4bf6d,0xbf6dbec4,0xbec4bf6d,0xbf7fbef1,0x3e95bf22,0x3f7f3ef1,0xbe953f22
.long 0xbf7bbf0e,0x3f55be48,0xbf7bbf0e,0x3f55be48,0xbf62bf22,0x3f7f3e95,0x3f623f22,0xbf7fbe95
.long 0xbf35bf35,0x3f353f35,0xbf35bf35,0x3f353f35,0xbef1bf46,0x3dc93f75,0x3ef13f46,0xbdc9bf75
.long 0xbe48bf55,0xbf0e3f7b,0xbe48bf55,0xbf0e3f7b,0x3dc9bf62,0xbf753f46,0xbdc93f62,0x3f75bf46
.long 0x3ec4bf6d,0xbf6d3ec4,0x3ec4bf6d,0xbf6d3ec4,0x3f22bf75,0xbef1bdc9,0xbf223f75,0x3ef13dc9
.long 0x3f55bf7b,0x3e48bf0e,0x3f55bf7b,0x3e48bf0e,0x3f75bf7f,0x3f46bf62,0xbf753f7f,0xbf463f62
.long 0x0,0x0,0x0,0x0,0xbf62bf46,0xbf7fbf75,0x3f623f46,0x3f7f3f75
.long 0xbf55bf7b,0xbe48bf0e,0xbf55bf7b,0xbe48bf0e,0x3dc9bef1,0x3f753f22,0xbdc93ef1,0xbf75bf22
.long 0x3f6d3ec4,0x3ec43f6d,0x3f6d3ec4,0x3ec43f6d,0x3f463f75,0xbf62bdc9,0xbf46bf75,0x3f623dc9
.long 0xbe483f55,0xbf0ebf7b,0xbe483f55,0xbf0ebf7b,0xbf753dc9,0x3f46bef1,0x3f75bdc9,0xbf463ef1
.long 0xbf35bf35,0x3f353f35,0xbf35bf35,0x3f353f35,0x3e95bf7f,0xbf223f62,0xbe953f7f,0x3f22bf62
.long 0x3f7bbf0e,0xbf55be48,0x3f7bbf0e,0xbf55be48,0x3f223e95,0x3ef1bf7f,0xbf22be95,0xbef13f7f
.long 0xbec43f6d,0x3f6dbec4,0xbec43f6d,0x3f6dbec4,0xbf7f3f62,0xbe953f46,0x3f7fbf62,0x3e95bf46
.long 0xbf0e3e48,0xbf7b3f55,0xbf0e3e48,0xbf7b3f55,0x3ef1bf22,0x3dc9be95,0xbef13f22,0xbdc93e95
.long 0x0,0x0,0x0,0x0,0xbf75bf7f,0xbf46bf62,0x3f753f7f,0x3f463f62
.long 0x3f0e3e48,0x3f7b3f55,0x3f0e3e48,0x3f7b3f55,0x3f223f75,0xbef13dc9,0xbf22bf75,0x3ef1bdc9
.long 0xbf6dbec4,0xbec4bf6d,0xbf6dbec4,0xbec4bf6d,0xbdc9bf62,0x3f753f46,0x3dc93f62,0xbf75bf46
.long 0x3f7b3f0e,0xbf553e48,0x3f7b3f0e,0xbf553e48,0xbef13f46,0x3dc9bf75,0x3ef1bf46,0xbdc93f75
.long 0xbf35bf35,0x3f353f35,0xbf35bf35,0x3f353f35,0x3f62bf22,0xbf7f3e95,0xbf623f22,0x3f7fbe95
.long 0x3e483f55,0x3f0ebf7b,0x3e483f55,0x3f0ebf7b,0xbf7f3ef1,0x3e953f22,0x3f7fbef1,0xbe95bf22
.long 0x3ec4bf6d,0xbf6d3ec4,0x3ec4bf6d,0xbf6d3ec4,0x3f46be95,0x3f62bf7f,0xbf463e95,0xbf623f7f
.long 0xbf553f7b,0xbe483f0e,0xbf553f7b,0xbe483f0e,0xbe953dc9,0xbf223ef1,0x3e95bdc9,0x3f22bef1
.long 0x0,0x0,0x0,0x0,0xbef1bf22,0xbdc9be95,0x3ef13f22,0x3dc93e95
.long 0x3f553f7b,0x3e483f0e,0x3f553f7b,0x3e483f0e,0xbf7fbf62,0xbe95bf46,0x3f7f3f62,0x3e953f46
.long 0x3f6d3ec4,0x3ec43f6d,0x3f6d3ec4,0x3ec43f6d,0xbf223e95,0xbef1bf7f,0x3f22be95,0x3ef13f7f
.long 0x3e48bf55,0x3f0e3f7b,0x3e48bf55,0x3f0e3f7b,0x3e953f7f,0xbf22bf62,0xbe95bf7f,0x3f223f62
.long 0xbf35bf35,0x3f353f35,0xbf35bf35,0x3f353f35,0x3f753dc9,0xbf46bef1,0xbf75bdc9,0x3f463ef1
.long 0xbf7b3f0e,0x3f553e48,0xbf7b3f0e,0x3f553e48,0x3f46bf75,0xbf623dc9,0xbf463f75,0x3f62bdc9
.long 0xbec43f6d,0x3f6dbec4,0xbec43f6d,0x3f6dbec4,0xbdc9bef1,0xbf753f22,0x3dc93ef1,0x3f75bf22
.long 0x3f0ebe48,0x3f7bbf55,0x3f0ebe48,0x3f7bbf55,0xbf623f46,0xbf7f3f75,0x3f62bf46,0x3f7fbf75
.long 0x0,0x0,0x0,0x0,0x3e95bdc9,0x3f22bef1,0xbe953dc9,0xbf223ef1
.long 0x3f0ebe48,0x3f7bbf55,0x3f0ebe48,0x3f7bbf55,0x3f46be95,0x3f62bf7f,0xbf463e95,0xbf623f7f
.long 0x3f6dbec4,0x3ec4bf6d,0x3f6dbec4,0x3ec4bf6d,0x3f7fbef1,0xbe95bf22,0xbf7f3ef1,0x3e953f22
.long 0x3f7bbf0e,0xbf55be48,0x3f7bbf0e,0xbf55be48,0x3f62bf22,0xbf7f3e95,0xbf623f22,0x3f7fbe95
.long 0x3f35bf35,0xbf353f35,0x3f35bf35,0xbf353f35,0x3ef1bf46,0xbdc93f75,0xbef13f46,0x3dc9bf75
.long 0x3e48bf55,0x3f0e3f7b,0x3e48bf55,0x3f0e3f7b,0xbdc9bf62,0x3f753f46,0x3dc93f62,0xbf75bf46
.long 0xbec4bf6d,0x3f6d3ec4,0xbec4bf6d,0x3f6d3ec4,0xbf22bf75,0x3ef1bdc9,0x3f223f75,0xbef13dc9
.long 0xbf55bf7b,0xbe48bf0e,0xbf55bf7b,0xbe48bf0e,0xbf75bf7f,0xbf46bf62,0x3f753f7f,0x3f463f62
.long 0x0,0x0,0x0,0x0,0x3f62bf46,0x3f7fbf75,0xbf623f46,0xbf7f3f75
.long 0x3f55bf7b,0x3e48bf0e,0x3f55bf7b,0x3e48bf0e,0xbdc9bef1,0xbf753f22,0x3dc93ef1,0x3f75bf22
.long 0xbf6d3ec4,0xbec43f6d,0xbf6d3ec4,0xbec43f6d,0xbf463f75,0x3f62bdc9,0x3f46bf75,0xbf623dc9
.long 0x3e483f55,0x3f0ebf7b,0x3e483f55,0x3f0ebf7b,0x3f753dc9,0xbf46bef1,0xbf75bdc9,0x3f463ef1
.long 0x3f35bf35,0xbf353f35,0x3f35bf35,0xbf353f35,0xbe95bf7f,0x3f223f62,0x3e953f7f,0xbf22bf62
.long 0xbf7bbf0e,0x3f55be48,0xbf7bbf0e,0x3f55be48,0xbf223e95,0xbef1bf7f,0x3f22be95,0x3ef13f7f
.long 0x3ec43f6d,0xbf6dbec4,0x3ec43f6d,0xbf6dbec4,0x3f7f3f62,0x3e953f46,0xbf7fbf62,0xbe95bf46
.long 0x3f0e3e48,0x3f7b3f55,0x3f0e3e48,0x3f7b3f55,0xbef1bf22,0xbdc9be95,0x3ef13f22,0x3dc93e95
.long 0x0,0x0,0x0,0x0,0x3f75bf7f,0x3f46bf62,0xbf753f7f,0xbf463f62
.long 0xbf0e3e48,0xbf7b3f55,0xbf0e3e48,0xbf7b3f55,0xbf223f75,0x3ef13dc9,0x3f22bf75,0xbef1bdc9
.long 0x3f6dbec4,0x3ec4bf6d,0x3f6dbec4,0x3ec4bf6d,0x3dc9bf62,0xbf753f46,0xbdc93f62,0x3f75bf46
.long 0xbf7b3f0e,0x3f553e48,0xbf7b3f0e,0x3f553e48,0x3ef13f46,0xbdc9bf75,0xbef1bf46,0x3dc93f75
.long 0x3f35bf35,0xbf353f35,0x3f35bf35,0xbf353f35,0xbf62bf22,0x3f7f3e95,0x3f623f22,0xbf7fbe95
.long 0xbe483f55,0xbf0ebf7b,0xbe483f55,0xbf0ebf7b,0x3f7f3ef1,0xbe953f22,0xbf7fbef1,0x3e95bf22
.long 0xbec4bf6d,0x3f6d3ec4,0xbec4bf6d,0x3f6d3ec4,0xbf46be95,0xbf62bf7f,0x3f463e95,0x3f623f7f
.long 0x3f553f7b,0x3e483f0e,0x3f553f7b,0x3e483f0e,0x3e953dc9,0x3f223ef1,0xbe95bdc9,0xbf22bef1
.long 0x0,0x0,0x0,0x0,0x3ef1bf22,0x3dc9be95,0xbef13f22,0xbdc93e95
.long 0xbf553f7b,0xbe483f0e,0xbf553f7b,0xbe483f0e,0x3f7fbf62,0x3e95bf46,0xbf7f3f62,0xbe953f46
.long 0xbf6d3ec4,0xbec43f6d,0xbf6d3ec4,0xbec43f6d,0x3f223e95,0x3ef1bf7f,0xbf22be95,0xbef13f7f
.long 0xbe48bf55,0xbf0e3f7b,0xbe48bf55,0xbf0e3f7b,0xbe953f7f,0x3f22bf62,0x3e95bf7f,0xbf223f62
.long 0x3f35bf35,0xbf353f35,0x3f35bf35,0xbf353f35,0xbf753dc9,0x3f46bef1,0x3f75bdc9,0xbf463ef1
.long 0x3f7b3f0e,0xbf553e48,0x3f7b3f0e,0xbf553e48,0xbf46bf75,0x3f623dc9,0x3f463f75,0xbf62bdc9
.long 0x3ec43f6d,0xbf6dbec4,0x3ec43f6d,0xbf6dbec4,0x3dc9bef1,0x3f753f22,0xbdc93ef1,0xbf75bf22
.long 0xbf0ebe48,0xbf7bbf55,0xbf0ebe48,0xbf7bbf55,0x3f623f46,0x3f7f3f75,0xbf62bf46,0xbf7fbf75
.long 0xbf803f80,0xbf803f80,0xbf803f80,0xbf803f80,0xbf753f7f,0xbf463f62,0x3f75bf7f,0x3f46bf62
.long 0xbf553f7b,0xbe483f0e,0xbf553f7b,0xbe483f0e,0xbf223f75,0x3ef13dc9,0x3f22bf75,0xbef1bdc9
.long 0xbec43f6d,0x3f6dbec4,0xbec43f6d,0x3f6dbec4,0xbdc93f62,0x3f75bf46,0x3dc9bf62,0xbf753f46
.long 0x3e483f55,0x3f0ebf7b,0x3e483f55,0x3f0ebf7b,0x3ef13f46,0xbdc9bf75,0xbef1bf46,0x3dc93f75
.long 0x3f353f35,0xbf35bf35,0x3f353f35,0xbf35bf35,0x3f623f22,0xbf7fbe95,0xbf62bf22,0x3f7f3e95
.long 0x3f7b3f0e,0xbf553e48,0x3f7b3f0e,0xbf553e48,0x3f7f3ef1,0xbe953f22,0xbf7fbef1,0x3e95bf22
.long 0x3f6d3ec4,0x3ec43f6d,0x3f6d3ec4,0x3ec43f6d,0x3f463e95,0x3f623f7f,0xbf46be95,0xbf62bf7f
.long 0x3f0e3e48,0x3f7b3f55,0x3f0e3e48,0x3f7b3f55,0x3e953dc9,0x3f223ef1,0xbe95bdc9,0xbf22bef1
.long 0xbf803f80,0xbf803f80,0xbf803f80,0xbf803f80,0xbef13f22,0xbdc93e95,0x3ef1bf22,0x3dc9be95
.long 0x3f0ebe48,0x3f7bbf55,0x3f0ebe48,0x3f7bbf55,0x3f7fbf62,0x3e95bf46,0xbf7f3f62,0xbe953f46
.long 0x3ec4bf6d,0xbf6d3ec4,0x3ec4bf6d,0xbf6d3ec4,0xbf22be95,0xbef13f7f,0x3f223e95,0x3ef1bf7f
.long 0xbf7b3f0e,0x3f553e48,0xbf7b3f0e,0x3f553e48,0xbe953f7f,0x3f22bf62,0x3e95bf7f,0xbf223f62
.long 0x3f353f35,0xbf35bf35,0x3f353f35,0xbf35bf35,0x3f75bdc9,0xbf463ef1,0xbf753dc9,0x3f46bef1
.long 0x3e48bf55,0x3f0e3f7b,0x3e48bf55,0x3f0e3f7b,0xbf46bf75,0x3f623dc9,0x3f463f75,0xbf62bdc9
.long 0xbf6dbec4,0xbec4bf6d,0xbf6dbec4,0xbec4bf6d,0xbdc93ef1,0xbf75bf22,0x3dc9bef1,0x3f753f22
.long 0x3f553f7b,0x3e483f0e,0x3f553f7b,0x3e483f0e,0x3f623f46,0x3f7f3f75,0xbf62bf46,0xbf7fbf75
.long 0xbf803f80,0xbf803f80,0xbf803f80,0xbf803f80,0x3e95bdc9,0x3f22bef1,0xbe953dc9,0xbf223ef1
.long 0x3f55bf7b,0x3e48bf0e,0x3f55bf7b,0x3e48bf0e,0xbf463e95,0xbf623f7f,0x3f46be95,0x3f62bf7f
.long 0xbec43f6d,0x3f6dbec4,0xbec43f6d,0x3f6dbec4,0x3f7fbef1,0xbe95bf22,0xbf7f3ef1,0x3e953f22
.long 0xbe48bf55,0xbf0e3f7b,0xbe48bf55,0xbf0e3f7b,0xbf623f22,0x3f7fbe95,0x3f62bf22,0xbf7f3e95
.long 0x3f353f35,0xbf35bf35,0x3f353f35,0xbf35bf35,0x3ef1bf46,0xbdc93f75,0xbef13f46,0x3dc9bf75
.long 0xbf7bbf0e,0x3f55be48,0xbf7bbf0e,0x3f55be48,0x3dc93f62,0xbf75bf46,0xbdc9bf62,0x3f753f46
.long 0x3f6d3ec4,0x3ec43f6d,0x3f6d3ec4,0x3ec43f6d,0xbf22bf75,0x3ef1bdc9,0x3f223f75,0xbef13dc9
.long 0xbf0ebe48,0xbf7bbf55,0xbf0ebe48,0xbf7bbf55,0x3f753f7f,0x3f463f62,0xbf75bf7f,0xbf46bf62
.long 0xbf803f80,0xbf803f80,0xbf803f80,0xbf803f80,0x3f62bf46,0x3f7fbf75,0xbf623f46,0xbf7f3f75
.long 0xbf0e3e48,0xbf7b3f55,0xbf0e3e48,0xbf7b3f55,0x3dc93ef1,0x3f75bf22,0xbdc9bef1,0xbf753f22
.long 0x3ec4bf6d,0xbf6d3ec4,0x3ec4bf6d,0xbf6d3ec4,0xbf463f75,0x3f62bdc9,0x3f46bf75,0xbf623dc9
.long 0x3f7bbf0e,0xbf55be48,0x3f7bbf0e,0xbf55be48,0xbf75bdc9,0x3f463ef1,0x3f753dc9,0xbf46bef1
.long 0x3f353f35,0xbf35bf35,0x3f353f35,0xbf35bf35,0xbe95bf7f,0x3f223f62,0x3e953f7f,0xbf22bf62
.long 0xbe483f55,0xbf0ebf7b,0xbe483f55,0xbf0ebf7b,0x3f22be95,0x3ef13f7f,0xbf223e95,0xbef1bf7f
.long 0xbf6dbec4,0xbec4bf6d,0xbf6dbec4,0xbec4bf6d,0x3f7f3f62,0x3e953f46,0xbf7fbf62,0xbe95bf46
.long 0xbf55bf7b,0xbe48bf0e,0xbf55bf7b,0xbe48bf0e,0x3ef13f22,0x3dc93e95,0xbef1bf22,0xbdc9be95
.long 0x3f80bf80,0x3f80bf80,0x3f80bf80,0x3f80bf80,0x3f75bf7f,0x3f46bf62,0xbf753f7f,0xbf463f62
.long 0x3f55bf7b,0x3e48bf0e,0x3f55bf7b,0x3e48bf0e,0x3f22bf75,0xbef1bdc9,0xbf223f75,0x3ef13dc9
.long 0x3ec4bf6d,0xbf6d3ec4,0x3ec4bf6d,0xbf6d3ec4,0x3dc9bf62,0xbf753f46,0xbdc93f62,0x3f75bf46
.long 0xbe48bf55,0xbf0e3f7b,0xbe48bf55,0xbf0e3f7b,0xbef1bf46,0x3dc93f75,0x3ef13f46,0xbdc9bf75
.long 0xbf35bf35,0x3f353f35,0xbf35bf35,0x3f353f35,0xbf62bf22,0x3f7f3e95,0x3f623f22,0xbf7fbe95
.long 0xbf7bbf0e,0x3f55be48,0xbf7bbf0e,0x3f55be48,0xbf7fbef1,0x3e95bf22,0x3f7f3ef1,0xbe953f22
.long 0xbf6dbec4,0xbec4bf6d,0xbf6dbec4,0xbec4bf6d,0xbf46be95,0xbf62bf7f,0x3f463e95,0x3f623f7f
.long 0xbf0ebe48,0xbf7bbf55,0xbf0ebe48,0xbf7bbf55,0xbe95bdc9,0xbf22bef1,0x3e953dc9,0x3f223ef1
.long 0x3f80bf80,0x3f80bf80,0x3f80bf80,0x3f80bf80,0x3ef1bf22,0x3dc9be95,0xbef13f22,0xbdc93e95
.long 0xbf0e3e48,0xbf7b3f55,0xbf0e3e48,0xbf7b3f55,0xbf7f3f62,0xbe953f46,0x3f7fbf62,0x3e95bf46
.long 0xbec43f6d,0x3f6dbec4,0xbec43f6d,0x3f6dbec4,0x3f223e95,0x3ef1bf7f,0xbf22be95,0xbef13f7f
.long 0x3f7bbf0e,0xbf55be48,0x3f7bbf0e,0xbf55be48,0x3e95bf7f,0xbf223f62,0xbe953f7f,0x3f22bf62
.long 0xbf35bf35,0x3f353f35,0xbf35bf35,0x3f353f35,0xbf753dc9,0x3f46bef1,0x3f75bdc9,0xbf463ef1
.long 0xbe483f55,0xbf0ebf7b,0xbe483f55,0xbf0ebf7b,0x3f463f75,0xbf62bdc9,0xbf46bf75,0x3f623dc9
.long 0x3f6d3ec4,0x3ec43f6d,0x3f6d3ec4,0x3ec43f6d,0x3dc9bef1,0x3f753f22,0xbdc93ef1,0xbf75bf22
.long 0xbf55bf7b,0xbe48bf0e,0xbf55bf7b,0xbe48bf0e,0xbf62bf46,0xbf7fbf75,0x3f623f46,0x3f7f3f75
.long 0x3f80bf80,0x3f80bf80,0x3f80bf80,0x3f80bf80,0xbe953dc9,0xbf223ef1,0x3e95bdc9,0x3f22bef1
.long 0xbf553f7b,0xbe483f0e,0xbf553f7b,0xbe483f0e,0x3f46be95,0x3f62bf7f,0xbf463e95,0xbf623f7f
.long 0x3ec4bf6d,0xbf6d3ec4,0x3ec4bf6d,0xbf6d3ec4,0xbf7f3ef1,0x3e953f22,0x3f7fbef1,0xbe95bf22
.long 0x3e483f55,0x3f0ebf7b,0x3e483f55,0x3f0ebf7b,0x3f62bf22,0xbf7f3e95,0xbf623f22,0x3f7fbe95
.long 0xbf35bf35,0x3f353f35,0xbf35bf35,0x3f353f35,0xbef13f46,0x3dc9bf75,0x3ef1bf46,0xbdc93f75
.long 0x3f7b3f0e,0xbf553e48,0x3f7b3f0e,0xbf553e48,0xbdc9bf62,0x3f753f46,0x3dc93f62,0xbf75bf46
.long 0xbf6dbec4,0xbec4bf6d,0xbf6dbec4,0xbec4bf6d,0x3f223f75,0xbef13dc9,0xbf22bf75,0x3ef1bdc9
.long 0x3f0e3e48,0x3f7b3f55,0x3f0e3e48,0x3f7b3f55,0xbf75bf7f,0xbf46bf62,0x3f753f7f,0x3f463f62
.long 0x3f80bf80,0x3f80bf80,0x3f80bf80,0x3f80bf80,0xbf623f46,0xbf7f3f75,0x3f62bf46,0x3f7fbf75
.long 0x3f0ebe48,0x3f7bbf55,0x3f0ebe48,0x3f7bbf55,0xbdc9bef1,0xbf753f22,0x3dc93ef1,0x3f75bf22
.long 0xbec43f6d,0x3f6dbec4,0xbec43f6d,0x3f6dbec4,0x3f46bf75,0xbf623dc9,0xbf463f75,0x3f62bdc9
.long 0xbf7b3f0e,0x3f553e48,0xbf7b3f0e,0x3f553e48,0x3f753dc9,0xbf46bef1,0xbf75bdc9,0x3f463ef1
.long 0xbf35bf35,0x3f353f35,0xbf35bf35,0x3f353f35,0x3e953f7f,0xbf22bf62,0xbe95bf7f,0x3f223f62
.long 0x3e48bf55,0x3f0e3f7b,0x3e48bf55,0x3f0e3f7b,0xbf223e95,0xbef1bf7f,0x3f22be95,0x3ef13f7f
.long 0x3f6d3ec4,0x3ec43f6d,0x3f6d3ec4,0x3ec43f6d,0xbf7fbf62,0xbe95bf46,0x3f7f3f62,0x3e953f46
.long 0x3f553f7b,0x3e483f0e,0x3f553f7b,0x3e483f0e,0xbef1bf22,0xbdc9be95,0x3ef13f22,0x3dc93e95
.long 0xbdc90000,0xbe95be48,0x3f7f3f80,0x3f753f7b,0x3e950000,0x3f463f0e,0x3f753f80,0x3f223f55
.long 0xbef10000,0xbf7fbf55,0x3f623f80,0x3dc93f0e,0x3f220000,0x3f623f7b,0x3f463f80,0xbef13e48
.long 0xbf460000,0xbef1bf7b,0x3f223f80,0xbf62be48,0x3f620000,0xbdc93f55,0x3ef13f80,0xbf7fbf0e
.long 0xbf750000,0x3f22bf0e,0x3e953f80,0xbf46bf55,0x3f7f0000,0xbf753e48,0x3dc93f80,0xbe95bf7b
.long 0xbf7f0000,0x3f753e48,0xbdc93f80,0x3e95bf7b,0x3f750000,0xbf22bf0e,0xbe953f80,0x3f46bf55
.long 0xbf620000,0x3dc93f55,0xbef13f80,0x3f7fbf0e,0x3f460000,0x3ef1bf7b,0xbf223f80,0x3f62be48
.long 0xbf220000,0xbf623f7b,0xbf463f80,0x3ef13e48,0x3ef10000,0x3f7fbf55,0xbf623f80,0xbdc93f0e
.long 0xbe950000,0xbf463f0e,0xbf753f80,0xbf223f55,0x3dc90000,0x3e95be48,0xbf7f3f80,0xbf753f7b
.long 0xbef1bec4,0xbf22bf0e,0x3f623f6d,0x3f463f55,0x3f7f3f6d,0x3f623f7b,0x3dc93ec4,0xbef1be48
.long 0xbf22bf6d,0x3e95be48,0xbf46bec4,0xbf75bf7b,0xbe953ec4,0xbf7fbf55,0xbf75bf6d,0x3dc9bf0e
.long 0x3f753ec4,0x3dc93f55,0xbe95bf6d,0x3f7f3f0e,0xbf46bf6d,0x3f753e48,0x3f22bec4,0x3e953f7b
.long 0xbdc93f6d,0xbef1bf7b,0x3f7f3ec4,0xbf623e48,0x3f62bec4,0xbf463f0e,0x3ef13f6d,0xbf22bf55
.long 0xbf62bec4,0x3f463f0e,0xbef13f6d,0x3f22bf55,0x3dc93f6d,0x3ef1bf7b,0xbf7f3ec4,0x3f623e48
.long 0x3f46bf6d,0xbf753e48,0xbf22bec4,0xbe953f7b,0xbf753ec4,0xbdc93f55,0x3e95bf6d,0xbf7f3f0e
.long 0x3e953ec4,0x3f7fbf55,0x3f75bf6d,0xbdc9bf0e,0x3f22bf6d,0xbe95be48,0x3f46bec4,0x3f75bf7b
.long 0xbf7f3f6d,0xbf623f7b,0xbdc93ec4,0x3ef1be48,0x3ef1bec4,0x3f22bf0e,0xbf623f6d,0xbf463f55
.long 0xbf46bf35,0xbf62bf55,0x3f223f35,0x3ef13f0e,0x3ef13f35,0xbdc93e48,0xbf62bf35,0xbf7fbf7b
.long 0x3f753f35,0x3f463f7b,0xbe95bf35,0x3f223e48,0xbdc9bf35,0x3f753f0e,0x3f7f3f35,0x3e953f55
.long 0xbf7fbf35,0x3e95bf0e,0xbdc93f35,0xbf75bf55,0xbe953f35,0xbf22bf7b,0xbf75bf35,0x3f46be48
.long 0x3f623f35,0xbf7fbe48,0x3ef1bf35,0x3dc93f7b,0x3f22bf35,0xbef13f55,0x3f463f35,0xbf62bf0e
.long 0xbf22bf35,0x3ef13f55,0xbf463f35,0x3f62bf0e,0xbf623f35,0x3f7fbe48,0xbef1bf35,0xbdc93f7b
.long 0x3e953f35,0x3f22bf7b,0x3f75bf35,0xbf46be48,0x3f7fbf35,0xbe95bf0e,0x3dc93f35,0x3f75bf55
.long 0x3dc9bf35,0xbf753f0e,0xbf7f3f35,0xbe953f55,0xbf753f35,0xbf463f7b,0x3e95bf35,0xbf223e48
.long 0xbef13f35,0x3dc93e48,0x3f62bf35,0x3f7fbf7b,0x3f46bf35,0x3f62bf55,0xbf223f35,0xbef13f0e
.long 0xbf75bf6d,0xbf7fbf7b,0x3e953ec4,0x3dc93e48,0xbf22bec4,0xbf75bf55,0xbf46bf6d,0xbe95bf0e
.long 0xbdc93ec4,0xbf62bf0e,0x3f7f3f6d,0x3ef13f55,0x3ef13f6d,0xbf46be48,0xbf62bec4,0xbf22bf7b
.long 0x3f623f6d,0xbf223e48,0x3ef1bec4,0x3f463f7b,0x3f7f3ec4,0xbef13f0e,0x3dc93f6d,0xbf62bf55
.long 0x3f46bec4,0xbe953f55,0xbf22bf6d,0x3f753f0e,0x3e95bf6d,0xbdc93f7b,0x3f753ec4,0xbf7fbe48
.long 0xbe95bf6d,0x3dc93f7b,0xbf753ec4,0x3f7fbe48,0xbf46bec4,0x3e953f55,0x3f22bf6d,0xbf753f0e
.long 0xbf7f3ec4,0x3ef13f0e,0xbdc93f6d,0x3f62bf55,0xbf623f6d,0x3f223e48,0xbef1bec4,0xbf463f7b
.long 0xbef13f6d,0x3f46be48,0x3f62bec4,0x3f22bf7b,0x3dc93ec4,0x3f62bf0e,0xbf7f3f6d,0xbef13f55
.long 0x3f22bec4,0x3f75bf55,0x3f46bf6d,0x3e95bf0e,0x3f75bf6d,0x3f7fbf7b,0xbe953ec4,0xbdc93e48
.long 0x3f7f3f80,0x3f753f7b,0x3dc90000,0x3e953e48,0xbf75bf80,0xbf22bf55,0x3e950000,0x3f463f0e
.long 0x3f623f80,0x3dc93f0e,0x3ef10000,0x3f7f3f55,0xbf46bf80,0x3ef1be48,0x3f220000,0x3f623f7b
.long 0x3f223f80,0xbf62be48,0x3f460000,0x3ef13f7b,0xbef1bf80,0x3f7f3f0e,0x3f620000,0xbdc93f55
.long 0x3e953f80,0xbf46bf55,0x3f750000,0xbf223f0e,0xbdc9bf80,0x3e953f7b,0x3f7f0000,0xbf753e48
.long 0xbdc93f80,0x3e95bf7b,0x3f7f0000,0xbf75be48,0x3e95bf80,0xbf463f55,0x3f750000,0xbf22bf0e
.long 0xbef13f80,0x3f7fbf0e,0x3f620000,0xbdc9bf55,0x3f22bf80,0xbf623e48,0x3f460000,0x3ef1bf7b
.long 0xbf463f80,0x3ef13e48,0x3f220000,0x3f62bf7b,0x3f62bf80,0x3dc9bf0e,0x3ef10000,0x3f7fbf55
.long 0xbf753f80,0xbf223f55,0x3e950000,0x3f46bf0e,0x3f7fbf80,0x3f75bf7b,0x3dc90000,0x3e95be48
.long 0x3f623f6d,0x3f463f55,0x3ef13ec4,0x3f223f0e,0xbdc9bec4,0x3ef13e48,0x3f7f3f6d,0x3f623f7b
.long 0xbf46bec4,0xbf75bf7b,0x3f223f6d,0xbe953e48,0x3f753f6d,0xbdc93f0e,0xbe953ec4,0xbf7fbf55
.long 0xbe95bf6d,0x3f7f3f0e,0xbf75bec4,0xbdc9bf55,0xbf223ec4,0xbe95bf7b,0xbf46bf6d,0x3f753e48
.long 0x3f7f3ec4,0xbf623e48,0x3dc9bf6d,0x3ef13f7b,0xbef1bf6d,0x3f223f55,0x3f62bec4,0xbf463f0e
.long 0xbef13f6d,0x3f22bf55,0x3f623ec4,0xbf46bf0e,0x3f7fbec4,0xbf62be48,0x3dc93f6d,0x3ef1bf7b
.long 0xbf22bec4,0xbe953f7b,0xbf463f6d,0x3f75be48,0xbe953f6d,0x3f7fbf0e,0xbf753ec4,0xbdc93f55
.long 0x3f75bf6d,0xbdc9bf0e,0xbe95bec4,0xbf7f3f55,0xbf463ec4,0xbf753f7b,0x3f22bf6d,0xbe95be48
.long 0xbdc93ec4,0x3ef1be48,0x3f7fbf6d,0x3f62bf7b,0x3f62bf6d,0x3f46bf55,0x3ef1bec4,0x3f22bf0e
.long 0x3f223f35,0x3ef13f0e,0x3f463f35,0x3f623f55,0x3f623f35,0x3f7f3f7b,0x3ef13f35,0xbdc93e48
.long 0xbe95bf35,0x3f223e48,0xbf75bf35,0xbf46bf7b,0xbf7fbf35,0xbe95bf55,0xbdc9bf35,0x3f753f0e
.long 0xbdc93f35,0xbf75bf55,0x3f7f3f35,0xbe953f0e,0x3f753f35,0xbf463e48,0xbe953f35,0xbf22bf7b
.long 0x3ef1bf35,0x3dc93f7b,0xbf62bf35,0x3f7f3e48,0xbf46bf35,0x3f623f0e,0x3f22bf35,0xbef13f55
.long 0xbf463f35,0x3f62bf0e,0x3f223f35,0xbef1bf55,0x3ef13f35,0x3dc9bf7b,0xbf623f35,0x3f7fbe48
.long 0x3f75bf35,0xbf46be48,0xbe95bf35,0xbf223f7b,0xbdc9bf35,0xbf753f55,0x3f7fbf35,0xbe95bf0e
.long 0xbf7f3f35,0xbe953f55,0xbdc93f35,0x3f75bf0e,0xbe953f35,0x3f22be48,0xbf753f35,0xbf463f7b
.long 0x3f62bf35,0x3f7fbf7b,0x3ef1bf35,0xbdc9be48,0x3f22bf35,0x3ef1bf0e,0x3f46bf35,0x3f62bf55
.long 0x3e953ec4,0x3dc93e48,0x3f753f6d,0x3f7f3f7b,0x3f463f6d,0x3e953f0e,0xbf22bec4,0xbf75bf55
.long 0x3f7f3f6d,0x3ef13f55,0x3dc9bec4,0x3f623f0e,0x3f623ec4,0x3f223f7b,0x3ef13f6d,0xbf46be48
.long 0x3ef1bec4,0x3f463f7b,0xbf62bf6d,0x3f22be48,0xbdc9bf6d,0x3f623f55,0x3f7f3ec4,0xbef13f0e
.long 0xbf22bf6d,0x3f753f0e,0xbf463ec4,0x3e95bf55,0xbf75bec4,0x3f7f3e48,0x3e95bf6d,0xbdc93f7b
.long 0xbf753ec4,0x3f7fbe48,0x3e953f6d,0xbdc9bf7b,0xbf223f6d,0x3f75bf0e,0xbf46bec4,0x3e953f55
.long 0xbdc93f6d,0x3f62bf55,0x3f7fbec4,0xbef1bf0e,0x3ef13ec4,0x3f46bf7b,0xbf623f6d,0x3f223e48
.long 0x3f62bec4,0x3f22bf7b,0x3ef1bf6d,0xbf463e48,0x3f7fbf6d,0x3ef1bf55,0x3dc93ec4,0x3f62bf0e
.long 0x3f46bf6d,0x3e95bf0e,0xbf223ec4,0xbf753f55,0x3e95bec4,0x3dc9be48,0x3f75bf6d,0x3f7fbf7b
.long 0xbf7fbf80,0xbf75bf7b,0xbdc90000,0xbe95be48,0x3f753f80,0x3f223f55,0xbe950000,0xbf46bf0e
.long 0xbf62bf80,0xbdc9bf0e,0xbef10000,0xbf7fbf55,0x3f463f80,0xbef13e48,0xbf220000,0xbf62bf7b
.long 0xbf22bf80,0x3f623e48,0xbf460000,0xbef1bf7b,0x3ef13f80,0xbf7fbf0e,0xbf620000,0x3dc9bf55
.long 0xbe95bf80,0x3f463f55,0xbf750000,0x3f22bf0e,0x3dc93f80,0xbe95bf7b,0xbf7f0000,0x3f75be48
.long 0x3dc9bf80,0xbe953f7b,0xbf7f0000,0x3f753e48,0xbe953f80,0x3f46bf55,0xbf750000,0x3f223f0e
.long 0x3ef1bf80,0xbf7f3f0e,0xbf620000,0x3dc93f55,0xbf223f80,0x3f62be48,0xbf460000,0xbef13f7b
.long 0x3f46bf80,0xbef1be48,0xbf220000,0xbf623f7b,0xbf623f80,0xbdc93f0e,0xbef10000,0xbf7f3f55
.long 0x3f75bf80,0x3f22bf55,0xbe950000,0xbf463f0e,0xbf7f3f80,0xbf753f7b,0xbdc90000,0xbe953e48
.long 0xbf62bf6d,0xbf46bf55,0xbef1bec4,0xbf22bf0e,0x3dc93ec4,0xbef1be48,0xbf7fbf6d,0xbf62bf7b
.long 0x3f463ec4,0x3f753f7b,0xbf22bf6d,0x3e95be48,0xbf75bf6d,0x3dc9bf0e,0x3e95bec4,0x3f7f3f55
.long 0x3e953f6d,0xbf7fbf0e,0x3f753ec4,0x3dc93f55,0x3f22bec4,0x3e953f7b,0x3f463f6d,0xbf75be48
.long 0xbf7fbec4,0x3f62be48,0xbdc93f6d,0xbef1bf7b,0x3ef13f6d,0xbf22bf55,0xbf623ec4,0x3f46bf0e
.long 0x3ef1bf6d,0xbf223f55,0xbf62bec4,0x3f463f0e,0xbf7f3ec4,0x3f623e48,0xbdc9bf6d,0xbef13f7b
.long 0x3f223ec4,0x3e95bf7b,0x3f46bf6d,0xbf753e48,0x3e95bf6d,0xbf7f3f0e,0x3f75bec4,0x3dc9bf55
.long 0xbf753f6d,0x3dc93f0e,0x3e953ec4,0x3f7fbf55,0x3f46bec4,0x3f75bf7b,0xbf223f6d,0x3e953e48
.long 0x3dc9bec4,0xbef13e48,0xbf7f3f6d,0xbf623f7b,0xbf623f6d,0xbf463f55,0xbef13ec4,0xbf223f0e
.long 0xbf22bf35,0xbef1bf0e,0xbf46bf35,0xbf62bf55,0xbf62bf35,0xbf7fbf7b,0xbef1bf35,0x3dc9be48
.long 0x3e953f35,0xbf22be48,0x3f753f35,0x3f463f7b,0x3f7f3f35,0x3e953f55,0x3dc93f35,0xbf75bf0e
.long 0x3dc9bf35,0x3f753f55,0xbf7fbf35,0x3e95bf0e,0xbf75bf35,0x3f46be48,0x3e95bf35,0x3f223f7b
.long 0xbef13f35,0xbdc9bf7b,0x3f623f35,0xbf7fbe48,0x3f463f35,0xbf62bf0e,0xbf223f35,0x3ef1bf55
.long 0x3f46bf35,0xbf623f0e,0xbf22bf35,0x3ef13f55,0xbef1bf35,0xbdc93f7b,0x3f62bf35,0xbf7f3e48
.long 0xbf753f35,0x3f463e48,0x3e953f35,0x3f22bf7b,0x3dc93f35,0x3f75bf55,0xbf7f3f35,0x3e953f0e
.long 0x3f7fbf35,0x3e95bf55,0x3dc9bf35,0xbf753f0e,0x3e95bf35,0xbf223e48,0x3f75bf35,0x3f46bf7b
.long 0xbf623f35,0xbf7f3f7b,0xbef13f35,0x3dc93e48,0xbf223f35,0xbef13f0e,0xbf463f35,0xbf623f55
.long 0xbe95bec4,0xbdc9be48,0xbf75bf6d,0xbf7fbf7b,0xbf46bf6d,0xbe95bf0e,0x3f223ec4,0x3f753f55
.long 0xbf7fbf6d,0xbef1bf55,0xbdc93ec4,0xbf62bf0e,0xbf62bec4,0xbf22bf7b,0xbef1bf6d,0x3f463e48
.long 0xbef13ec4,0xbf46bf7b,0x3f623f6d,0xbf223e48,0x3dc93f6d,0xbf62bf55,0xbf7fbec4,0x3ef1bf0e
.long 0x3f223f6d,0xbf75bf0e,0x3f46bec4,0xbe953f55,0x3f753ec4,0xbf7fbe48,0xbe953f6d,0x3dc9bf7b
.long 0x3f75bec4,0xbf7f3e48,0xbe95bf6d,0x3dc93f7b,0x3f22bf6d,0xbf753f0e,0x3f463ec4,0xbe95bf55
.long 0x3dc9bf6d,0xbf623f55,0xbf7f3ec4,0x3ef13f0e,0xbef1bec4,0xbf463f7b,0x3f62bf6d,0xbf22be48
.long 0xbf623ec4,0xbf223f7b,0xbef13f6d,0x3f46be48,0xbf7f3f6d,0xbef13f55,0xbdc9bec4,0xbf623f0e
.long 0xbf463f6d,0xbe953f0e,0x3f22bec4,0x3f75bf55,0xbe953ec4,0xbdc93e48,0xbf753f6d,0xbf7f3f7b
.long 0x3dc90000,0x3e95be48,0xbf7f3f80,0xbf753f7b,0xbe950000,0xbf463f0e,0xbf753f80,0xbf223f55
.long 0x3ef10000,0x3f7fbf55,0xbf623f80,0xbdc93f0e,0xbf220000,0xbf623f7b,0xbf463f80,0x3ef13e48
.long 0x3f460000,0x3ef1bf7b,0xbf223f80,0x3f62be48,0xbf620000,0x3dc93f55,0xbef13f80,0x3f7fbf0e
.long 0x3f750000,0xbf22bf0e,0xbe953f80,0x3f46bf55,0xbf7f0000,0x3f753e48,0xbdc93f80,0x3e95bf7b
.long 0x3f7f0000,0xbf753e48,0x3dc93f80,0xbe95bf7b,0xbf750000,0x3f22bf0e,0x3e953f80,0xbf46bf55
.long 0x3f620000,0xbdc93f55,0x3ef13f80,0xbf7fbf0e,0xbf460000,0xbef1bf7b,0x3f223f80,0xbf62be48
.long 0x3f220000,0x3f623f7b,0x3f463f80,0xbef13e48,0xbef10000,0xbf7fbf55,0x3f623f80,0x3dc93f0e
.long 0x3e950000,0x3f463f0e,0x3f753f80,0x3f223f55,0xbdc90000,0xbe95be48,0x3f7f3f80,0x3f753f7b
.long 0x3ef1bec4,0x3f22bf0e,0xbf623f6d,0xbf463f55,0xbf7f3f6d,0xbf623f7b,0xbdc93ec4,0x3ef1be48
.long 0x3f22bf6d,0xbe95be48,0x3f46bec4,0x3f75bf7b,0x3e953ec4,0x3f7fbf55,0x3f75bf6d,0xbdc9bf0e
.long 0xbf753ec4,0xbdc93f55,0x3e95bf6d,0xbf7f3f0e,0x3f46bf6d,0xbf753e48,0xbf22bec4,0xbe953f7b
.long 0x3dc93f6d,0x3ef1bf7b,0xbf7f3ec4,0x3f623e48,0xbf62bec4,0x3f463f0e,0xbef13f6d,0x3f22bf55
.long 0x3f62bec4,0xbf463f0e,0x3ef13f6d,0xbf22bf55,0xbdc93f6d,0xbef1bf7b,0x3f7f3ec4,0xbf623e48
.long 0xbf46bf6d,0x3f753e48,0x3f22bec4,0x3e953f7b,0x3f753ec4,0x3dc93f55,0xbe95bf6d,0x3f7f3f0e
.long 0xbe953ec4,0xbf7fbf55,0xbf75bf6d,0x3dc9bf0e,0xbf22bf6d,0x3e95be48,0xbf46bec4,0xbf75bf7b
.long 0x3f7f3f6d,0x3f623f7b,0x3dc93ec4,0xbef1be48,0xbef1bec4,0xbf22bf0e,0x3f623f6d,0x3f463f55
.long 0x3f46bf35,0x3f62bf55,0xbf223f35,0xbef13f0e,0xbef13f35,0x3dc93e48,0x3f62bf35,0x3f7fbf7b
.long 0xbf753f35,0xbf463f7b,0x3e95bf35,0xbf223e48,0x3dc9bf35,0xbf753f0e,0xbf7f3f35,0xbe953f55
.long 0x3f7fbf35,0xbe95bf0e,0x3dc93f35,0x3f75bf55,0x3e953f35,0x3f22bf7b,0x3f75bf35,0xbf46be48
.long 0xbf623f35,0x3f7fbe48,0xbef1bf35,0xbdc93f7b,0xbf22bf35,0x3ef13f55,0xbf463f35,0x3f62bf0e
.long 0x3f22bf35,0xbef13f55,0x3f463f35,0xbf62bf0e,0x3f623f35,0xbf7fbe48,0x3ef1bf35,0x3dc93f7b
.long 0xbe953f35,0xbf22bf7b,0xbf75bf35,0x3f46be48,0xbf7fbf35,0x3e95bf0e,0xbdc93f35,0xbf75bf55
.long 0xbdc9bf35,0x3f753f0e,0x3f7f3f35,0x3e953f55,0x3f753f35,0x3f463f7b,0xbe95bf35,0x3f223e48
.long 0x3ef13f35,0xbdc93e48,0xbf62bf35,0xbf7fbf7b,0xbf46bf35,0xbf62bf55,0x3f223f35,0x3ef13f0e
.long 0x3f75bf6d,0x3f7fbf7b,0xbe953ec4,0xbdc93e48,0x3f22bec4,0x3f75bf55,0x3f46bf6d,0x3e95bf0e
.long 0x3dc93ec4,0x3f62bf0e,0xbf7f3f6d,0xbef13f55,0xbef13f6d,0x3f46be48,0x3f62bec4,0x3f22bf7b
.long 0xbf623f6d,0x3f223e48,0xbef1bec4,0xbf463f7b,0xbf7f3ec4,0x3ef13f0e,0xbdc93f6d,0x3f62bf55
.long 0xbf46bec4,0x3e953f55,0x3f22bf6d,0xbf753f0e,0xbe95bf6d,0x3dc93f7b,0xbf753ec4,0x3f7fbe48
.long 0x3e95bf6d,0xbdc93f7b,0x3f753ec4,0xbf7fbe48,0x3f46bec4,0xbe953f55,0xbf22bf6d,0x3f753f0e
.long 0x3f7f3ec4,0xbef13f0e,0x3dc93f6d,0xbf62bf55,0x3f623f6d,0xbf223e48,0x3ef1bec4,0x3f463f7b
.long 0x3ef13f6d,0xbf46be48,0xbf62bec4,0xbf22bf7b,0xbdc93ec4,0xbf62bf0e,0x3f7f3f6d,0x3ef13f55
.long 0xbf22bec4,0xbf75bf55,0xbf46bf6d,0xbe95bf0e,0xbf75bf6d,0xbf7fbf7b,0x3e953ec4,0x3dc93e48
.long 0xbf7f3f80,0xbf753f7b,0xbdc90000,0xbe953e48,0x3f75bf80,0x3f22bf55,0xbe950000,0xbf463f0e
.long 0xbf623f80,0xbdc93f0e,0xbef10000,0xbf7f3f55,0x3f46bf80,0xbef1be48,0xbf220000,0xbf623f7b
.long 0xbf223f80,0x3f62be48,0xbf460000,0xbef13f7b,0x3ef1bf80,0xbf7f3f0e,0xbf620000,0x3dc93f55
.long 0xbe953f80,0x3f46bf55,0xbf750000,0x3f223f0e,0x3dc9bf80,0xbe953f7b,0xbf7f0000,0x3f753e48
.long 0x3dc93f80,0xbe95bf7b,0xbf7f0000,0x3f75be48,0xbe95bf80,0x3f463f55,0xbf750000,0x3f22bf0e
.long 0x3ef13f80,0xbf7fbf0e,0xbf620000,0x3dc9bf55,0xbf22bf80,0x3f623e48,0xbf460000,0xbef1bf7b
.long 0x3f463f80,0xbef13e48,0xbf220000,0xbf62bf7b,0xbf62bf80,0xbdc9bf0e,0xbef10000,0xbf7fbf55
.long 0x3f753f80,0x3f223f55,0xbe950000,0xbf46bf0e,0xbf7fbf80,0xbf75bf7b,0xbdc90000,0xbe95be48
.long 0xbf623f6d,0xbf463f55,0xbef13ec4,0xbf223f0e,0x3dc9bec4,0xbef13e48,0xbf7f3f6d,0xbf623f7b
.long 0x3f46bec4,0x3f75bf7b,0xbf223f6d,0x3e953e48,0xbf753f6d,0x3dc93f0e,0x3e953ec4,0x3f7fbf55
.long 0x3e95bf6d,0xbf7f3f0e,0x3f75bec4,0x3dc9bf55,0x3f223ec4,0x3e95bf7b,0x3f46bf6d,0xbf753e48
.long 0xbf7f3ec4,0x3f623e48,0xbdc9bf6d,0xbef13f7b,0x3ef1bf6d,0xbf223f55,0xbf62bec4,0x3f463f0e
.long 0x3ef13f6d,0xbf22bf55,0xbf623ec4,0x3f46bf0e,0xbf7fbec4,0x3f62be48,0xbdc93f6d,0xbef1bf7b
.long 0x3f22bec4,0x3e953f7b,0x3f463f6d,0xbf75be48,0x3e953f6d,0xbf7fbf0e,0x3f753ec4,0x3dc93f55
.long 0xbf75bf6d,0x3dc9bf0e,0x3e95bec4,0x3f7f3f55,0x3f463ec4,0x3f753f7b,0xbf22bf6d,0x3e95be48
.long 0x3dc93ec4,0xbef1be48,0xbf7fbf6d,0xbf62bf7b,0xbf62bf6d,0xbf46bf55,0xbef1bec4,0xbf22bf0e
.long 0xbf223f35,0xbef13f0e,0xbf463f35,0xbf623f55,0xbf623f35,0xbf7f3f7b,0xbef13f35,0x3dc93e48
.long 0x3e95bf35,0xbf223e48,0x3f75bf35,0x3f46bf7b,0x3f7fbf35,0x3e95bf55,0x3dc9bf35,0xbf753f0e
.long 0x3dc93f35,0x3f75bf55,0xbf7f3f35,0x3e953f0e,0xbf753f35,0x3f463e48,0x3e953f35,0x3f22bf7b
.long 0xbef1bf35,0xbdc93f7b,0x3f62bf35,0xbf7f3e48,0x3f46bf35,0xbf623f0e,0xbf22bf35,0x3ef13f55
.long 0x3f463f35,0xbf62bf0e,0xbf223f35,0x3ef1bf55,0xbef13f35,0xbdc9bf7b,0x3f623f35,0xbf7fbe48
.long 0xbf75bf35,0x3f46be48,0x3e95bf35,0x3f223f7b,0x3dc9bf35,0x3f753f55,0xbf7fbf35,0x3e95bf0e
.long 0x3f7f3f35,0x3e953f55,0x3dc93f35,0xbf75bf0e,0x3e953f35,0xbf22be48,0x3f753f35,0x3f463f7b
.long 0xbf62bf35,0xbf7fbf7b,0xbef1bf35,0x3dc9be48,0xbf22bf35,0xbef1bf0e,0xbf46bf35,0xbf62bf55
.long 0xbe953ec4,0xbdc93e48,0xbf753f6d,0xbf7f3f7b,0xbf463f6d,0xbe953f0e,0x3f22bec4,0x3f75bf55
.long 0xbf7f3f6d,0xbef13f55,0xbdc9bec4,0xbf623f0e,0xbf623ec4,0xbf223f7b,0xbef13f6d,0x3f46be48
.long 0xbef1bec4,0xbf463f7b,0x3f62bf6d,0xbf22be48,0x3dc9bf6d,0xbf623f55,0xbf7f3ec4,0x3ef13f0e
.long 0x3f22bf6d,0xbf753f0e,0x3f463ec4,0xbe95bf55,0x3f75bec4,0xbf7f3e48,0xbe95bf6d,0x3dc93f7b
.long 0x3f753ec4,0xbf7fbe48,0xbe953f6d,0x3dc9bf7b,0x3f223f6d,0xbf75bf0e,0x3f46bec4,0xbe953f55
.long 0x3dc93f6d,0xbf62bf55,0xbf7fbec4,0x3ef1bf0e,0xbef13ec4,0xbf46bf7b,0x3f623f6d,0xbf223e48
.long 0xbf62bec4,0xbf22bf7b,0xbef1bf6d,0x3f463e48,0xbf7fbf6d,0xbef1bf55,0xbdc93ec4,0xbf62bf0e
.long 0xbf46bf6d,0xbe95bf0e,0x3f223ec4,0x3f753f55,0xbe95bec4,0xbdc9be48,0xbf75bf6d,0xbf7fbf7b
.long 0x3f7fbf80,0x3f75bf7b,0x3dc90000,0x3e95be48,0xbf753f80,0xbf223f55,0x3e950000,0x3f46bf0e
.long 0x3f62bf80,0x3dc9bf0e,0x3ef10000,0x3f7fbf55,0xbf463f80,0x3ef13e48,0x3f220000,0x3f62bf7b
.long 0x3f22bf80,0xbf623e48,0x3f460000,0x3ef1bf7b,0xbef13f80,0x3f7fbf0e,0x3f620000,0xbdc9bf55
.long 0x3e95bf80,0xbf463f55,0x3f750000,0xbf22bf0e,0xbdc93f80,0x3e95bf7b,0x3f7f0000,0xbf75be48
.long 0xbdc9bf80,0x3e953f7b,0x3f7f0000,0xbf753e48,0x3e953f80,0xbf46bf55,0x3f750000,0xbf223f0e
.long 0xbef1bf80,0x3f7f3f0e,0x3f620000,0xbdc93f55,0x3f223f80,0xbf62be48,0x3f460000,0x3ef13f7b
.long 0xbf46bf80,0x3ef1be48,0x3f220000,0x3f623f7b,0x3f623f80,0x3dc93f0e,0x3ef10000,0x3f7f3f55
.long 0xbf75bf80,0xbf22bf55,0x3e950000,0x3f463f0e,0x3f7f3f80,0x3f753f7b,0x3dc90000,0x3e953e48
.long 0x3f62bf6d,0x3f46bf55,0x3ef1bec4,0x3f22bf0e,0xbdc93ec4,0x3ef1be48,0x3f7fbf6d,0x3f62bf7b
.long 0xbf463ec4,0xbf753f7b,0x3f22bf6d,0xbe95be48,0x3f75bf6d,0xbdc9bf0e,0xbe95bec4,0xbf7f3f55
.long 0xbe953f6d,0x3f7fbf0e,0xbf753ec4,0xbdc93f55,0xbf22bec4,0xbe953f7b,0xbf463f6d,0x3f75be48
.long 0x3f7fbec4,0xbf62be48,0x3dc93f6d,0x3ef1bf7b,0xbef13f6d,0x3f22bf55,0x3f623ec4,0xbf46bf0e
.long 0xbef1bf6d,0x3f223f55,0x3f62bec4,0xbf463f0e,0x3f7f3ec4,0xbf623e48,0x3dc9bf6d,0x3ef13f7b
.long 0xbf223ec4,0xbe95bf7b,0xbf46bf6d,0x3f753e48,0xbe95bf6d,0x3f7f3f0e,0xbf75bec4,0xbdc9bf55
.long 0x3f753f6d,0xbdc93f0e,0xbe953ec4,0xbf7fbf55,0xbf46bec4,0xbf75bf7b,0x3f223f6d,0xbe953e48
.long 0xbdc9bec4,0x3ef13e48,0x3f7f3f6d,0x3f623f7b,0x3f623f6d,0x3f463f55,0x3ef13ec4,0x3f223f0e
.long 0x3f22bf35,0x3ef1bf0e,0x3f46bf35,0x3f62bf55,0x3f62bf35,0x3f7fbf7b,0x3ef1bf35,0xbdc9be48
.long 0xbe953f35,0x3f22be48,0xbf753f35,0xbf463f7b,0xbf7f3f35,0xbe953f55,0xbdc93f35,0x3f75bf0e
.long 0xbdc9bf35,0xbf753f55,0x3f7fbf35,0xbe95bf0e,0x3f75bf35,0xbf46be48,0xbe95bf35,0xbf223f7b
.long 0x3ef13f35,0x3dc9bf7b,0xbf623f35,0x3f7fbe48,0xbf463f35,0x3f62bf0e,0x3f223f35,0xbef1bf55
.long 0xbf46bf35,0x3f623f0e,0x3f22bf35,0xbef13f55,0x3ef1bf35,0x3dc93f7b,0xbf62bf35,0x3f7f3e48
.long 0x3f753f35,0xbf463e48,0xbe953f35,0xbf22bf7b,0xbdc93f35,0xbf75bf55,0x3f7f3f35,0xbe953f0e
.long 0xbf7fbf35,0xbe95bf55,0xbdc9bf35,0x3f753f0e,0xbe95bf35,0x3f223e48,0xbf75bf35,0xbf46bf7b
.long 0x3f623f35,0x3f7f3f7b,0x3ef13f35,0xbdc93e48,0x3f223f35,0x3ef13f0e,0x3f463f35,0x3f623f55
.long 0x3e95bec4,0x3dc9be48,0x3f75bf6d,0x3f7fbf7b,0x3f46bf6d,0x3e95bf0e,0xbf223ec4,0xbf753f55
.long 0x3f7fbf6d,0x3ef1bf55,0x3dc93ec4,0x3f62bf0e,0x3f62bec4,0x3f22bf7b,0x3ef1bf6d,0xbf463e48
.long 0x3ef13ec4,0x3f46bf7b,0xbf623f6d,0x3f223e48,0xbdc93f6d,0x3f62bf55,0x3f7fbec4,0xbef1bf0e
.long 0xbf223f6d,0x3f75bf0e,0xbf46bec4,0x3e953f55,0xbf753ec4,0x3f7fbe48,0x3e953f6d,0xbdc9bf7b
.long 0xbf75bec4,0x3f7f3e48,0x3e95bf6d,0xbdc93f7b,0xbf22bf6d,0x3f753f0e,0xbf463ec4,0x3e95bf55
.long 0xbdc9bf6d,0x3f623f55,0x3f7f3ec4,0xbef13f0e,0x3ef1bec4,0x3f463f7b,0xbf62bf6d,0x3f22be48
.long 0x3f623ec4,0x3f223f7b,0x3ef13f6d,0xbf46be48,0x3f7f3f6d,0x3ef13f55,0x3dc9bec4,0x3f623f0e
.long 0x3f463f6d,0x3e953f0e,0xbf22bec4,0xbf75bf55,0x3e953ec4,0x3dc93e48,0x3f753f6d,0x3f7f3f7b
.size k2_tab, 18432
.text
.p2align 8
.type k3_tab,@object
k3_tab:
.long 0x3f803f80,0x3f803f80,0x3f803f80,0x3f803f80,0x3f7b3f80,0x3f553f6d,0x3f6d3f7b,0x3f353f55
.long 0x3f6d3f80,0x3ec43f35,0x3f353f6d,0x3ec4,0x3f553f80,0xbe483ec4,0x3ec43f55,0xbf35be48
.long 0x3f353f80,0xbf350000,0x3f35,0xbf80bf35,0x3f0e3f80,0xbf7bbec4,0xbec43f0e,0xbf35bf7b
.long 0x3ec43f80,0xbf6dbf35,0xbf353ec4,0xbf6d,0x3e483f80,0xbf0ebf6d,0xbf6d3e48,0x3f35bf0e
.long 0x3f80,0xbf80,0xbf800000,0x3f800000,0xbe483f80,0x3f0ebf6d,0xbf6dbe48,0x3f353f0e
.long 0xbec43f80,0x3f6dbf35,0xbf35bec4,0x3f6d,0xbf0e3f80,0x3f7bbec4,0xbec4bf0e,0xbf353f7b
.long 0xbf353f80,0x3f350000,0xbf35,0xbf803f35,0xbf553f80,0x3e483ec4,0x3ec4bf55,0xbf353e48
.long 0xbf6d3f80,0xbec43f35,0x3f35bf6d,0xbec4,0xbf7b3f80,0xbf553f6d,0x3f6dbf7b,0x3f35bf55
.long 0x3f803f80,0x3f803f80,0x3f803f80,0x3f803f80,0x3f0e3f35,0x3e483ec4,0x3ec43f0e,0x3e48
.long 0xbec40000,0xbf6dbf35,0xbf35bec4,0xbf80bf6d,0xbf7bbf35,0xbf0ebf6d,0xbf6dbf7b,0xbf0e
.long 0xbf35bf80,0x3f350000,0xbf35,0x3f803f35,0x3e48bf35,0x3f553f6d,0x3f6d3e48,0x3f55
.long 0x3f6d0000,0xbec43f35,0x3f353f6d,0xbf80bec4,0x3f553f35,0xbf7bbec4,0xbec43f55,0xbf7b
.long 0x3f80,0xbf80,0xbf800000,0x3f800000,0xbf553f35,0x3f7bbec4,0xbec4bf55,0x3f7b
.long 0xbf6d0000,0x3ec43f35,0x3f35bf6d,0xbf803ec4,0xbe48bf35,0xbf553f6d,0x3f6dbe48,0xbf55
.long 0x3f35bf80,0xbf350000,0x3f35,0x3f80bf35,0x3f7bbf35,0x3f0ebf6d,0xbf6d3f7b,0x3f0e
.long 0x3ec40000,0x3f6dbf35,0xbf353ec4,0xbf803f6d,0xbf0e3f35,0xbe483ec4,0x3ec4bf0e,0xbe48
.long 0x3f803f80,0x3f803f80,0x3f803f80,0x3f803f80,0xbe480000,0xbf0ebec4,0xbec4be48,0xbf35bf0e
.long 0xbf6dbf80,0xbec4bf35,0xbf35bf6d,0xbec4,0x3f0e0000,0x3f7b3f6d,0x3f6d3f0e,0x3f353f7b
.long 0x3f353f80,0xbf350000,0x3f35,0xbf80bf35,0xbf550000,0xbe48bf6d,0xbf6dbf55,0x3f35be48
.long 0xbec4bf80,0x3f6d3f35,0x3f35bec4,0x3f6d,0x3f7b0000,0xbf553ec4,0x3ec43f7b,0xbf35bf55
.long 0x3f80,0xbf80,0xbf800000,0x3f800000,0xbf7b0000,0x3f553ec4,0x3ec4bf7b,0xbf353f55
.long 0x3ec4bf80,0xbf6d3f35,0x3f353ec4,0xbf6d,0x3f550000,0x3e48bf6d,0xbf6d3f55,0x3f353e48
.long 0xbf353f80,0x3f350000,0xbf35,0xbf803f35,0xbf0e0000,0xbf7b3f6d,0x3f6dbf0e,0x3f35bf7b
.long 0x3f6dbf80,0x3ec4bf35,0xbf353f6d,0x3ec4,0x3e480000,0x3f0ebec4,0xbec43e48,0xbf353f0e
.long 0x3f803f80,0x3f803f80,0x3f803f80,0x3f803f80,0xbf55bf35,0xbf7bbf6d,0xbf6dbf55,0xbf80bf7b
.long 0x3ec40000,0x3f6d3f35,0x3f353ec4,0x3f803f6d,0x3e483f35,0xbf55bec4,0xbec43e48,0xbf80bf55
.long 0xbf35bf80,0x3f350000,0xbf35,0x3f803f35,0x3f7b3f35,0xbf0e3ec4,0x3ec43f7b,0xbf80bf0e
.long 0xbf6d0000,0x3ec4bf35,0xbf35bf6d,0x3f803ec4,0x3f0ebf35,0xbe483f6d,0x3f6d3f0e,0xbf80be48
.long 0x3f80,0xbf80,0xbf800000,0x3f800000,0xbf0ebf35,0x3e483f6d,0x3f6dbf0e,0xbf803e48
.long 0x3f6d0000,0xbec4bf35,0xbf353f6d,0x3f80bec4,0xbf7b3f35,0x3f0e3ec4,0x3ec4bf7b,0xbf803f0e
.long 0x3f35bf80,0xbf350000,0x3f35,0x3f80bf35,0xbe483f35,0x3f55bec4,0xbec4be48,0xbf803f55
.long 0xbec40000,0xbf6d3f35,0x3f35bec4,0x3f80bf6d,0x3f55bf35,0x3f7bbf6d,0xbf6d3f55,0xbf803f7b
.long 0x0,0x0,0x0,0x0,0x3e480000,0x3f0e3ec4,0xbec4be48,0xbf35bf0e
.long 0x3ec40000,0x3f6d3f35,0xbf35bec4,0xbf80bf6d,0x3f0e0000,0x3f7b3f6d,0xbf6dbf0e,0xbf35bf7b
.long 0x3f350000,0x3f353f80,0xbf80bf35,0xbf35,0x3f550000,0x3e483f6d,0xbf6dbf55,0x3f35be48
.long 0x3f6d0000,0xbec43f35,0xbf35bf6d,0x3f803ec4,0x3f7b0000,0xbf553ec4,0xbec4bf7b,0x3f353f55
.long 0x3f800000,0xbf800000,0xbf80,0x3f80,0x3f7b0000,0xbf55bec4,0x3ec4bf7b,0xbf353f55
.long 0x3f6d0000,0xbec4bf35,0x3f35bf6d,0xbf803ec4,0x3f550000,0x3e48bf6d,0x3f6dbf55,0xbf35be48
.long 0x3f350000,0x3f35bf80,0x3f80bf35,0xbf35,0x3f0e0000,0x3f7bbf6d,0x3f6dbf0e,0x3f35bf7b
.long 0x3ec40000,0x3f6dbf35,0x3f35bec4,0x3f80bf6d,0x3e480000,0x3f0ebec4,0x3ec4be48,0x3f35bf0e
.long 0x0,0x0,0x0,0x0,0x3f553f35,0x3f7b3f6d,0xbf6dbf55,0xbf80bf7b
.long 0x3f6d3f80,0x3ec43f35,0xbf35bf6d,0xbec4,0x3e483f35,0xbf55bec4,0x3ec4be48,0x3f803f55
.long 0xbf350000,0xbf35bf80,0x3f803f35,0x3f35,0xbf7bbf35,0x3f0ebec4,0x3ec43f7b,0xbf80bf0e
.long 0xbec4bf80,0x3f6d3f35,0xbf353ec4,0xbf6d,0x3f0ebf35,0xbe483f6d,0xbf6dbf0e,0x3f803e48
.long 0x3f800000,0xbf800000,0xbf80,0x3f80,0x3f0e3f35,0xbe48bf6d,0x3f6dbf0e,0xbf803e48
.long 0xbec43f80,0x3f6dbf35,0x3f353ec4,0xbf6d,0xbf7b3f35,0x3f0e3ec4,0xbec43f7b,0x3f80bf0e
.long 0xbf350000,0xbf353f80,0xbf803f35,0x3f35,0x3e48bf35,0xbf553ec4,0xbec4be48,0xbf803f55
.long 0x3f6dbf80,0x3ec4bf35,0x3f35bf6d,0xbec4,0x3f55bf35,0x3f7bbf6d,0x3f6dbf55,0x3f80bf7b
.long 0x0,0x0,0x0,0x0,0x3f7b3f80,0x3f553f6d,0xbf6dbf7b,0xbf35bf55
.long 0xbec40000,0xbf6dbf35,0x3f353ec4,0x3f803f6d,0xbf55bf80,0x3e48bec4,0x3ec43f55,0xbf35be48
.long 0x3f350000,0x3f353f80,0xbf80bf35,0xbf35,0x3f0e3f80,0xbf7bbec4,0x3ec4bf0e,0x3f353f7b
.long 0xbf6d0000,0x3ec4bf35,0x3f353f6d,0xbf80bec4,0xbe48bf80,0x3f0e3f6d,0xbf6d3e48,0x3f35bf0e
.long 0x3f800000,0xbf800000,0xbf80,0x3f80,0xbe483f80,0x3f0ebf6d,0x3f6d3e48,0xbf35bf0e
.long 0xbf6d0000,0x3ec43f35,0xbf353f6d,0x3f80bec4,0x3f0ebf80,0xbf7b3ec4,0xbec4bf0e,0xbf353f7b
.long 0x3f350000,0x3f35bf80,0x3f80bf35,0xbf35,0xbf553f80,0x3e483ec4,0xbec43f55,0x3f35be48
.long 0xbec40000,0xbf6d3f35,0xbf353ec4,0xbf803f6d,0x3f7bbf80,0x3f55bf6d,0x3f6dbf7b,0x3f35bf55
.long 0x0,0x0,0x0,0x0,0x3f0e3f35,0x3e483ec4,0xbec4bf0e,0xbe48
.long 0xbf6dbf80,0xbec4bf35,0x3f353f6d,0x3ec4,0x3f7b3f35,0x3f0e3f6d,0xbf6dbf7b,0xbf0e
.long 0xbf350000,0xbf35bf80,0x3f803f35,0x3f35,0x3e48bf35,0x3f553f6d,0xbf6dbe48,0xbf55
.long 0x3ec43f80,0xbf6dbf35,0x3f35bec4,0x3f6d,0xbf55bf35,0x3f7b3ec4,0xbec43f55,0xbf7b
.long 0x3f800000,0xbf800000,0xbf80,0x3f80,0xbf553f35,0x3f7bbec4,0x3ec43f55,0xbf7b
.long 0x3ec4bf80,0xbf6d3f35,0xbf35bec4,0x3f6d,0x3e483f35,0x3f55bf6d,0x3f6dbe48,0xbf55
.long 0xbf350000,0xbf353f80,0xbf803f35,0x3f35,0x3f7bbf35,0x3f0ebf6d,0x3f6dbf7b,0xbf0e
.long 0xbf6d3f80,0xbec43f35,0xbf353f6d,0x3ec4,0x3f0ebf35,0x3e48bec4,0x3ec4bf0e,0xbe48
.long 0xbf803f80,0xbf803f80,0x3f80bf80,0x3f80bf80,0xbf7b3f80,0xbf553f6d,0x3f6dbf7b,0x3f35bf55
.long 0xbf6d3f80,0xbec43f35,0x3f35bf6d,0xbec4,0xbf553f80,0x3e483ec4,0x3ec4bf55,0xbf353e48
.long 0xbf353f80,0x3f350000,0xbf35,0xbf803f35,0xbf0e3f80,0x3f7bbec4,0xbec4bf0e,0xbf353f7b
.long 0xbec43f80,0x3f6dbf35,0xbf35bec4,0x3f6d,0xbe483f80,0x3f0ebf6d,0xbf6dbe48,0x3f353f0e
.long 0x3f80,0xbf80,0xbf800000,0x3f800000,0x3e483f80,0xbf0ebf6d,0xbf6d3e48,0x3f35bf0e
.long 0x3ec43f80,0xbf6dbf35,0xbf353ec4,0xbf6d,0x3f0e3f80,0xbf7bbec4,0xbec43f0e,0xbf35bf7b
.long 0x3f353f80,0xbf350000,0x3f35,0xbf80bf35,0x3f553f80,0xbe483ec4,0x3ec43f55,0xbf35be48
.long 0x3f6d3f80,0x3ec43f35,0x3f353f6d,0x3ec4,0x3f7b3f80,0x3f553f6d,0x3f6d3f7b,0x3f353f55
.long 0xbf803f80,0xbf803f80,0x3f80bf80,0x3f80bf80,0xbf0e3f35,0xbe483ec4,0x3ec4bf0e,0xbe48
.long 0x3ec40000,0x3f6dbf35,0xbf353ec4,0xbf803f6d,0x3f7bbf35,0x3f0ebf6d,0xbf6d3f7b,0x3f0e
.long 0x3f35bf80,0xbf350000,0x3f35,0x3f80bf35,0xbe48bf35,0xbf553f6d,0x3f6dbe48,0xbf55
.long 0xbf6d0000,0x3ec43f35,0x3f35bf6d,0xbf803ec4,0xbf553f35,0x3f7bbec4,0xbec4bf55,0x3f7b
.long 0x3f80,0xbf80,0xbf800000,0x3f800000,0x3f553f35,0xbf7bbec4,0xbec43f55,0xbf7b
.long 0x3f6d0000,0xbec43f35,0x3f353f6d,0xbf80bec4,0x3e48bf35,0x3f553f6d,0x3f6d3e48,0x3f55
.long 0xbf35bf80,0x3f350000,0xbf35,0x3f803f35,0xbf7bbf35,0xbf0ebf6d,0xbf6dbf7b,0xbf0e
.long 0xbec40000,0xbf6dbf35,0xbf35bec4,0xbf80bf6d,0x3f0e3f35,0x3e483ec4,0x3ec43f0e,0x3e48
.long 0xbf803f80,0xbf803f80,0x3f80bf80,0x3f80bf80,0x3e480000,0x3f0ebec4,0xbec43e48,0xbf353f0e
.long 0x3f6dbf80,0x3ec4bf35,0xbf353f6d,0x3ec4,0xbf0e0000,0xbf7b3f6d,0x3f6dbf0e,0x3f35bf7b
.long 0xbf353f80,0x3f350000,0xbf35,0xbf803f35,0x3f550000,0x3e48bf6d,0xbf6d3f55,0x3f353e48
.long 0x3ec4bf80,0xbf6d3f35,0x3f353ec4,0xbf6d,0xbf7b0000,0x3f553ec4,0x3ec4bf7b,0xbf353f55
.long 0x3f80,0xbf80,0xbf800000,0x3f800000,0x3f7b0000,0xbf553ec4,0x3ec43f7b,0xbf35bf55
.long 0xbec4bf80,0x3f6d3f35,0x3f35bec4,0x3f6d,0xbf550000,0xbe48bf6d,0xbf6dbf55,0x3f35be48
.long 0x3f353f80,0xbf350000,0x3f35,0xbf80bf35,0x3f0e0000,0x3f7b3f6d,0x3f6d3f0e,0x3f353f7b
.long 0xbf6dbf80,0xbec4bf35,0xbf35bf6d,0xbec4,0xbe480000,0xbf0ebec4,0xbec4be48,0xbf35bf0e
.long 0xbf803f80,0xbf803f80,0x3f80bf80,0x3f80bf80,0x3f55bf35,0x3f7bbf6d,0xbf6d3f55,0xbf803f7b
.long 0xbec40000,0xbf6d3f35,0x3f35bec4,0x3f80bf6d,0xbe483f35,0x3f55bec4,0xbec4be48,0xbf803f55
.long 0x3f35bf80,0xbf350000,0x3f35,0x3f80bf35,0xbf7b3f35,0x3f0e3ec4,0x3ec4bf7b,0xbf803f0e
.long 0x3f6d0000,0xbec4bf35,0xbf353f6d,0x3f80bec4,0xbf0ebf35,0x3e483f6d,0x3f6dbf0e,0xbf803e48
.long 0x3f80,0xbf80,0xbf800000,0x3f800000,0x3f0ebf35,0xbe483f6d,0x3f6d3f0e,0xbf80be48
.long 0xbf6d0000,0x3ec4bf35,0xbf35bf6d,0x3f803ec4,0x3f7b3f35,0xbf0e3ec4,0x3ec43f7b,0xbf80bf0e
.long 0xbf35bf80,0x3f350000,0xbf35,0x3f803f35,0x3e483f35,0xbf55bec4,0xbec43e48,0xbf80bf55
.long 0x3ec40000,0x3f6d3f35,0x3f353ec4,0x3f803f6d,0xbf55bf35,0xbf7bbf6d,0xbf6dbf55,0xbf80bf7b
.long 0x0,0x0,0x0,0x0,0xbe480000,0xbf0e3ec4,0xbec43e48,0xbf353f0e
.long 0xbec40000,0xbf6d3f35,0xbf353ec4,0xbf803f6d,0xbf0e0000,0xbf7b3f6d,0xbf6d3f0e,0xbf353f7b
.long 0xbf350000,0xbf353f80,0xbf803f35,0x3f35,0xbf550000,0xbe483f6d,0xbf6d3f55,0x3f353e48
.long 0xbf6d0000,0x3ec43f35,0xbf353f6d,0x3f80bec4,0xbf7b0000,0x3f553ec4,0xbec43f7b,0x3f35bf55
.long 0xbf800000,0x3f800000,0x3f80,0xbf80,0xbf7b0000,0x3f55bec4,0x3ec43f7b,0xbf35bf55
.long 0xbf6d0000,0x3ec4bf35,0x3f353f6d,0xbf80bec4,0xbf550000,0xbe48bf6d,0x3f6d3f55,0xbf353e48
.long 0xbf350000,0xbf35bf80,0x3f803f35,0x3f35,0xbf0e0000,0xbf7bbf6d,0x3f6d3f0e,0x3f353f7b
.long 0xbec40000,0xbf6dbf35,0x3f353ec4,0x3f803f6d,0xbe480000,0xbf0ebec4,0x3ec43e48,0x3f353f0e
.long 0x0,0x0,0x0,0x0,0xbf553f35,0xbf7b3f6d,0xbf6d3f55,0xbf803f7b
.long 0xbf6d3f80,0xbec43f35,0xbf353f6d,0x3ec4,0xbe483f35,0x3f55bec4,0x3ec43e48,0x3f80bf55
.long 0x3f350000,0x3f35bf80,0x3f80bf35,0xbf35,0x3f7bbf35,0xbf0ebec4,0x3ec4bf7b,0xbf803f0e
.long 0x3ec4bf80,0xbf6d3f35,0xbf35bec4,0x3f6d,0xbf0ebf35,0x3e483f6d,0xbf6d3f0e,0x3f80be48
.long 0xbf800000,0x3f800000,0x3f80,0xbf80,0xbf0e3f35,0x3e48bf6d,0x3f6d3f0e,0xbf80be48
.long 0x3ec43f80,0xbf6dbf35,0x3f35bec4,0x3f6d,0x3f7b3f35,0xbf0e3ec4,0xbec4bf7b,0x3f803f0e
.long 0x3f350000,0x3f353f80,0xbf80bf35,0xbf35,0xbe48bf35,0x3f553ec4,0xbec43e48,0xbf80bf55
.long 0xbf6dbf80,0xbec4bf35,0x3f353f6d,0x3ec4,0xbf55bf35,0xbf7bbf6d,0x3f6d3f55,0x3f803f7b
.long 0x0,0x0,0x0,0x0,0xbf7b3f80,0xbf553f6d,0xbf6d3f7b,0xbf353f55
.long 0x3ec40000,0x3f6dbf35,0x3f35bec4,0x3f80bf6d,0x3f55bf80,0xbe48bec4,0x3ec4bf55,0xbf353e48
.long 0xbf350000,0xbf353f80,0xbf803f35,0x3f35,0xbf0e3f80,0x3f7bbec4,0x3ec43f0e,0x3f35bf7b
.long 0x3f6d0000,0xbec4bf35,0x3f35bf6d,0xbf803ec4,0x3e48bf80,0xbf0e3f6d,0xbf6dbe48,0x3f353f0e
.long 0xbf800000,0x3f800000,0x3f80,0xbf80,0x3e483f80,0xbf0ebf6d,0x3f6dbe48,0xbf353f0e
.long 0x3f6d0000,0xbec43f35,0xbf35bf6d,0x3f803ec4,0xbf0ebf80,0x3f7b3ec4,0xbec43f0e,0xbf35bf7b
.long 0xbf350000,0xbf35bf80,0x3f803f35,0x3f35,0x3f553f80,0xbe483ec4,0xbec4bf55,0x3f353e48
.long 0x3ec40000,0x3f6d3f35,0xbf35bec4,0xbf80bf6d,0xbf7bbf80,0xbf55bf6d,0x3f6d3f7b,0x3f353f55
.long 0x0,0x0,0x0,0x0,0xbf0e3f35,0xbe483ec4,0xbec43f0e,0x3e48
.long 0x3f6dbf80,0x3ec4bf35,0x3f35bf6d,0xbec4,0xbf7b3f35,0xbf0e3f6d,0xbf6d3f7b,0x3f0e
.long 0x3f350000,0x3f35bf80,0x3f80bf35,0xbf35,0xbe48bf35,0xbf553f6d,0xbf6d3e48,0x3f55
.long 0xbec43f80,0x3f6dbf35,0x3f353ec4,0xbf6d,0x3f55bf35,0xbf7b3ec4,0xbec4bf55,0x3f7b
.long 0xbf800000,0x3f800000,0x3f80,0xbf80,0x3f553f35,0xbf7bbec4,0x3ec4bf55,0x3f7b
.long 0xbec4bf80,0x3f6d3f35,0xbf353ec4,0xbf6d,0xbe483f35,0xbf55bf6d,0x3f6d3e48,0x3f55
.long 0x3f350000,0x3f353f80,0xbf80bf35,0xbf35,0xbf7bbf35,0xbf0ebf6d,0x3f6d3f7b,0x3f0e
.long 0x3f6d3f80,0x3ec43f35,0xbf35bf6d,0xbec4,0xbf0ebf35,0xbe48bec4,0x3ec43f0e,0x3e48
.long 0x40003f80,0x40004000,0x0,0x0,0x3ffb3f80,0x3fd53fed,0x0,0x0
.long 0x3fed3f80,0x3f443fb5,0x0,0x0,0x3fd53f80,0xbec83f44,0x0,0x0
.long 0x3fb53f80,0xbfb50000,0x0,0x0,0x3f8e3f80,0xbffbbf44,0x0,0x0
.long 0x3f443f80,0xbfedbfb5,0x0,0x0,0x3ec83f80,0xbf8ebfed,0x0,0x0
.long 0x3f80,0xc000,0x0,0x0,0xbec83f80,0x3f8ebfed,0x0,0x0
.long 0xbf443f80,0x3fedbfb5,0x0,0x0,0xbf8e3f80,0x3ffbbf44,0x0,0x0
.long 0xbfb53f80,0x3fb50000,0x0,0x0,0xbfd53f80,0x3ec83f44,0x0,0x0
.long 0xbfed3f80,0xbf443fb5,0x0,0x0,0xbffb3f80,0xbfd53fed,0x0,0x0
.long 0x40004000,0x40004000,0x0,0x0,0x3f8e3fb5,0x3ec83f44,0x0,0x0
.long 0xbf440000,0xbfedbfb5,0x0,0x0,0xbffbbfb5,0xbf8ebfed,0x0,0x0
.long 0xbfb5c000,0x3fb50000,0x0,0x0,0x3ec8bfb5,0x3fd53fed,0x0,0x0
.long 0x3fed0000,0xbf443fb5,0x0,0x0,0x3fd53fb5,0xbffbbf44,0x0,0x0
.long 0x4000,0xc000,0x0,0x0,0xbfd53fb5,0x3ffbbf44,0x0,0x0
.long 0xbfed0000,0x3f443fb5,0x0,0x0,0xbec8bfb5,0xbfd53fed,0x0,0x0
.long 0x3fb5c000,0xbfb50000,0x0,0x0,0x3ffbbfb5,0x3f8ebfed,0x0,0x0
.long 0x3f440000,0x3fedbfb5,0x0,0x0,0xbf8e3fb5,0xbec83f44,0x0,0x0
.long 0x40004000,0x40004000,0x0,0x0,0xbec80000,0xbf8ebf44,0x0,0x0
.long 0xbfedc000,0xbf44bfb5,0x0,0x0,0x3f8e0000,0x3ffb3fed,0x0,0x0
.long 0x3fb54000,0xbfb50000,0x0,0x0,0xbfd50000,0xbec8bfed,0x0,0x0
.long 0xbf44c000,0x3fed3fb5,0x0,0x0,0x3ffb0000,0xbfd53f44,0x0,0x0
.long 0x4000,0xc000,0x0,0x0,0xbffb0000,0x3fd53f44,0x0,0x0
.long 0x3f44c000,0xbfed3fb5,0x0,0x0,0x3fd50000,0x3ec8bfed,0x0,0x0
.long 0xbfb54000,0x3fb50000,0x0,0x0,0xbf8e0000,0xbffb3fed,0x0,0x0
.long 0x3fedc000,0x3f44bfb5,0x0,0x0,0x3ec80000,0x3f8ebf44,0x0,0x0
.long 0x40004000,0x40004000,0x0,0x0,0xbfd5bfb5,0xbffbbfed,0x0,0x0
.long 0x3f440000,0x3fed3fb5,0x0,0x0,0x3ec83fb5,0xbfd5bf44,0x0,0x0
.long 0xbfb5c000,0x3fb50000,0x0,0x0,0x3ffb3fb5,0xbf8e3f44,0x0,0x0
.long 0xbfed0000,0x3f44bfb5,0x0,0x0,0x3f8ebfb5,0xbec83fed,0x0,0x0
.long 0x4000,0xc000,0x0,0x0,0xbf8ebfb5,0x3ec83fed,0x0,0x0
.long 0x3fed0000,0xbf44bfb5,0x0,0x0,0xbffb3fb5,0x3f8e3f44,0x0,0x0
.long 0x3fb5c000,0xbfb50000,0x0,0x0,0xbec83fb5,0x3fd5bf44,0x0,0x0
.long 0xbf440000,0xbfed3fb5,0x0,0x0,0x3fd5bfb5,0x3ffbbfed,0x0,0x0
.long 0x3f80,0x0,0x0,0x0,0xbec8bf80,0xbf8ebf44,0x0,0x0
.long 0xbf443f80,0xbfedbfb5,0x0,0x0,0xbf8ebf80,0xbffbbfed,0x0,0x0
.long 0xbfb53f80,0xbfb5c000,0x0,0x0,0xbfd5bf80,0xbec8bfed,0x0,0x0
.long 0xbfed3f80,0x3f44bfb5,0x0,0x0,0xbffbbf80,0x3fd5bf44,0x0,0x0
.long 0xc0003f80,0x40000000,0x0,0x0,0xbffbbf80,0x3fd53f44,0x0,0x0
.long 0xbfed3f80,0x3f443fb5,0x0,0x0,0xbfd5bf80,0xbec83fed,0x0,0x0
.long 0xbfb53f80,0xbfb54000,0x0,0x0,0xbf8ebf80,0xbffb3fed,0x0,0x0
.long 0xbf443f80,0xbfed3fb5,0x0,0x0,0xbec8bf80,0xbf8e3f44,0x0,0x0
.long 0x0,0x0,0x0,0x0,0xbfd5bfb5,0xbffbbfed,0x0,0x0
.long 0xbfedc000,0xbf44bfb5,0x0,0x0,0xbec8bfb5,0x3fd53f44,0x0,0x0
.long 0x3fb50000,0x3fb54000,0x0,0x0,0x3ffb3fb5,0xbf8e3f44,0x0,0x0
.long 0x3f444000,0xbfedbfb5,0x0,0x0,0xbf8e3fb5,0x3ec8bfed,0x0,0x0
.long 0xc0000000,0x40000000,0x0,0x0,0xbf8ebfb5,0x3ec83fed,0x0,0x0
.long 0x3f44c000,0xbfed3fb5,0x0,0x0,0x3ffbbfb5,0xbf8ebf44,0x0,0x0
.long 0x3fb50000,0x3fb5c000,0x0,0x0,0xbec83fb5,0x3fd5bf44,0x0,0x0
.long 0xbfed4000,0xbf443fb5,0x0,0x0,0xbfd53fb5,0xbffb3fed,0x0,0x0
.long 0x0,0x0,0x0,0x0,0xbffbc000,0xbfd5bfed,0x0,0x0
.long 0x3f440000,0x3fed3fb5,0x0,0x0,0x3fd54000,0xbec83f44,0x0,0x0
.long 0xbfb50000,0xbfb5c000,0x0,0x0,0xbf8ec000,0x3ffb3f44,0x0,0x0
.long 0x3fed0000,0xbf443fb5,0x0,0x0,0x3ec84000,0xbf8ebfed,0x0,0x0
.long 0xc0000000,0x40000000,0x0,0x0,0x3ec8c000,0xbf8e3fed,0x0,0x0
.long 0x3fed0000,0xbf44bfb5,0x0,0x0,0xbf8e4000,0x3ffbbf44,0x0,0x0
.long 0xbfb50000,0xbfb54000,0x0,0x0,0x3fd5c000,0xbec8bf44,0x0,0x0
.long 0x3f440000,0x3fedbfb5,0x0,0x0,0xbffb4000,0xbfd53fed,0x0,0x0
.long 0x0,0x0,0x0,0x0,0xbf8ebfb5,0xbec8bf44,0x0,0x0
.long 0x3fed4000,0x3f443fb5,0x0,0x0,0xbffbbfb5,0xbf8ebfed,0x0,0x0
.long 0x3fb50000,0x3fb54000,0x0,0x0,0xbec83fb5,0xbfd5bfed,0x0,0x0
.long 0xbf44c000,0x3fed3fb5,0x0,0x0,0x3fd53fb5,0xbffbbf44,0x0,0x0
.long 0xc0000000,0x40000000,0x0,0x0,0x3fd5bfb5,0xbffb3f44,0x0,0x0
.long 0xbf444000,0x3fedbfb5,0x0,0x0,0xbec8bfb5,0xbfd53fed,0x0,0x0
.long 0x3fb50000,0x3fb5c000,0x0,0x0,0xbffb3fb5,0xbf8e3fed,0x0,0x0
.long 0x3fedc000,0x3f44bfb5,0x0,0x0,0xbf8e3fb5,0xbec83f44,0x0,0x0
.long 0x0,0x0,0x40004000,0x40004000,0x0,0x0,0x3ff53fff,0x3fc63fe2
.long 0x0,0x0,0x3fd53ffb,0x3ec83f8e,0x0,0x0,0x3fa23ff5,0xbf713e49
.long 0x0,0x0,0x3f443fed,0xbfedbf44,0x0,0x0,0x3e493fe2,0xbff5bfc6
.long 0x0,0x0,0xbec83fd5,0xbf8ebffb,0x0,0x0,0xbf713fc6,0x3e49bff5
.long 0x0,0x0,0xbfb53fb5,0x3fb5bfb5,0x0,0x0,0xbfe23fa2,0x3fffbf15
.long 0x0,0x0,0xbffb3f8e,0x3fd53ec8,0x0,0x0,0xbfff3f71,0x3f153fa2
.long 0x0,0x0,0xbfed3f44,0xbf443fed,0x0,0x0,0xbfc63f15,0xbfe23fff
.long 0x0,0x0,0xbf8e3ec8,0xbffb3fd5,0x0,0x0,0xbf153e49,0xbfa23f71
.long 0x0,0x0,0x40004000,0x40004000,0x0,0x0,0x3f713fa2,0x3e493f15
.long 0x0,0x0,0xbf8ebec8,0xbffbbfd5,0x0,0x0,0xbfffbfe2,0xbf15bfc6
.long 0x0,0x0,0xbf44bfed,0x3fed3f44,0x0,0x0,0x3fa2bf15,0x3f713fff
.long 0x0,0x0,0x3ffb3f8e,0xbfd53ec8,0x0,0x0,0x3f153fff,0xbfa2bfe2
.long 0x0,0x0,0xbfb53fb5,0x3fb5bfb5,0x0,0x0,0xbff5be49,0x3fc63f71
.long 0x0,0x0,0xbec8bfd5,0xbf8e3ffb,0x0,0x0,0x3fc6bff5,0xbfe23e49
.long 0x0,0x0,0x3fedbf44,0x3f44bfed,0x0,0x0,0x3e493f71,0x3ff5bfa2
.long 0x0,0x0,0xbfd53ffb,0xbec83f8e,0x0,0x0,0xbfe23fc6,0xbfff3ff5
.long 0x0,0x0,0x40004000,0x40004000,0x0,0x0,0xbf15be49,0xbfa2bf71
.long 0x0,0x0,0xbfd5bffb,0xbec8bf8e,0x0,0x0,0x3fc63f15,0x3fe23fff
.long 0x0,0x0,0x3f443fed,0xbfedbf44,0x0,0x0,0xbfffbf71,0x3f15bfa2
.long 0x0,0x0,0x3ec8bfd5,0x3f8e3ffb,0x0,0x0,0x3fe23fa2,0xbfffbf15
.long 0x0,0x0,0xbfb53fb5,0x3fb5bfb5,0x0,0x0,0xbf71bfc6,0x3e493ff5
.long 0x0,0x0,0x3ffbbf8e,0xbfd5bec8,0x0,0x0,0xbe493fe2,0x3ff5bfc6
.long 0x0,0x0,0xbfed3f44,0xbf443fed,0x0,0x0,0x3fa2bff5,0xbf71be49
.long 0x0,0x0,0x3f8ebec8,0x3ffbbfd5,0x0,0x0,0xbff53fff,0xbfc63fe2
.long 0x0,0x0,0x40004000,0x40004000,0x0,0x0,0xbfe2bfc6,0xbfffbff5
.long 0x0,0x0,0x3f8e3ec8,0x3ffb3fd5,0x0,0x0,0xbe493f71,0xbff5bfa2
.long 0x0,0x0,0xbf44bfed,0x3fed3f44,0x0,0x0,0x3fc63ff5,0xbfe2be49
.long 0x0,0x0,0xbffbbf8e,0x3fd5bec8,0x0,0x0,0x3ff5be49,0xbfc63f71
.long 0x0,0x0,0xbfb53fb5,0x3fb5bfb5,0x0,0x0,0x3f15bfff,0xbfa23fe2
.long 0x0,0x0,0x3ec83fd5,0x3f8ebffb,0x0,0x0,0xbfa2bf15,0xbf713fff
.long 0x0,0x0,0x3fedbf44,0x3f44bfed,0x0,0x0,0xbfff3fe2,0xbf153fc6
.long 0x0,0x0,0x3fd5bffb,0x3ec8bf8e,0x0,0x0,0xbf713fa2,0xbe493f15
.long 0x0,0x0,0x0,0x0,0x0,0x0,0xbf15be49,0xbfa2bf71
.long 0x0,0x0,0xbf8ebec8,0xbffbbfd5,0x0,0x0,0xbfc6bf15,0xbfe2bfff
.long 0x0,0x0,0xbfedbf44,0xbf44bfed,0x0,0x0,0xbfffbf71,0x3f15bfa2
.long 0x0,0x0,0xbffbbf8e,0x3fd5bec8,0x0,0x0,0xbfe2bfa2,0x3fff3f15
.long 0x0,0x0,0xbfb5bfb5,0x3fb53fb5,0x0,0x0,0xbf71bfc6,0x3e493ff5
.long 0x0,0x0,0xbec8bfd5,0xbf8e3ffb,0x0,0x0,0x3e49bfe2,0xbff53fc6
.long 0x0,0x0,0x3f44bfed,0xbfed3f44,0x0,0x0,0x3fa2bff5,0xbf71be49
.long 0x0,0x0,0x3fd5bffb,0x3ec8bf8e,0x0,0x0,0x3ff5bfff,0x3fc6bfe2
.long 0x0,0x0,0x0,0x0,0x0,0x0,0xbfe2bfc6,0xbfffbff5
.long 0x0,0x0,0xbfd5bffb,0xbec8bf8e,0x0,0x0,0x3e49bf71,0x3ff53fa2
.long 0x0,0x0,0x3fed3f44,0x3f443fed,0x0,0x0,0x3fc63ff5,0xbfe2be49
.long 0x0,0x0,0xbec83fd5,0xbf8ebffb,0x0,0x0,0xbff53e49,0x3fc6bf71
.long 0x0,0x0,0xbfb5bfb5,0x3fb53fb5,0x0,0x0,0x3f15bfff,0xbfa23fe2
.long 0x0,0x0,0x3ffbbf8e,0xbfd5bec8,0x0,0x0,0x3fa23f15,0x3f71bfff
.long 0x0,0x0,0xbf443fed,0x3fedbf44,0x0,0x0,0xbfff3fe2,0xbf153fc6
.long 0x0,0x0,0xbf8e3ec8,0xbffb3fd5,0x0,0x0,0x3f71bfa2,0x3e49bf15
.long 0x0,0x0,0x0,0x0,0x0,0x0,0xbff5bfff,0xbfc6bfe2
.long 0x0,0x0,0x3f8e3ec8,0x3ffb3fd5,0x0,0x0,0x3fa23ff5,0xbf713e49
.long 0x0,0x0,0xbfedbf44,0xbf44bfed,0x0,0x0,0xbe49bfe2,0x3ff53fc6
.long 0x0,0x0,0x3ffb3f8e,0xbfd53ec8,0x0,0x0,0xbf713fc6,0x3e49bff5
.long 0x0,0x0,0xbfb5bfb5,0x3fb53fb5,0x0,0x0,0x3fe2bfa2,0xbfff3f15
.long 0x0,0x0,0x3ec83fd5,0x3f8ebffb,0x0,0x0,0xbfff3f71,0x3f153fa2
.long 0x0,0x0,0x3f44bfed,0xbfed3f44,0x0,0x0,0x3fc6bf15,0x3fe2bfff
.long 0x0,0x0,0xbfd53ffb,0xbec83f8e,0x0,0x0,0xbf153e49,0xbfa23f71
.long 0x0,0x0,0x0,0x0,0x0,0x0,0xbf71bfa2,0xbe49bf15
.long 0x0,0x0,0x3fd53ffb,0x3ec83f8e,0x0,0x0,0xbfffbfe2,0xbf15bfc6
.long 0x0,0x0,0x3fed3f44,0x3f443fed,0x0,0x0,0xbfa23f15,0xbf71bfff
.long 0x0,0x0,0x3ec8bfd5,0x3f8e3ffb,0x0,0x0,0x3f153fff,0xbfa2bfe2
.long 0x0,0x0,0xbfb5bfb5,0x3fb53fb5,0x0,0x0,0x3ff53e49,0xbfc6bf71
.long 0x0,0x0,0xbffb3f8e,0x3fd53ec8,0x0,0x0,0x3fc6bff5,0xbfe23e49
.long 0x0,0x0,0xbf443fed,0x3fedbf44,0x0,0x0,0xbe49bf71,0xbff53fa2
.long 0x0,0x0,0x3f8ebec8,0x3ffbbfd5,0x0,0x0,0xbfe23fc6,0xbfff3ff5
.long 0xc0003f80,0xc0004000,0x0,0x0,0xbffb3f80,0xbfd53fed,0x0,0x0
.long 0xbfed3f80,0xbf443fb5,0x0,0x0,0xbfd53f80,0x3ec83f44,0x0,0x0
.long 0xbfb53f80,0x3fb50000,0x0,0x0,0xbf8e3f80,0x3ffbbf44,0x0,0x0
.long 0xbf443f80,0x3fedbfb5,0x0,0x0,0xbec83f80,0x3f8ebfed,0x0,0x0
.long 0x3f80,0xc000,0x0,0x0,0x3ec83f80,0xbf8ebfed,0x0,0x0
.long 0x3f443f80,0xbfedbfb5,0x0,0x0,0x3f8e3f80,0xbffbbf44,0x0,0x0
.long 0x3fb53f80,0xbfb50000,0x0,0x0,0x3fd53f80,0xbec83f44,0x0,0x0
.long 0x3fed3f80,0x3f443fb5,0x0,0x0,0x3ffb3f80,0x3fd53fed,0x0,0x0
.long 0xc0004000,0xc0004000,0x0,0x0,0xbf8e3fb5,0xbec83f44,0x0,0x0
.long 0x3f440000,0x3fedbfb5,0x0,0x0,0x3ffbbfb5,0x3f8ebfed,0x0,0x0
.long 0x3fb5c000,0xbfb50000,0x0,0x0,0xbec8bfb5,0xbfd53fed,0x0,0x0
.long 0xbfed0000,0x3f443fb5,0x0,0x0,0xbfd53fb5,0x3ffbbf44,0x0,0x0
.long 0x4000,0xc000,0x0,0x0,0x3fd53fb5,0xbffbbf44,0x0,0x0
.long 0x3fed0000,0xbf443fb5,0x0,0x0,0x3ec8bfb5,0x3fd53fed,0x0,0x0
.long 0xbfb5c000,0x3fb50000,0x0,0x0,0xbffbbfb5,0xbf8ebfed,0x0,0x0
.long 0xbf440000,0xbfedbfb5,0x0,0x0,0x3f8e3fb5,0x3ec83f44,0x0,0x0
.long 0xc0004000,0xc0004000,0x0,0x0,0x3ec80000,0x3f8ebf44,0x0,0x0
.long 0x3fedc000,0x3f44bfb5,0x0,0x0,0xbf8e0000,0xbffb3fed,0x0,0x0
.long 0xbfb54000,0x3fb50000,0x0,0x0,0x3fd50000,0x3ec8bfed,0x0,0x0
.long 0x3f44c000,0xbfed3fb5,0x0,0x0,0xbffb0000,0x3fd53f44,0x0,0x0
.long 0x4000,0xc000,0x0,0x0,0x3ffb0000,0xbfd53f44,0x0,0x0
.long 0xbf44c000,0x3fed3fb5,0x0,0x0,0xbfd50000,0xbec8bfed,0x0,0x0
.long 0x3fb54000,0xbfb50000,0x0,0x0,0x3f8e0000,0x3ffb3fed,0x0,0x0
.long 0xbfedc000,0xbf44bfb5,0x0,0x0,0xbec80000,0xbf8ebf44,0x0,0x0
.long 0xc0004000,0xc0004000,0x0,0x0,0x3fd5bfb5,0x3ffbbfed,0x0,0x0
.long 0xbf440000,0xbfed3fb5,0x0,0x0,0xbec83fb5,0x3fd5bf44,0x0,0x0
.long 0x3fb5c000,0xbfb50000,0x0,0x0,0xbffb3fb5,0x3f8e3f44,0x0,0x0
.long 0x3fed0000,0xbf44bfb5,0x0,0x0,0xbf8ebfb5,0x3ec83fed,0x0,0x0
.long 0x4000,0xc000,0x0,0x0,0x3f8ebfb5,0xbec83fed,0x0,0x0
.long 0xbfed0000,0x3f44bfb5,0x0,0x0,0x3ffb3fb5,0xbf8e3f44,0x0,0x0
.long 0xbfb5c000,0x3fb50000,0x0,0x0,0x3ec83fb5,0xbfd5bf44,0x0,0x0
.long 0x3f440000,0x3fed3fb5,0x0,0x0,0xbfd5bfb5,0xbffbbfed,0x0,0x0
.long 0x3f80,0x0,0x0,0x0,0x3ec8bf80,0x3f8ebf44,0x0,0x0
.long 0x3f443f80,0x3fedbfb5,0x0,0x0,0x3f8ebf80,0x3ffbbfed,0x0,0x0
.long 0x3fb53f80,0x3fb5c000,0x0,0x0,0x3fd5bf80,0x3ec8bfed,0x0,0x0
.long 0x3fed3f80,0xbf44bfb5,0x0,0x0,0x3ffbbf80,0xbfd5bf44,0x0,0x0
.long 0x40003f80,0xc0000000,0x0,0x0,0x3ffbbf80,0xbfd53f44,0x0,0x0
.long 0x3fed3f80,0xbf443fb5,0x0,0x0,0x3fd5bf80,0x3ec83fed,0x0,0x0
.long 0x3fb53f80,0x3fb54000,0x0,0x0,0x3f8ebf80,0x3ffb3fed,0x0,0x0
.long 0x3f443f80,0x3fed3fb5,0x0,0x0,0x3ec8bf80,0x3f8e3f44,0x0,0x0
.long 0x0,0x0,0x0,0x0,0x3fd5bfb5,0x3ffbbfed,0x0,0x0
.long 0x3fedc000,0x3f44bfb5,0x0,0x0,0x3ec8bfb5,0xbfd53f44,0x0,0x0
.long 0xbfb50000,0xbfb54000,0x0,0x0,0xbffb3fb5,0x3f8e3f44,0x0,0x0
.long 0xbf444000,0x3fedbfb5,0x0,0x0,0x3f8e3fb5,0xbec8bfed,0x0,0x0
.long 0x40000000,0xc0000000,0x0,0x0,0x3f8ebfb5,0xbec83fed,0x0,0x0
.long 0xbf44c000,0x3fed3fb5,0x0,0x0,0xbffbbfb5,0x3f8ebf44,0x0,0x0
.long 0xbfb50000,0xbfb5c000,0x0,0x0,0x3ec83fb5,0xbfd5bf44,0x0,0x0
.long 0x3fed4000,0x3f443fb5,0x0,0x0,0x3fd53fb5,0x3ffb3fed,0x0,0x0
.long 0x0,0x0,0x0,0x0,0x3ffbc000,0x3fd5bfed,0x0,0x0
.long 0xbf440000,0xbfed3fb5,0x0,0x0,0xbfd54000,0x3ec83f44,0x0,0x0
.long 0x3fb50000,0x3fb5c000,0x0,0x0,0x3f8ec000,0xbffb3f44,0x0,0x0
.long 0xbfed0000,0x3f443fb5,0x0,0x0,0xbec84000,0x3f8ebfed,0x0,0x0
.long 0x40000000,0xc0000000,0x0,0x0,0xbec8c000,0x3f8e3fed,0x0,0x0
.long 0xbfed0000,0x3f44bfb5,0x0,0x0,0x3f8e4000,0xbffbbf44,0x0,0x0
.long 0x3fb50000,0x3fb54000,0x0,0x0,0xbfd5c000,0x3ec8bf44,0x0,0x0
.long 0xbf440000,0xbfedbfb5,0x0,0x0,0x3ffb4000,0x3fd53fed,0x0,0x0
.long 0x0,0x0,0x0,0x0,0x3f8ebfb5,0x3ec8bf44,0x0,0x0
.long 0xbfed4000,0xbf443fb5,0x0,0x0,0x3ffbbfb5,0x3f8ebfed,0x0,0x0
.long 0xbfb50000,0xbfb54000,0x0,0x0,0x3ec83fb5,0x3fd5bfed,0x0,0x0
.long 0x3f44c000,0xbfed3fb5,0x0,0x0,0xbfd53fb5,0x3ffbbf44,0x0,0x0
.long 0x40000000,0xc0000000,0x0,0x0,0xbfd5bfb5,0x3ffb3f44,0x0,0x0
.long 0x3f444000,0xbfedbfb5,0x0,0x0,0x3ec8bfb5,0x3fd53fed,0x0,0x0
.long 0xbfb50000,0xbfb5c000,0x0,0x0,0x3ffb3fb5,0x3f8e3fed,0x0,0x0
.long 0xbfedc000,0xbf44bfb5,0x0,0x0,0x3f8e3fb5,0x3ec83f44,0x0,0x0
.long 0x0,0x0,0x0,0x0,0x0,0x0,0x3f15be49,0x3fa2bf71
.long 0x0,0x0,0x3f8ebec8,0x3ffbbfd5,0x0,0x0,0x3fc6bf15,0x3fe2bfff
.long 0x0,0x0,0x3fedbf44,0x3f44bfed,0x0,0x0,0x3fffbf71,0xbf15bfa2
.long 0x0,0x0,0x3ffbbf8e,0xbfd5bec8,0x0,0x0,0x3fe2bfa2,0xbfff3f15
.long 0x0,0x0,0x3fb5bfb5,0xbfb53fb5,0x0,0x0,0x3f71bfc6,0xbe493ff5
.long 0x0,0x0,0x3ec8bfd5,0x3f8e3ffb,0x0,0x0,0xbe49bfe2,0x3ff53fc6
.long 0x0,0x0,0xbf44bfed,0x3fed3f44,0x0,0x0,0xbfa2bff5,0x3f71be49
.long 0x0,0x0,0xbfd5bffb,0xbec8bf8e,0x0,0x0,0xbff5bfff,0xbfc6bfe2
.long 0x0,0x0,0x0,0x0,0x0,0x0,0x3fe2bfc6,0x3fffbff5
.long 0x0,0x0,0x3fd5bffb,0x3ec8bf8e,0x0,0x0,0xbe49bf71,0xbff53fa2
.long 0x0,0x0,0xbfed3f44,0xbf443fed,0x0,0x0,0xbfc63ff5,0x3fe2be49
.long 0x0,0x0,0x3ec83fd5,0x3f8ebffb,0x0,0x0,0x3ff53e49,0xbfc6bf71
.long 0x0,0x0,0x3fb5bfb5,0xbfb53fb5,0x0,0x0,0xbf15bfff,0x3fa23fe2
.long 0x0,0x0,0xbffbbf8e,0x3fd5bec8,0x0,0x0,0xbfa23f15,0xbf71bfff
.long 0x0,0x0,0x3f443fed,0xbfedbf44,0x0,0x0,0x3fff3fe2,0x3f153fc6
.long 0x0,0x0,0x3f8e3ec8,0x3ffb3fd5,0x0,0x0,0xbf71bfa2,0xbe49bf15
.long 0x0,0x0,0x0,0x0,0x0,0x0,0x3ff5bfff,0x3fc6bfe2
.long 0x0,0x0,0xbf8e3ec8,0xbffb3fd5,0x0,0x0,0xbfa23ff5,0x3f713e49
.long 0x0,0x0,0x3fedbf44,0x3f44bfed,0x0,0x0,0x3e49bfe2,0xbff53fc6
.long 0x0,0x0,0xbffb3f8e,0x3fd53ec8,0x0,0x0,0x3f713fc6,0xbe49bff5
.long 0x0,0x0,0x3fb5bfb5,0xbfb53fb5,0x0,0x0,0xbfe2bfa2,0x3fff3f15
.long 0x0,0x0,0xbec83fd5,0xbf8ebffb,0x0,0x0,0x3fff3f71,0xbf153fa2
.long 0x0,0x0,0xbf44bfed,0x3fed3f44,0x0,0x0,0xbfc6bf15,0xbfe2bfff
.long 0x0,0x0,0x3fd53ffb,0x3ec83f8e,0x0,0x0,0x3f153e49,0x3fa23f71
.long 0x0,0x0,0x0,0x0,0x0,0x0,0x3f71bfa2,0x3e49bf15
.long 0x0,0x0,0xbfd53ffb,0xbec83f8e,0x0,0x0,0x3fffbfe2,0x3f15bfc6
.long 0x0,0x0,0xbfed3f44,0xbf443fed,0x0,0x0,0x3fa23f15,0x3f71bfff
.long 0x0,0x0,0xbec8bfd5,0xbf8e3ffb,0x0,0x0,0xbf153fff,0x3fa2bfe2
.long 0x0,0x0,0x3fb5bfb5,0xbfb53fb5,0x0,0x0,0xbff53e49,0x3fc6bf71
.long 0x0,0x0,0x3ffb3f8e,0xbfd53ec8,0x0,0x0,0xbfc6bff5,0x3fe23e49
.long 0x0,0x0,0x3f443fed,0xbfedbf44,0x0,0x0,0x3e49bf71,0x3ff53fa2
.long 0x0,0x0,0xbf8ebec8,0xbffbbfd5,0x0,0x0,0x3fe23fc6,0x3fff3ff5
.long 0x0,0x0,0x4000c000,0x4000c000,0x0,0x0,0x3ff5bfff,0x3fc6bfe2
.long 0x0,0x0,0x3fd5bffb,0x3ec8bf8e,0x0,0x0,0x3fa2bff5,0xbf71be49
.long 0x0,0x0,0x3f44bfed,0xbfed3f44,0x0,0x0,0x3e49bfe2,0xbff53fc6
.long 0x0,0x0,0xbec8bfd5,0xbf8e3ffb,0x0,0x0,0xbf71bfc6,0x3e493ff5
.long 0x0,0x0,0xbfb5bfb5,0x3fb53fb5,0x0,0x0,0xbfe2bfa2,0x3fff3f15
.long 0x0,0x0,0xbffbbf8e,0x3fd5bec8,0x0,0x0,0xbfffbf71,0x3f15bfa2
.long 0x0,0x0,0xbfedbf44,0xbf44bfed,0x0,0x0,0xbfc6bf15,0xbfe2bfff
.long 0x0,0x0,0xbf8ebec8,0xbffbbfd5,0x0,0x0,0xbf15be49,0xbfa2bf71
.long 0x0,0x0,0x4000c000,0x4000c000,0x0,0x0,0x3f71bfa2,0x3e49bf15
.long 0x0,0x0,0xbf8e3ec8,0xbffb3fd5,0x0,0x0,0xbfff3fe2,0xbf153fc6
.long 0x0,0x0,0xbf443fed,0x3fedbf44,0x0,0x0,0x3fa23f15,0x3f71bfff
.long 0x0,0x0,0x3ffbbf8e,0xbfd5bec8,0x0,0x0,0x3f15bfff,0xbfa23fe2
.long 0x0,0x0,0xbfb5bfb5,0x3fb53fb5,0x0,0x0,0xbff53e49,0x3fc6bf71
.long 0x0,0x0,0xbec83fd5,0xbf8ebffb,0x0,0x0,0x3fc63ff5,0xbfe2be49
.long 0x0,0x0,0x3fed3f44,0x3f443fed,0x0,0x0,0x3e49bf71,0x3ff53fa2
.long 0x0,0x0,0xbfd5bffb,0xbec8bf8e,0x0,0x0,0xbfe2bfc6,0xbfffbff5
.long 0x0,0x0,0x4000c000,0x4000c000,0x0,0x0,0xbf153e49,0xbfa23f71
.long 0x0,0x0,0xbfd53ffb,0xbec83f8e,0x0,0x0,0x3fc6bf15,0x3fe2bfff
.long 0x0,0x0,0x3f44bfed,0xbfed3f44,0x0,0x0,0xbfff3f71,0x3f153fa2
.long 0x0,0x0,0x3ec83fd5,0x3f8ebffb,0x0,0x0,0x3fe2bfa2,0xbfff3f15
.long 0x0,0x0,0xbfb5bfb5,0x3fb53fb5,0x0,0x0,0xbf713fc6,0x3e49bff5
.long 0x0,0x0,0x3ffb3f8e,0xbfd53ec8,0x0,0x0,0xbe49bfe2,0x3ff53fc6
.long 0x0,0x0,0xbfedbf44,0xbf44bfed,0x0,0x0,0x3fa23ff5,0xbf713e49
.long 0x0,0x0,0x3f8e3ec8,0x3ffb3fd5,0x0,0x0,0xbff5bfff,0xbfc6bfe2
.long 0x0,0x0,0x4000c000,0x4000c000,0x0,0x0,0xbfe23fc6,0xbfff3ff5
.long 0x0,0x0,0x3f8ebec8,0x3ffbbfd5,0x0,0x0,0xbe49bf71,0xbff53fa2
.long 0x0,0x0,0xbf443fed,0x3fedbf44,0x0,0x0,0x3fc6bff5,0xbfe23e49
.long 0x0,0x0,0xbffb3f8e,0x3fd53ec8,0x0,0x0,0x3ff53e49,0xbfc6bf71
.long 0x0,0x0,0xbfb5bfb5,0x3fb53fb5,0x0,0x0,0x3f153fff,0xbfa2bfe2
.long 0x0,0x0,0x3ec8bfd5,0x3f8e3ffb,0x0,0x0,0xbfa23f15,0xbf71bfff
.long 0x0,0x0,0x3fed3f44,0x3f443fed,0x0,0x0,0xbfffbfe2,0xbf15bfc6
.long 0x0,0x0,0x3fd53ffb,0x3ec83f8e,0x0,0x0,0xbf71bfa2,0xbe49bf15
.long 0x35803500,0x35803580,0x3500,0x0,0x35353500,0xb5350000,0xb535b500,0xb535b580
.long 0x3500,0xb580,0xb5803500,0x35800000,0xb5353500,0x35350000,0xb535b500,0xb5353580
.long 0xb5803500,0xb5803580,0x3500,0x0,0xb5353500,0x35350000,0x3535b500,0x3535b580
.long 0x3500,0xb580,0x35803500,0xb5800000,0x35353500,0xb5350000,0x3535b500,0x35353580
.long 0x35803500,0x35803580,0x3500,0x0,0x35353500,0xb5350000,0xb535b500,0xb535b580
.long 0x3500,0xb580,0xb5803500,0x35800000,0xb5353500,0x35350000,0xb535b500,0xb5353580
.long 0xb5803500,0xb5803580,0x3500,0x0,0xb5353500,0x35350000,0x3535b500,0x3535b580
.long 0x3500,0xb580,0x35803500,0xb5800000,0x35353500,0xb5350000,0x3535b500,0x35353580
.long 0x35803580,0x35803580,0x0,0x0,0x350e357b,0xb555b448,0xb555b448,0xb50eb57b
.long 0xb4c4356d,0x34c4b56d,0xb56db4c4,0x356d34c4,0xb57b3555,0x3448350e,0xb448b50e,0xb57b3555
.long 0xb5353535,0xb5353535,0x3535b535,0x3535b535,0x3448350e,0x357bb555,0x357bb555,0xb448b50e
.long 0x356d34c4,0xb56db4c4,0x34c4b56d,0xb4c4356d,0x35553448,0x350e357b,0xb50eb57b,0x35553448
.long 0x0,0x0,0xb580b580,0xb580b580,0xb555b448,0xb50eb57b,0xb50eb57b,0x35553448
.long 0xb56db4c4,0x356d34c4,0x34c4b56d,0xb4c4356d,0xb448b50e,0xb57b3555,0x357bb555,0xb448b50e
.long 0x3535b535,0x3535b535,0x3535b535,0x3535b535,0x357bb555,0xb448b50e,0xb448b50e,0xb57b3555
.long 0x34c4b56d,0xb4c4356d,0xb56db4c4,0x356d34c4,0xb50eb57b,0x35553448,0xb555b448,0xb50eb57b
.long 0x35803580,0x35803580,0x0,0x0,0x34c4356d,0xb56db4c4,0xb56db4c4,0xb4c4b56d
.long 0xb5353535,0x3535b535,0xb535b535,0x35353535,0xb56d34c4,0xb4c4356d,0x34c4b56d,0xb56d34c4
.long 0x0,0x0,0x3580b580,0x3580b580,0x356db4c4,0x34c4b56d,0x34c4b56d,0xb56d34c4
.long 0x3535b535,0xb5353535,0xb535b535,0x35353535,0xb4c4b56d,0x356d34c4,0xb56db4c4,0xb4c4b56d
.long 0xb580b580,0xb580b580,0x0,0x0,0xb4c4b56d,0x356d34c4,0x356d34c4,0x34c4356d
.long 0x3535b535,0xb5353535,0x35353535,0xb535b535,0x356db4c4,0x34c4b56d,0xb4c4356d,0x356db4c4
.long 0x0,0x0,0xb5803580,0xb5803580,0xb56d34c4,0xb4c4356d,0xb4c4356d,0x356db4c4
.long 0xb5353535,0x3535b535,0x35353535,0xb535b535,0x34c4356d,0xb56db4c4,0x356d34c4,0x34c4356d
.long 0x35803580,0x35803580,0x0,0x0,0x34483555,0xb57bb50e,0xb57bb50e,0xb448b555
.long 0xb56d34c4,0x356db4c4,0xb4c4b56d,0x34c4356d,0xb50eb448,0xb555357b,0x3555b57b,0xb50eb448
.long 0x3535b535,0x3535b535,0x3535b535,0x3535b535,0x3555b57b,0xb50eb448,0xb50eb448,0xb555357b
.long 0xb4c4b56d,0x34c4356d,0xb56d34c4,0x356db4c4,0xb57bb50e,0xb448b555,0x34483555,0xb57bb50e
.long 0x0,0x0,0x35803580,0x35803580,0x357b350e,0x34483555,0x34483555,0xb57bb50e
.long 0x34c4356d,0xb4c4b56d,0xb56d34c4,0x356db4c4,0xb555357b,0x350e3448,0xb50eb448,0xb555357b
.long 0xb5353535,0xb5353535,0x3535b535,0x3535b535,0x350e3448,0x3555b57b,0x3555b57b,0xb50eb448
.long 0x356db4c4,0xb56d34c4,0xb4c4b56d,0x34c4356d,0xb448b555,0x357b350e,0xb57bb50e,0xb448b555
.long 0x35803500,0x35803580,0x3500,0x0,0x35353500,0xb5350000,0xb535b500,0xb535b580
.long 0x3500,0xb580,0xb5803500,0x35800000,0xb5353500,0x35350000,0xb535b500,0xb5353580
.long 0xb5803500,0xb5803580,0x3500,0x0,0xb5353500,0x35350000,0x3535b500,0x3535b580
.long 0x3500,0xb580,0x35803500,0xb5800000,0x35353500,0xb5350000,0x3535b500,0x35353580
.long 0x35803500,0x35803580,0x3500,0x0,0x35353500,0xb5350000,0xb535b500,0xb535b580
.long 0x3500,0xb580,0xb5803500,0x35800000,0xb5353500,0x35350000,0xb535b500,0xb5353580
.long 0xb5803500,0xb5803580,0x3500,0x0,0xb5353500,0x35350000,0x3535b500,0x3535b580
.long 0x3500,0xb580,0x35803500,0xb5800000,0x35353500,0xb5350000,0x3535b500,0x35353580
.long 0xb580b580,0xb580b580,0x0,0x0,0xb50eb57b,0x35553448,0x35553448,0x350e357b
.long 0x34c4b56d,0xb4c4356d,0x356d34c4,0xb56db4c4,0x357bb555,0xb448b50e,0x3448350e,0x357bb555
.long 0x3535b535,0x3535b535,0xb5353535,0xb5353535,0xb448b50e,0xb57b3555,0xb57b3555,0x3448350e
.long 0xb56db4c4,0x356d34c4,0xb4c4356d,0x34c4b56d,0xb555b448,0xb50eb57b,0x350e357b,0xb555b448
.long 0x0,0x0,0x35803580,0x35803580,0x35553448,0x350e357b,0x350e357b,0xb555b448
.long 0x356d34c4,0xb56db4c4,0xb4c4356d,0x34c4b56d,0x3448350e,0x357bb555,0xb57b3555,0x3448350e
.long 0xb5353535,0xb5353535,0xb5353535,0xb5353535,0xb57b3555,0x3448350e,0x3448350e,0x357bb555
.long 0xb4c4356d,0x34c4b56d,0x356d34c4,0xb56db4c4,0x350e357b,0xb555b448,0x35553448,0x350e357b
.long 0x35803580,0x35803580,0x0,0x0,0x34c4356d,0xb56db4c4,0xb56db4c4,0xb4c4b56d
.long 0xb5353535,0x3535b535,0xb535b535,0x35353535,0xb56d34c4,0xb4c4356d,0x34c4b56d,0xb56d34c4
.long 0x0,0x0,0x3580b580,0x3580b580,0x356db4c4,0x34c4b56d,0x34c4b56d,0xb56d34c4
.long 0x3535b535,0xb5353535,0xb535b535,0x35353535,0xb4c4b56d,0x356d34c4,0xb56db4c4,0xb4c4b56d
.long 0xb580b580,0xb580b580,0x0,0x0,0xb4c4b56d,0x356d34c4,0x356d34c4,0x34c4356d
.long 0x3535b535,0xb5353535,0x35353535,0xb535b535,0x356db4c4,0x34c4b56d,0xb4c4356d,0x356db4c4
.long 0x0,0x0,0xb5803580,0xb5803580,0xb56d34c4,0xb4c4356d,0xb4c4356d,0x356db4c4
.long 0xb5353535,0x3535b535,0x35353535,0xb535b535,0x34c4356d,0xb56db4c4,0x356d34c4,0x34c4356d
.long 0xb580b580,0xb580b580,0x0,0x0,0xb448b555,0x357b350e,0x357b350e,0x34483555
.long 0x356db4c4,0xb56d34c4,0x34c4356d,0xb4c4b56d,0x350e3448,0x3555b57b,0xb555357b,0x350e3448
.long 0xb5353535,0xb5353535,0xb5353535,0xb5353535,0xb555357b,0x350e3448,0x350e3448,0x3555b57b
.long 0x34c4356d,0xb4c4b56d,0x356db4c4,0xb56d34c4,0x357b350e,0x34483555,0xb448b555,0x357b350e
.long 0x0,0x0,0xb580b580,0xb580b580,0xb57bb50e,0xb448b555,0xb448b555,0x357b350e
.long 0xb4c4b56d,0x34c4356d,0x356db4c4,0xb56d34c4,0x3555b57b,0xb50eb448,0x350e3448,0x3555b57b
.long 0x3535b535,0x3535b535,0xb5353535,0xb5353535,0xb50eb448,0xb555357b,0xb555357b,0x350e3448
.long 0xb56d34c4,0x356db4c4,0x34c4356d,0xb4c4b56d,0x34483555,0xb57bb50e,0x357b350e,0x34483555
.size k3_tab, 14336
.text
code_end:
.section .rodata,"a"
.p2align 6
.amdhsa_kernel adaLN_cond__spectral_gfnet__mixer_channel_mlp__prompt_kernel
  .amdhsa_next_free_vgpr 256
  .amdhsa_next_free_sgpr 70
  .amdhsa_accum_offset 256
  .amdhsa_group_segment_fixed_size 0
  .amdhsa_kernarg_size 104
  .amdhsa_user_sgpr_count 2
  .amdhsa_user_sgpr_kernarg_segment_ptr 1
  .amdhsa_system_sgpr_workgroup_id_x 1
  .amdhsa_float_denorm_mode_32 3
.end_amdhsa_kernel
```
